```python
import torch

def _softmax(x, axis=-1):
    return torch.softmax(x, dim=axis)
def _gelu(x):
    return torch.nn.functional.gelu(x, approximate="tanh")
def _silu(x):
    return torch.nn.functional.silu(x)
def _sigmoid(x):
    return torch.sigmoid(x)
def _layernorm(x, axis=-1, eps=1e-5):
    m = x.mean(dim=axis, keepdim=True)
    v = x.var(dim=axis, keepdim=True, unbiased=False)
    return (x - m) / torch.sqrt(v + eps)
def _scatter_add(tgt, idx, src, axis=0):
    return tgt.clone().index_add_(axis, idx, src)
def _segment_sum(src, seg, n):
    out = torch.zeros((n,) + src.shape[1:], dtype=src.dtype)
    return out.index_add_(0, seg, src)
def _pad(x, pw):
    flat = tuple(v for pair in reversed(pw) for v in pair)
    return torch.nn.functional.pad(x, flat)

kernel_name = 'interleave_layers__ssm_conv_s4d__glu_gated_geglu__prompt'

def setup_inputs():

    _w = (lambda a: (lambda t: t.to(torch.bfloat16) if t.is_floating_point() else t)(torch.as_tensor(a)))
    def _A_setup():
        Bsz, L, D, N = 1, 2048, 512, 128
        return {
            "u": _w((lambda *s: torch.randn(*s, dtype=torch.bfloat16) * 0.05)(Bsz, L, D)),
            "log_A_real": _w((lambda *s: torch.randn(*s, dtype=torch.bfloat16) * 3.2)(D, N) * 0.5),
            "A_imag": _w((lambda *s: torch.randn(*s, dtype=torch.bfloat16) * 0.05)(D, N) * 3.14),
            "C_real": _w((lambda *s: torch.randn(*s, dtype=torch.bfloat16) * 0.05)(D, N) / N ** 0.5),
            "C_imag": _w((lambda *s: torch.randn(*s, dtype=torch.bfloat16) * 0.05)(D, N) / N ** 0.5),
            "log_dt": _w((lambda *s: torch.randn(*s, dtype=torch.bfloat16) * 0.05)(D) * 0.5 - 4.0),
            "D_skip": _w((lambda *s: torch.randn(*s, dtype=torch.bfloat16) * 0.05)(D)),
        }
    _A_in = _A_setup()

    def _B_setup():
        B, S, Dm, Df = 1, 2048, 512, 1376
        return {
            "x": _w((lambda *s: torch.randn(*s, dtype=torch.bfloat16) * 0.05)(B, S, Dm)),
            "w_gate": _w((lambda *s: torch.randn(*s, dtype=torch.bfloat16) * 0.8)(Dm, Df) * (Dm ** -0.5)),
            "w_up": _w((lambda *s: torch.randn(*s, dtype=torch.bfloat16) * 0.8)(Dm, Df) * (Dm ** -0.5)),
            "w_down": _w((lambda *s: torch.randn(*s, dtype=torch.bfloat16) * 0.8)(Df, Dm) * (Df ** -0.5)),
        }
    _B_in = _B_setup()

    return {
        "A_u": _A_in["u"],
        "A_log_A_real": _A_in["log_A_real"],
        "A_A_imag": _A_in["A_imag"],
        "A_C_real": _A_in["C_real"],
        "A_C_imag": _A_in["C_imag"],
        "A_log_dt": _A_in["log_dt"],
        "A_D_skip": _A_in["D_skip"],
        "B_x": _B_in["x"],
        "B_w_gate": _B_in["w_gate"],
        "B_w_up": _B_in["w_up"],
        "B_w_down": _B_in["w_down"],
    }

def reference(A_u, A_log_A_real, A_A_imag, A_C_real, A_C_imag, A_log_dt, A_D_skip, B_x, B_w_gate, B_w_up, B_w_down):
    def _A_ref(u, log_A_real, A_imag, C_real, C_imag, log_dt, D_skip):
        L = u.shape[1]
        dt = torch.exp(log_dt)
        A = -torch.exp(log_A_real) + 1j * A_imag
        C = (C_real + 1j * C_imag) * dt[:, None]
        pos = (lambda x, dt: x.to(dt))(torch.arange(L), log_dt.dtype)
        P = torch.exp((A * dt[:, None])[:, :, None] * pos[None, None, :])
        K = 2.0 * torch.einsum("dn,dnl->dl", C, P).real
        L2 = 2 * L
        u_t = (lambda x, *d: x.permute(*d))(u, 0, 2, 1)
        Kf = (lambda x, *a, **k: torch.fft.rfft(x.float(), *a, **k))(K, L2)
        Uf = (lambda x, *a, **k: torch.fft.rfft(x.float(), *a, **k))(u_t, L2)
        y = (lambda x, *a, **k: torch.fft.irfft(x, *a, **k).to(torch.bfloat16))(Uf * Kf[None, :, :], L2)[:, :, :L]
        y = (lambda x, *d: x.permute(*d))(y, 0, 2, 1)
        return y + u * D_skip[None, None, :]

    def _B_ref(x, w_gate, w_up, w_down):
        g = torch.einsum("bsd,df->bsf", x, w_gate)
        u = torch.einsum("bsd,df->bsf", x, w_up)
        h = _gelu(g) * u
        return torch.einsum("bsf,fd->bsd", h, w_down)

    x = A_u
    x = x + _A_ref(_layernorm(x, axis=-1), A_log_A_real, A_A_imag, A_C_real, A_C_imag, A_log_dt, A_D_skip)
    x = x + _B_ref(_layernorm(x, axis=-1), B_w_gate, B_w_up, B_w_down)
    x = x + _A_ref(_layernorm(x, axis=-1), A_log_A_real, A_A_imag, A_C_real, A_C_imag, A_log_dt, A_D_skip)
    x = x + _B_ref(_layernorm(x, axis=-1), B_w_gate, B_w_up, B_w_down)
    return x
```

```asm
; @launch grid=(256,1,1) block=(256,1,1) lds=163840
.amdgcn_target "amdgcn-amd-amdhsa--gfx950"
.text
.globl interleave_layers__ssm_conv_s4d__glu_gated_geglu__prompt_kernel
.p2align 8
.type interleave_layers__ssm_conv_s4d__glu_gated_geglu__prompt_kernel,@function
interleave_layers__ssm_conv_s4d__glu_gated_geglu__prompt_kernel:
    s_cmp_ge_u32 s2, 256
    s_cbranch_scc1 mk_end
    s_load_dwordx16 s[56:71], s[0:1], 0
    s_load_dwordx8 s[72:79], s[0:1], 64
    s_load_dwordx4 s[12:15], s[0:1], 96
    s_getpc_b64 s[46:47]
    s_lshr_b32 s31, s2, 3
    s_lshl_b32 s31, s31, 12
    v_lshl_add_u32 v27, v0, 4, s31
    v_min_u32 v27, mk_codeend - interleave_layers__ssm_conv_s4d__glu_gated_geglu__prompt_kernel - 64, v27
    v_mov_b32 v249, s47
    v_add_co_u32 v248, vcc, s46, v27
    s_nop 1
    v_addc_co_u32 v249, vcc, 0, v249, vcc
    global_load_dwordx4 v[244:247], v[248:249], off
    v_and_b32 v1, 63, v0
    v_lshrrev_b32 v24, 6, v0
    s_nop 0
    v_readfirstlane_b32 s3, v24
    v_lshlrev_b32 v2, 4, v1
    v_lshlrev_b32 v3, 4, v0
    v_lshlrev_b32 v94, 1, v1
    v_lshlrev_b32 v95, 2, v1
    v_lshrrev_b32 v24, 3, v1
    v_lshlrev_b32 v24, 10, v24
    v_and_b32 v25, 7, v1
    v_lshl_add_u32 v96, v25, 4, v24
    v_and_b32 v97, 15, v1
    v_lshrrev_b32 v98, 4, v1
    s_lshr_b32 s90, s3, 1
    s_and_b32 s89, s3, 1
    s_lshl_b32 s88, s2, 1
    s_add_u32 s88, s88, s90
    s_lshl_b32 s95, s2, 2
    s_add_u32 s95, s95, s3
    s_mov_b32 s82, 131072
    s_mov_b32 s83, 0x20000
    s_mov_b32 s86, 131072
    s_mov_b32 s87, 0x20000
    s_mov_b32 s6, 268435456
    s_mov_b32 s7, 0x20000
    s_mov_b32 s10, 2097152
    s_mov_b32 s11, 0x20000
    s_bfe_u32 s97, s2, 0x20001
    s_mul_i32 s97, s97, 22
    s_min_u32 s97, s97, 64
    s_lshr_b32 s34, s2, 3
    s_mul_i32 s96, s34, 44032
    s_lshl_b32 s33, s97, 5
    s_add_u32 s96, s96, s33
    s_xor_b32 s99, s3, 3
    s_lshl_b32 s99, s99, 8
    s_add_u32 s99, s99, s2
    s_lshr_b32 s32, s99, 3
    s_lshl_b32 s98, s32, 15
    s_and_b32 s32, s2, 7
    s_lshl_b32 s29, s32, 7
    s_add_u32 s98, s98, s29
    v_add_u32 v24, 0, v0
    v_mul_u32_u24 v25, 1490, v24
    v_lshrrev_b32 v25, 16, v25
    v_mul_u32_u24 v25, 2048, v25
    v_lshl_add_u32 v107, v24, 4, v25
    v_add_u32 v24, 256, v0
    v_mul_u32_u24 v25, 1490, v24
    v_lshrrev_b32 v25, 16, v25
    v_mul_u32_u24 v25, 2048, v25
    v_lshl_add_u32 v108, v24, 4, v25
    v_add_u32 v24, 512, v0
    v_mul_u32_u24 v25, 1490, v24
    v_lshrrev_b32 v25, 16, v25
    v_mul_u32_u24 v25, 2048, v25
    v_lshl_add_u32 v109, v24, 4, v25
    v_mov_b32 v25, 2146435072
    v_cmp_gt_u32 vcc, 192, v0
    s_lshl_b32 s42, s34, 16
    s_lshl_b32 s32, s3, 14
    v_cndmask_b32 v109, v25, v109, vcc
    s_add_u32 s36, s42, s32
    s_add_u32 s36, s36, s29
    s_lshl_b32 s32, s3, 11
    s_add_u32 m0, s32, 28672
    s_lshl_b32 s31, s88, 8
    s_lshl_b32 s32, s89, 7
    s_add_u32 s32, s32, s31
    s_lshl_b32 s33, s2, 2
    s_lshl_b32 s34, s95, 11
    v_mov_b32 v132, 0
    v_mov_b32 v133, 0
    v_mov_b32 v134, 0
    v_mov_b32 v135, 0
    v_lshlrev_b32 v19, 7, v1
    v_lshlrev_b32 v26, 8, v1
    s_mov_b32 s39, 16220160
    s_cmp_eq_u32 s95, 3
    s_cselect_b32 s39, s39, 2146435072
    s_cselect_b32 s28, 0, 2146435072
    s_add_u32 s38, s39, 16384
    v_mov_b32 v21, 1
    s_waitcnt lgkmcnt(0)
    s_mov_b32 s4, s14
    s_mov_b32 s5, s15
    buffer_store_dword v132, v26, s[4:7], s39 offen sc1
    buffer_store_dword v132, v26, s[4:7], s38 offen sc1
    s_mov_b64 exec, -1
    s_mov_b32 s8, s56
    s_mov_b32 s9, s57
    buffer_load_dwordx4 v96, s[8:11], s36 offen nt lds
    s_add_u32 m0, m0, 1024
    s_add_u32 s36, s36, 8192
    buffer_load_dwordx4 v96, s[8:11], s36 offen nt lds
    s_load_dword s91, s[66:67], s33
    s_load_dword s92, s[68:69], s33
    s_mov_b32 s80, s58
    s_mov_b32 s81, s59
    s_mov_b32 s84, s62
    s_mov_b32 s85, s63
    buffer_load_ushort v32, v94, s[80:83], s32 offen
    buffer_load_dword v36, v95, s[84:87], s31 offen
    buffer_load_ushort v34, v94, s[84:87], s32 offen
    s_mov_b32 s80, s60
    s_mov_b32 s81, s61
    s_mov_b32 s84, s64
    s_mov_b32 s85, s65
    buffer_load_ushort v33, v94, s[80:83], s32 offen
    buffer_load_dword v37, v95, s[84:87], s31 offen
    buffer_load_ushort v35, v94, s[84:87], s32 offen
    buffer_load_dwordx4 v[48:51], v2, s[8:11], s34 offen nt
    buffer_load_dwordx4 v[52:55], v2, s[8:11], s34 offen offset:1024 nt
    s_mov_b32 s14, 256
    s_mov_b32 s15, 0x20000
    s_mov_b32 s8, s78
    s_mov_b32 s9, s79
    s_bitcmp1_b32 s2, 0
    s_cselect_b32 s80, s74, s72
    s_cselect_b32 s81, s75, s73
    s_mov_b32 s82, 1409024
    s_mov_b32 s84, s76
    s_mov_b32 s85, s77
    s_mov_b32 s86, 1409024
    s_lshl_b32 s35, s3, 10
    s_lshl_b32 s40, s3, 12
    s_lshl_b32 s37, s95, 9
    s_lshr_b32 s38, s95, 6
    s_add_u32 s37, s37, 15990784
    s_cmp_eq_u32 s38, 7
    s_cselect_b32 s37, 2146435072, s37
    s_cmp_ge_u32 s38, 11
    s_cselect_b32 s37, 2146435072, s37
    s_mov_b64 exec, 15
    buffer_store_dword v132, v19, s[4:7], s37 offen sc1
    s_lshl_b32 s37, s95, 7
    s_add_u32 s37, s37, 15859712
    s_mov_b64 exec, 0xff
    buffer_store_dwordx4 v[132:135], v2, s[4:7], s37 offen sc1
    s_mov_b64 exec, -1
    v_lshrrev_b32 v24, 2, v97
    v_lshl_add_u32 v24, v98, 3, v24
    v_lshlrev_b32 v24, 7, v24
    v_and_b32 v25, 3, v97
    v_lshl_add_u32 v99, v25, 3, v24
    s_lshl_b32 s31, s3, 5
    s_add_u32 s31, s31, 28672
    v_add_u32 v99, s31, v99
    v_lshlrev_b32 v100, 6, v97
    v_lshl_add_u32 v100, v98, 4, v100
    s_lshl_b32 s32, s29, 5
    s_add_u32 s42, s42, s32
    s_add_u32 s42, s42, s35
    s_add_u32 s43, s42, 32768
    v_lshl_add_u32 v106, v98, 6, s35
    s_mov_b32 s25, 400000
    s_mov_b32 s24, 0x3f803f80
    s_mov_b32 s16, 0x3b000000
    s_mov_b32 s17, 0x3b000000
    s_mov_b32 s18, 0x3727c5ac
    s_mov_b32 s19, 0x3727c5ac
    v_subrev_u32 v24, 7, v97
    v_lshlrev_b32 v24, 7, v24
    v_subrev_u32 v25, 10, v97
    v_lshlrev_b32 v25, 9, v25
    v_cmp_eq_u32 vcc, 15, v97
    v_max3_i32 v92, v97, v24, v25
    v_mov_b32 v24, 516
    v_cndmask_b32 v92, v92, v24, vcc
    v_cvt_f32_u32 v92, v92
    v_lshlrev_b32 v93, 3, v97
    s_waitcnt vmcnt(12)
    s_mov_b64 exec, 1
    buffer_store_dword v21, off, s[12:15], s28 sc1
    s_mov_b64 exec, -1
    v_cvt_f32_u32 v93, v93
    v_lshrrev_b32 v24, 5, v1
    v_mul_u32_u24 v26, 4096, v24
    v_add_u32 v26, v2, v26
    ds_write_b128 v26, v[132:135] offset:16640
    v_bfe_u32 v26, v1, 2, 2
    v_mul_u32_u24 v27, 4160, v26
    v_and_b32 v25, 3, v1
    v_lshl_add_u32 v27, v25, 4, v27
    ds_write_b128 v27, v[132:135] offset:4096
    v_lshl_add_u32 v26, v24, 3, v26
    v_mul_u32_u24 v101, 704, v26
    v_lshlrev_b32 v103, 7, v26
    v_lshl_add_u32 v103, v25, 3, v103
    v_bfe_u32 v25, v1, 4, 1
    v_lshl_add_u32 v101, v25, 5, v101
    v_lshl_add_u32 v103, v25, 5, v103
    v_lshlrev_b32 v102, 15, v25
    v_lshl_add_u32 v102, v24, 9, v102
    v_lshl_add_u32 v102, v97, 4, v102
    v_and_b32 v25, 1, v1
    v_lshl_add_u32 v101, v25, 4, v101
    v_bfe_u32 v25, v1, 1, 1
    v_lshl_add_u32 v101, v25, 3, v101
    s_lshl_b32 s31, s3, 6
    s_add_u32 s31, s31, 64000
    v_add_u32 v101, s31, v101
    s_add_u32 s31, s40, 76288
    v_add_u32 v103, s31, v103
    s_lshl_b32 s97, s97, 15
    s_add_u32 m0, s35, 64000
    s_nop 0
    buffer_load_dwordx4 v107, s[80:83], s96 offen nt lds
    s_lshr_b32 s32, s2, 3
    s_lshl_b32 s32, s32, 10
    s_add_u32 s97, s97, s32
    s_and_b32 s32, s2, 1
    s_lshl_b32 s32, s32, 8
    s_add_u32 s97, s97, s32
    s_lshl_b32 s32, s3, 16
    s_add_u32 s97, s97, s32
    s_add_u32 m0, s35, 68096
    s_nop 0
    buffer_load_dwordx4 v108, s[80:83], s96 offen nt lds
    s_add_u32 s97, s97, 16777216
    v_lshlrev_b32 v17, 11, v0
    v_mov_b32 v25, 2146435072
    v_cmp_gt_u32 s[54:55], 16, v0
    v_cmp_gt_u32 s[52:53], 2, v0
    v_cmp_gt_u32 vcc, 8, v0
    v_lshlrev_b32 v19, 7, v0
    v_lshlrev_b32 v18, 8, v0
    s_add_u32 m0, s35, 72192
    s_nop 0
    buffer_load_dwordx4 v109, s[80:83], s96 offen nt lds
    v_add_u32 v23, 90112, v2
    v_cndmask_b32 v17, v25, v17, s[54:55]
    v_cndmask_b32 v13, v25, v19, s[52:53]
    v_cndmask_b32 v19, v25, v19, s[54:55]
    v_cndmask_b32 v18, v25, v18, vcc
    s_and_b32 s32, s2, 15
    s_lshl_b32 s26, s32, 7
    s_lshl_b32 s27, s32, 11
    s_add_u32 m0, s40, 76288
    s_nop 0
    buffer_load_dwordx4 v96, s[84:87], s98 offen nt lds
    s_add_u32 s98, s98, 8192
    v_lshlrev_b32 v24, 3, v0
    v_sub_u32 v24, 2047, v24
    v_cvt_f32_u32 v24, v24
    v_mov_b32 v25, v24
    v_add_f32 v26, 0xbf800000, v24
    v_cvt_pk_bf16_f32 v25, v25, v26
    v_and_b32 v120, 0xffff, v25
    s_add_u32 m0, s40, 77312
    s_nop 0
    buffer_load_dwordx4 v96, s[84:87], s98 offen nt lds
    s_add_u32 s98, s98, 8192
    v_lshlrev_b32 v120, 1, v120
    v_lshrrev_b32 v121, 15, v25
    v_add_f32 v25, 0xc0000000, v24
    v_add_f32 v26, 0xc0400000, v24
    v_cvt_pk_bf16_f32 v25, v25, v26
    v_and_b32 v122, 0xffff, v25
    v_lshlrev_b32 v122, 1, v122
    v_lshrrev_b32 v123, 15, v25
    s_add_u32 m0, s40, 78336
    s_nop 0
    buffer_load_dwordx4 v96, s[84:87], s98 offen nt lds
    s_add_u32 s98, s98, 8192
    v_add_f32 v25, 0xc0800000, v24
    v_add_f32 v26, 0xc0a00000, v24
    v_cvt_pk_bf16_f32 v25, v25, v26
    v_and_b32 v124, 0xffff, v25
    v_lshlrev_b32 v124, 1, v124
    v_lshrrev_b32 v125, 15, v25
    v_add_f32 v25, 0xc0c00000, v24
    v_add_f32 v26, 0xc0e00000, v24
    s_add_u32 m0, s40, 79360
    s_nop 0
    buffer_load_dwordx4 v96, s[84:87], s98 offen nt lds
    s_add_u32 s98, s98, 8192
    v_max_f32 v26, 0.5, v26
    v_cvt_pk_bf16_f32 v25, v25, v26
    v_and_b32 v126, 0xffff, v25
    v_lshlrev_b32 v126, 1, v126
    v_lshrrev_b32 v127, 15, v25
    v_add_f32 v25, 0xc1000000, v24
    v_add_f32 v26, 0xc1100000, v24
    v_max_f32 v25, 0.5, v25
    v_cvt_pk_bf16_f32 v25, v25, v26
    v_and_b32 v128, 0xffff, v25
    v_lshlrev_b32 v128, 1, v128
    s_lshr_b32 s32, s99, 3
    s_lshl_b32 s32, s32, 11
    s_cmp_ge_u32 s99, 352
    s_mul_i32 s99, s29, 1408
    s_cselect_b32 s32, 2146435072, s32
    s_add_u32 s99, s99, s32
    s_add_u32 s99, s99, 20971520
    v_lshlrev_b32 v24, 2, v98
    v_cvt_f32_u32 v112, v24
    v_add_f32 v113, 1.0, v112
    v_add_f32 v114, 2.0, v112
    v_add_f32 v115, 2.0, v113
    s_mov_b32 exec_lo, 0
    v_mov_b32 v112, 0x44800000
    v_mov_b32 v113, 0x44c00000
    v_mov_b32 v114, 0x45000000
    v_mov_b32 v115, 0x44010000
    s_mov_b32 exec_hi, 0xffff
    v_mov_b32 v115, 0x44000000
    s_mov_b64 exec, -1
    s_mul_i32 s31, s89, 0x43800000
    v_add_f32 v24, s31, v93
    s_mul_i32 s32, s90, 3328
    v_add_f32 v112, v112, v24
    v_add_f32 v113, v113, v24
    v_add_f32 v114, v114, v24
    v_add_f32 v115, v115, v24
    v_add_f32 v116, 0x43000000, v112
    v_add_f32 v117, 0x43000000, v113
    v_add_f32 v118, 0x43000000, v114
    v_add_f32 v119, 0x43000000, v115
    v_max_f32 v112, 0.5, v112
    v_lshrrev_b32 v112, 15, v112
    v_lshrrev_b32 v113, 15, v113
    v_lshrrev_b32 v114, 15, v114
    v_lshrrev_b32 v115, 15, v115
    v_lshrrev_b32 v116, 15, v116
    v_lshrrev_b32 v117, 15, v117
    v_lshrrev_b32 v118, 15, v118
    v_lshrrev_b32 v119, 15, v119
    v_add_u32 v112, s32, v112
    v_add_u32 v113, s32, v113
    v_add_u32 v114, s32, v114
    v_add_u32 v115, s32, v115
    v_add_u32 v116, s32, v116
    v_add_u32 v117, s32, v117
    v_add_u32 v118, s32, v118
    v_add_u32 v119, s32, v119
    s_waitcnt vmcnt(10)
    s_waitcnt lgkmcnt(0)
    s_barrier
    ds_read_b64_tr_b16 v[56:57], v99 offset:0
    ds_read_b64_tr_b16 v[58:59], v99 offset:512
    ds_read_b64_tr_b16 v[60:61], v99 offset:4096
    ds_read_b64_tr_b16 v[62:63], v99 offset:4608
    s_lshl_b32 s32, s90, 4
    s_lshr_b32 s91, s91, s32
    s_lshl_b32 s91, s91, 16
    v_mov_b32 v24, 0x3fb8aa3b
    v_mul_f32 v105, s91, v24
    v_lshlrev_b32 v32, 16, v32
    v_mul_f32 v32, v32, v24
    v_exp_f32 v105, v105
    v_exp_f32 v32, v32
    v_and_b32 v36, 0x7fff7fff, v36
    v_and_b32 v37, 0x7fff7fff, v37
    v_pk_max_u16 v36, v36, v37
    v_cvt_pk_bf16_f32 v105, v105, v32
    v_lshrrev_b32 v37, 16, v36
    v_and_b32 v36, 0xffff, v36
    v_max_u32 v36, v36, v37
    v_and_b32 v32, 0xffff0000, v105
    v_lshlrev_b32 v105, 16, v105
    v_max_u32_dpp v36, v36, v36 row_ror:8 row_mask:0xf bank_mask:0xf
    v_mul_f32 v32, v32, v105
    v_lshlrev_b32 v33, 16, v33
    s_waitcnt lgkmcnt(0)
    buffer_store_dwordx4 v[56:59], v100, s[4:7], s42 offen sc1
    v_max_u32_dpp v36, v36, v36 row_ror:4 row_mask:0xf bank_mask:0xf
    v_mul_f32 v156, 0xbfb8aa3b, v32
    v_mul_f32 v33, v33, v105
    v_max_u32_dpp v36, v36, v36 row_ror:2 row_mask:0xf bank_mask:0xf
    v_mul_f32 v33, 0x3e22f983, v33
    v_lshlrev_b32 v34, 16, v34
    v_max_u32_dpp v36, v36, v36 row_ror:1 row_mask:0xf bank_mask:0xf
    v_lshlrev_b32 v35, 16, v35
    v_rndne_f32 v24, v33
    v_readlane_b32 s31, v36, 0
    v_readlane_b32 s32, v36, 16
    v_readlane_b32 s33, v36, 32
    v_readlane_b32 s34, v36, 48
    v_sub_f32 v157, v33, v24
    buffer_store_dwordx4 v[60:63], v100, s[4:7], s43 offen sc1
    s_max_u32 s31, s31, s32
    s_max_u32 s33, s33, s34
    s_max_u32 s31, s31, s33
    s_lshr_b32 s31, s31, 7
    s_max_u32 s31, s31, 1
    s_min_u32 s31, s31, 253
    s_lshl_b32 s94, s31, 23
    s_sub_u32 s93, 254, s31
    s_lshl_b32 s93, s93, 23
    v_mul_f32 v158, s93, v34
    v_mul_f32 v159, s93, v35
    ds_write_b128 v3, v[156:159] offset:36864
    v_add_f32 v104, v105, v105
    v_mul_f32 v104, s94, v104
    v_mov_b32 v140, 0
    v_mov_b32 v141, 0
    v_mov_b32 v142, 0
    v_mov_b32 v143, 0
    v_dot2c_f32_bf16 v140, s24, v48
    v_dot2c_f32_bf16 v142, v48, v48
    v_dot2c_f32_bf16 v141, s24, v52
    v_dot2c_f32_bf16 v143, v52, v52
    v_dot2c_f32_bf16 v140, s24, v49
    v_dot2c_f32_bf16 v142, v49, v49
    v_dot2c_f32_bf16 v141, s24, v53
    v_dot2c_f32_bf16 v143, v53, v53
    v_dot2c_f32_bf16 v140, s24, v50
    v_dot2c_f32_bf16 v142, v50, v50
    v_dot2c_f32_bf16 v141, s24, v54
    v_dot2c_f32_bf16 v143, v54, v54
    v_dot2c_f32_bf16 v140, s24, v51
    v_dot2c_f32_bf16 v142, v51, v51
    v_dot2c_f32_bf16 v141, s24, v55
    v_dot2c_f32_bf16 v143, v55, v55
    s_waitcnt lgkmcnt(0)
    s_nop 0
    v_permlane32_swap_b32 v140, v141
    v_permlane32_swap_b32 v142, v143
    v_add_f32 v140, v140, v141
    v_add_f32 v142, v142, v143
    ds_read_b128 v[172:175], v106 offset:36864
    v_add_f32_dpp v140, v140, v140 row_ror:8 row_mask:0xf bank_mask:0xf
    v_add_f32_dpp v142, v142, v142 row_ror:8 row_mask:0xf bank_mask:0xf
    ds_read_b128 v[176:179], v106 offset:36880
    v_add_f32_dpp v140, v140, v140 row_ror:4 row_mask:0xf bank_mask:0xf
    v_add_f32_dpp v142, v142, v142 row_ror:4 row_mask:0xf bank_mask:0xf
    ds_read_b128 v[180:183], v106 offset:36896
    v_add_f32_dpp v140, v140, v140 row_ror:2 row_mask:0xf bank_mask:0xf
    v_add_f32_dpp v142, v142, v142 row_ror:2 row_mask:0xf bank_mask:0xf
    ds_read_b128 v[184:187], v106 offset:36912
    v_add_f32_dpp v140, v140, v140 row_ror:1 row_mask:0xf bank_mask:0xf
    v_add_f32_dpp v142, v142, v142 row_ror:1 row_mask:0xf bank_mask:0xf
    v_mov_b32 v141, v140
    v_mov_b32 v143, v142
    ds_read_b128 v[188:191], v106 offset:37120
    ds_read_b128 v[192:195], v106 offset:37136
    v_permlane16_swap_b32 v140, v141
    v_permlane16_swap_b32 v142, v143
    v_add_f32 v140, v140, v141
    v_add_f32 v142, v142, v143
    v_mul_f32 v140, s16, v140
    v_mul_f32 v142, s16, v142
    ds_read_b128 v[196:199], v106 offset:37152
    v_fma_f32 v142, -v140, v140, v142
    ds_read_b128 v[200:203], v106 offset:37168
    v_max_f32 v142, 0, v142
    ds_read_b128 v[204:207], v106 offset:37376
    v_add_f32 v142, s18, v142
    ds_read_b128 v[208:211], v106 offset:37392
    v_rsq_f32 v142, v142
    ds_read_b128 v[212:215], v106 offset:37408
    ds_read_b128 v[216:219], v106 offset:37424
    v_mul_f32_e64 v140, -v140, v142
    ds_read_b128 v[220:223], v106 offset:37632
    ds_read_b128 v[224:227], v106 offset:37648
    ds_read_b128 v[228:231], v106 offset:37664
    ds_read_b128 v[232:235], v106 offset:37680
    v_mov_b32 v143, v142
    v_mov_b32 v141, v140
    s_lshl_b32 s33, s95, 4
    s_add_u32 s33, s33, 15728640
    v_permlane32_swap_b32 v142, v143
    v_permlane32_swap_b32 v140, v141
    s_mov_b64 exec, 1
    buffer_store_dwordx4 v[140:143], off, s[4:7], s33 sc1
    s_mov_b64 exec, -1
    buffer_load_dword v20, v18, s[12:15], 0 offen sc1
    s_waitcnt lgkmcnt(0)
    v_pk_mul_f32 v[34:35], v[172:173], v[92:93] op_sel:[1,0] op_sel_hi:[1,1]
    v_pk_mul_f32 v[32:33], v[172:173], v[92:93] op_sel:[0,0] op_sel_hi:[0,1]
    v_fract_f32 v34, v34
    v_cos_f32 v38, v35
    v_sin_f32 v39, v35
    v_exp_f32 v33, v33
    v_exp_f32 v32, v32
    v_cos_f32 v36, v34
    v_sin_f32_e64 v37, v34
    v_pk_mul_f32 v[38:39], v[38:39], v[32:33] op_sel:[0,1] op_sel_hi:[1,1]
    v_pk_mul_f32 v[36:37], v[36:37], v[32:33] op_sel:[0,0] op_sel_hi:[1,0]
    v_pk_mul_f32 v[34:35], v[38:39], v[174:175] op_sel:[0,0] op_sel_hi:[1,0]
    v_cvt_pk_f16_f32 v136, v36, -v37
    v_pk_fma_f32 v[34:35], v[38:39], v[174:175], v[34:35] op_sel:[1,1,0] op_sel_hi:[0,1,1] neg_lo:[1,0,0]
    v_cvt_pk_f16_f32 v140, v34, v35
    v_mov_b32_dpp v40, v136 row_newbcast:8 row_mask:0xf bank_mask:0xf
    v_mov_b32_dpp v41, v136 row_newbcast:9 row_mask:0xf bank_mask:0xf
    v_mov_b32_dpp v42, v136 row_newbcast:10 row_mask:0xf bank_mask:0xf
    v_pk_mul_f16 v43, v140, v40 op_sel:[0,0] op_sel_hi:[1,0]
    v_pk_mul_f16 v44, v140, v41 op_sel:[0,0] op_sel_hi:[1,0]
    v_pk_mul_f16 v45, v140, v42 op_sel:[0,0] op_sel_hi:[1,0]
    v_pk_fma_f16 v144, v140, v40, v43 op_sel:[1,1,0] op_sel_hi:[0,1,1] neg_hi:[1,0,0]
    v_pk_fma_f16 v148, v140, v41, v44 op_sel:[1,1,0] op_sel_hi:[0,1,1] neg_hi:[1,0,0]
    v_pk_fma_f16 v152, v140, v42, v45 op_sel:[1,1,0] op_sel_hi:[0,1,1] neg_hi:[1,0,0]
    v_pk_mul_f32 v[34:35], v[176:177], v[92:93] op_sel:[1,0] op_sel_hi:[1,1]
    v_pk_mul_f32 v[32:33], v[176:177], v[92:93] op_sel:[0,0] op_sel_hi:[0,1]
    v_fract_f32 v34, v34
    v_cos_f32 v38, v35
    v_sin_f32 v39, v35
    v_exp_f32 v33, v33
    v_exp_f32 v32, v32
    v_cos_f32 v36, v34
    v_sin_f32_e64 v37, v34
    v_pk_mul_f32 v[38:39], v[38:39], v[32:33] op_sel:[0,1] op_sel_hi:[1,1]
    v_pk_mul_f32 v[36:37], v[36:37], v[32:33] op_sel:[0,0] op_sel_hi:[1,0]
    v_pk_mul_f32 v[34:35], v[38:39], v[178:179] op_sel:[0,0] op_sel_hi:[1,0]
    v_cvt_pk_f16_f32 v137, v36, -v37
    v_pk_fma_f32 v[34:35], v[38:39], v[178:179], v[34:35] op_sel:[1,1,0] op_sel_hi:[0,1,1] neg_lo:[1,0,0]
    v_cvt_pk_f16_f32 v141, v34, v35
    v_mov_b32_dpp v40, v137 row_newbcast:8 row_mask:0xf bank_mask:0xf
    v_mov_b32_dpp v41, v137 row_newbcast:9 row_mask:0xf bank_mask:0xf
    v_mov_b32_dpp v42, v137 row_newbcast:10 row_mask:0xf bank_mask:0xf
    v_pk_mul_f16 v43, v141, v40 op_sel:[0,0] op_sel_hi:[1,0]
    v_pk_mul_f16 v44, v141, v41 op_sel:[0,0] op_sel_hi:[1,0]
    v_pk_mul_f16 v45, v141, v42 op_sel:[0,0] op_sel_hi:[1,0]
    v_pk_fma_f16 v145, v141, v40, v43 op_sel:[1,1,0] op_sel_hi:[0,1,1] neg_hi:[1,0,0]
    v_pk_fma_f16 v149, v141, v41, v44 op_sel:[1,1,0] op_sel_hi:[0,1,1] neg_hi:[1,0,0]
    v_pk_fma_f16 v153, v141, v42, v45 op_sel:[1,1,0] op_sel_hi:[0,1,1] neg_hi:[1,0,0]
    v_pk_mul_f32 v[34:35], v[180:181], v[92:93] op_sel:[1,0] op_sel_hi:[1,1]
    v_pk_mul_f32 v[32:33], v[180:181], v[92:93] op_sel:[0,0] op_sel_hi:[0,1]
    v_fract_f32 v34, v34
    v_cos_f32 v38, v35
    v_sin_f32 v39, v35
    v_exp_f32 v33, v33
    v_exp_f32 v32, v32
    v_cos_f32 v36, v34
    v_sin_f32_e64 v37, v34
    v_pk_mul_f32 v[38:39], v[38:39], v[32:33] op_sel:[0,1] op_sel_hi:[1,1]
    v_pk_mul_f32 v[36:37], v[36:37], v[32:33] op_sel:[0,0] op_sel_hi:[1,0]
    v_pk_mul_f32 v[34:35], v[38:39], v[182:183] op_sel:[0,0] op_sel_hi:[1,0]
    v_cvt_pk_f16_f32 v138, v36, -v37
    v_pk_fma_f32 v[34:35], v[38:39], v[182:183], v[34:35] op_sel:[1,1,0] op_sel_hi:[0,1,1] neg_lo:[1,0,0]
    v_cvt_pk_f16_f32 v142, v34, v35
    v_mov_b32_dpp v40, v138 row_newbcast:8 row_mask:0xf bank_mask:0xf
    v_mov_b32_dpp v41, v138 row_newbcast:9 row_mask:0xf bank_mask:0xf
    v_mov_b32_dpp v42, v138 row_newbcast:10 row_mask:0xf bank_mask:0xf
    v_pk_mul_f16 v43, v142, v40 op_sel:[0,0] op_sel_hi:[1,0]
    v_pk_mul_f16 v44, v142, v41 op_sel:[0,0] op_sel_hi:[1,0]
    v_pk_mul_f16 v45, v142, v42 op_sel:[0,0] op_sel_hi:[1,0]
    v_pk_fma_f16 v146, v142, v40, v43 op_sel:[1,1,0] op_sel_hi:[0,1,1] neg_hi:[1,0,0]
    v_pk_fma_f16 v150, v142, v41, v44 op_sel:[1,1,0] op_sel_hi:[0,1,1] neg_hi:[1,0,0]
    v_pk_fma_f16 v154, v142, v42, v45 op_sel:[1,1,0] op_sel_hi:[0,1,1] neg_hi:[1,0,0]
    v_pk_mul_f32 v[34:35], v[184:185], v[92:93] op_sel:[1,0] op_sel_hi:[1,1]
    v_pk_mul_f32 v[32:33], v[184:185], v[92:93] op_sel:[0,0] op_sel_hi:[0,1]
    v_fract_f32 v34, v34
    v_cos_f32 v38, v35
    v_sin_f32 v39, v35
    v_exp_f32 v33, v33
    v_exp_f32 v32, v32
    v_cos_f32 v36, v34
    v_sin_f32_e64 v37, v34
    v_pk_mul_f32 v[38:39], v[38:39], v[32:33] op_sel:[0,1] op_sel_hi:[1,1]
    v_pk_mul_f32 v[36:37], v[36:37], v[32:33] op_sel:[0,0] op_sel_hi:[1,0]
    v_pk_mul_f32 v[34:35], v[38:39], v[186:187] op_sel:[0,0] op_sel_hi:[1,0]
    v_cvt_pk_f16_f32 v139, v36, -v37
    v_pk_fma_f32 v[34:35], v[38:39], v[186:187], v[34:35] op_sel:[1,1,0] op_sel_hi:[0,1,1] neg_lo:[1,0,0]
    v_cvt_pk_f16_f32 v143, v34, v35
    v_mov_b32_dpp v40, v139 row_newbcast:8 row_mask:0xf bank_mask:0xf
    v_mov_b32_dpp v41, v139 row_newbcast:9 row_mask:0xf bank_mask:0xf
    v_mov_b32_dpp v42, v139 row_newbcast:10 row_mask:0xf bank_mask:0xf
    v_pk_mul_f16 v43, v143, v40 op_sel:[0,0] op_sel_hi:[1,0]
    v_pk_mul_f16 v44, v143, v41 op_sel:[0,0] op_sel_hi:[1,0]
    v_pk_mul_f16 v45, v143, v42 op_sel:[0,0] op_sel_hi:[1,0]
    v_pk_fma_f16 v147, v143, v40, v43 op_sel:[1,1,0] op_sel_hi:[0,1,1] neg_hi:[1,0,0]
    v_pk_fma_f16 v151, v143, v41, v44 op_sel:[1,1,0] op_sel_hi:[0,1,1] neg_hi:[1,0,0]
    v_pk_fma_f16 v155, v143, v42, v45 op_sel:[1,1,0] op_sel_hi:[0,1,1] neg_hi:[1,0,0]
    v_mfma_f32_16x16x32_f16 v[156:159], v[136:139], v[140:143], 0
    v_lshrrev_b32 v24, 3, v0
    v_and_b32 v26, 7, v0
    v_mfma_f32_16x16x32_f16 v[160:163], v[136:139], v[144:147], 0
    v_lshlrev_b32 v4, 15, v24
    v_lshl_add_u32 v4, v26, 4, v4
    v_mfma_f32_16x16x32_f16 v[164:167], v[136:139], v[148:151], 0
    s_lshl_b32 s31, s2, 7
    v_add_u32 v4, s31, v4
    v_mfma_f32_16x16x32_f16 v[168:171], v[136:139], v[152:155], 0
    v_and_b32 v26, 3, v0
    v_lshl_add_u32 v24, v24, 2, v26
    v_bfe_u32 v26, v0, 2, 1
    v_lshlrev_b32 v5, 5, v24
    v_lshl_add_u32 v5, v26, 4, v5
    s_waitcnt vmcnt(0)
    v_cmp_gt_u32 vcc, 1, v20
    s_nop 0
    s_and_b64 vcc, vcc, s[52:53]
    s_and_b64 vcc, vcc, 1
    s_cbranch_scc1 mk_ps1
mk_po2:
    s_barrier
    s_add_u32 s38, s27, 16220160
    buffer_atomic_add v21, v18, s[4:7], s38 offen sc1
    v_pk_mul_f32 v[34:35], v[188:189], v[92:93] op_sel:[1,0] op_sel_hi:[1,1]
    v_pk_mul_f32 v[32:33], v[188:189], v[92:93] op_sel:[0,0] op_sel_hi:[0,1]
    v_fract_f32 v34, v34
    v_cos_f32 v38, v35
    v_sin_f32 v39, v35
    v_exp_f32 v33, v33
    v_exp_f32 v32, v32
    v_cos_f32 v36, v34
    v_sin_f32_e64 v37, v34
    v_pk_mul_f32 v[38:39], v[38:39], v[32:33] op_sel:[0,1] op_sel_hi:[1,1]
    v_pk_mul_f32 v[36:37], v[36:37], v[32:33] op_sel:[0,0] op_sel_hi:[1,0]
    v_pk_mul_f32 v[34:35], v[38:39], v[190:191] op_sel:[0,0] op_sel_hi:[1,0]
    v_cvt_pk_f16_f32 v136, v36, -v37
    v_pk_fma_f32 v[34:35], v[38:39], v[190:191], v[34:35] op_sel:[1,1,0] op_sel_hi:[0,1,1] neg_lo:[1,0,0]
    v_cvt_pk_f16_f32 v140, v34, v35
    v_mov_b32_dpp v40, v136 row_newbcast:8 row_mask:0xf bank_mask:0xf
    v_mov_b32_dpp v41, v136 row_newbcast:9 row_mask:0xf bank_mask:0xf
    v_mov_b32_dpp v42, v136 row_newbcast:10 row_mask:0xf bank_mask:0xf
    v_pk_mul_f16 v43, v140, v40 op_sel:[0,0] op_sel_hi:[1,0]
    v_pk_mul_f16 v44, v140, v41 op_sel:[0,0] op_sel_hi:[1,0]
    v_pk_mul_f16 v45, v140, v42 op_sel:[0,0] op_sel_hi:[1,0]
    v_pk_fma_f16 v144, v140, v40, v43 op_sel:[1,1,0] op_sel_hi:[0,1,1] neg_hi:[1,0,0]
    v_pk_fma_f16 v148, v140, v41, v44 op_sel:[1,1,0] op_sel_hi:[0,1,1] neg_hi:[1,0,0]
    v_pk_fma_f16 v152, v140, v42, v45 op_sel:[1,1,0] op_sel_hi:[0,1,1] neg_hi:[1,0,0]
    v_pk_mul_f32 v[34:35], v[192:193], v[92:93] op_sel:[1,0] op_sel_hi:[1,1]
    v_pk_mul_f32 v[32:33], v[192:193], v[92:93] op_sel:[0,0] op_sel_hi:[0,1]
    v_fract_f32 v34, v34
    v_cos_f32 v38, v35
    v_sin_f32 v39, v35
    v_exp_f32 v33, v33
    v_exp_f32 v32, v32
    v_cos_f32 v36, v34
    v_sin_f32_e64 v37, v34
    v_pk_mul_f32 v[38:39], v[38:39], v[32:33] op_sel:[0,1] op_sel_hi:[1,1]
    v_pk_mul_f32 v[36:37], v[36:37], v[32:33] op_sel:[0,0] op_sel_hi:[1,0]
    v_pk_mul_f32 v[34:35], v[38:39], v[194:195] op_sel:[0,0] op_sel_hi:[1,0]
    v_cvt_pk_f16_f32 v137, v36, -v37
    v_pk_fma_f32 v[34:35], v[38:39], v[194:195], v[34:35] op_sel:[1,1,0] op_sel_hi:[0,1,1] neg_lo:[1,0,0]
    v_cvt_pk_f16_f32 v141, v34, v35
    v_mov_b32_dpp v40, v137 row_newbcast:8 row_mask:0xf bank_mask:0xf
    v_mov_b32_dpp v41, v137 row_newbcast:9 row_mask:0xf bank_mask:0xf
    v_mov_b32_dpp v42, v137 row_newbcast:10 row_mask:0xf bank_mask:0xf
    v_pk_mul_f16 v43, v141, v40 op_sel:[0,0] op_sel_hi:[1,0]
    v_pk_mul_f16 v44, v141, v41 op_sel:[0,0] op_sel_hi:[1,0]
    v_pk_mul_f16 v45, v141, v42 op_sel:[0,0] op_sel_hi:[1,0]
    v_pk_fma_f16 v145, v141, v40, v43 op_sel:[1,1,0] op_sel_hi:[0,1,1] neg_hi:[1,0,0]
    v_pk_fma_f16 v149, v141, v41, v44 op_sel:[1,1,0] op_sel_hi:[0,1,1] neg_hi:[1,0,0]
    v_pk_fma_f16 v153, v141, v42, v45 op_sel:[1,1,0] op_sel_hi:[0,1,1] neg_hi:[1,0,0]
    v_pk_mul_f32 v[34:35], v[196:197], v[92:93] op_sel:[1,0] op_sel_hi:[1,1]
    v_pk_mul_f32 v[32:33], v[196:197], v[92:93] op_sel:[0,0] op_sel_hi:[0,1]
    v_fract_f32 v34, v34
    v_cos_f32 v38, v35
    v_sin_f32 v39, v35
    v_exp_f32 v33, v33
    v_exp_f32 v32, v32
    v_cos_f32 v36, v34
    v_sin_f32_e64 v37, v34
    v_pk_mul_f32 v[38:39], v[38:39], v[32:33] op_sel:[0,1] op_sel_hi:[1,1]
    v_pk_mul_f32 v[36:37], v[36:37], v[32:33] op_sel:[0,0] op_sel_hi:[1,0]
    v_pk_mul_f32 v[34:35], v[38:39], v[198:199] op_sel:[0,0] op_sel_hi:[1,0]
    v_cvt_pk_f16_f32 v138, v36, -v37
    v_pk_fma_f32 v[34:35], v[38:39], v[198:199], v[34:35] op_sel:[1,1,0] op_sel_hi:[0,1,1] neg_lo:[1,0,0]
    v_cvt_pk_f16_f32 v142, v34, v35
    v_mov_b32_dpp v40, v138 row_newbcast:8 row_mask:0xf bank_mask:0xf
    v_mov_b32_dpp v41, v138 row_newbcast:9 row_mask:0xf bank_mask:0xf
    v_mov_b32_dpp v42, v138 row_newbcast:10 row_mask:0xf bank_mask:0xf
    v_pk_mul_f16 v43, v142, v40 op_sel:[0,0] op_sel_hi:[1,0]
    v_pk_mul_f16 v44, v142, v41 op_sel:[0,0] op_sel_hi:[1,0]
    v_pk_mul_f16 v45, v142, v42 op_sel:[0,0] op_sel_hi:[1,0]
    v_pk_fma_f16 v146, v142, v40, v43 op_sel:[1,1,0] op_sel_hi:[0,1,1] neg_hi:[1,0,0]
    v_pk_fma_f16 v150, v142, v41, v44 op_sel:[1,1,0] op_sel_hi:[0,1,1] neg_hi:[1,0,0]
    v_pk_fma_f16 v154, v142, v42, v45 op_sel:[1,1,0] op_sel_hi:[0,1,1] neg_hi:[1,0,0]
    v_pk_mul_f32 v[34:35], v[200:201], v[92:93] op_sel:[1,0] op_sel_hi:[1,1]
    v_pk_mul_f32 v[32:33], v[200:201], v[92:93] op_sel:[0,0] op_sel_hi:[0,1]
    v_fract_f32 v34, v34
    v_cos_f32 v38, v35
    v_sin_f32 v39, v35
    v_exp_f32 v33, v33
    v_exp_f32 v32, v32
    v_cos_f32 v36, v34
    v_sin_f32_e64 v37, v34
    v_pk_mul_f32 v[38:39], v[38:39], v[32:33] op_sel:[0,1] op_sel_hi:[1,1]
    v_pk_mul_f32 v[36:37], v[36:37], v[32:33] op_sel:[0,0] op_sel_hi:[1,0]
    v_pk_mul_f32 v[34:35], v[38:39], v[202:203] op_sel:[0,0] op_sel_hi:[1,0]
    v_cvt_pk_f16_f32 v139, v36, -v37
    v_pk_fma_f32 v[34:35], v[38:39], v[202:203], v[34:35] op_sel:[1,1,0] op_sel_hi:[0,1,1] neg_lo:[1,0,0]
    v_cvt_pk_f16_f32 v143, v34, v35
    v_mov_b32_dpp v40, v139 row_newbcast:8 row_mask:0xf bank_mask:0xf
    v_mov_b32_dpp v41, v139 row_newbcast:9 row_mask:0xf bank_mask:0xf
    v_mov_b32_dpp v42, v139 row_newbcast:10 row_mask:0xf bank_mask:0xf
    v_pk_mul_f16 v43, v143, v40 op_sel:[0,0] op_sel_hi:[1,0]
    v_pk_mul_f16 v44, v143, v41 op_sel:[0,0] op_sel_hi:[1,0]
    v_pk_mul_f16 v45, v143, v42 op_sel:[0,0] op_sel_hi:[1,0]
    v_pk_fma_f16 v147, v143, v40, v43 op_sel:[1,1,0] op_sel_hi:[0,1,1] neg_hi:[1,0,0]
    v_pk_fma_f16 v151, v143, v41, v44 op_sel:[1,1,0] op_sel_hi:[0,1,1] neg_hi:[1,0,0]
    v_pk_fma_f16 v155, v143, v42, v45 op_sel:[1,1,0] op_sel_hi:[0,1,1] neg_hi:[1,0,0]
    v_mfma_f32_16x16x32_f16 v[156:159], v[136:139], v[140:143], v[156:159]
    v_mul_u32_u24 v6, 4608, v26
    v_lshl_add_u32 v6, v24, 4, v6
    v_mfma_f32_16x16x32_f16 v[160:163], v[136:139], v[144:147], v[160:163]
    v_mul_u32_u24 v10, 9216, v26
    v_lshrrev_b32 v27, 5, v24
    v_mfma_f32_16x16x32_f16 v[164:167], v[136:139], v[148:151], v[164:167]
    v_mul_u32_u24 v27, 1152, v27
    v_add_u32 v10, v10, v27
    v_mfma_f32_16x16x32_f16 v[168:171], v[136:139], v[152:155], v[168:171]
    v_and_b32 v27, 1, v24
    v_mul_u32_u24 v27, 640, v27
    v_add_u32 v10, v10, v27
    v_bfe_u32 v27, v24, 1, 4
    v_lshl_add_u32 v10, v27, 4, v10
    s_barrier
    ds_read_b64_tr_b16 v[64:65], v101 offset:0
    ds_read_b64_tr_b16 v[66:67], v101 offset:2816
    ds_read_b64_tr_b16 v[68:69], v101 offset:256
    ds_read_b64_tr_b16 v[70:71], v101 offset:3072
    ds_read_b64_tr_b16 v[72:73], v101 offset:512
    ds_read_b64_tr_b16 v[74:75], v101 offset:3328
    ds_read_b64_tr_b16 v[76:77], v103 offset:0
    ds_read_b64_tr_b16 v[78:79], v103 offset:512
    ds_read_b64_tr_b16 v[80:81], v103 offset:2048
    ds_read_b64_tr_b16 v[82:83], v103 offset:2560
    ds_read_b64_tr_b16 v[84:85], v103 offset:64
    ds_read_b64_tr_b16 v[86:87], v103 offset:576
    ds_read_b64_tr_b16 v[88:89], v103 offset:2112
    ds_read_b64_tr_b16 v[90:91], v103 offset:2624
    v_pk_mul_f32 v[34:35], v[204:205], v[92:93] op_sel:[1,0] op_sel_hi:[1,1]
    v_pk_mul_f32 v[32:33], v[204:205], v[92:93] op_sel:[0,0] op_sel_hi:[0,1]
    v_fract_f32 v34, v34
    v_cos_f32 v38, v35
    v_sin_f32 v39, v35
    v_exp_f32 v33, v33
    v_exp_f32 v32, v32
    v_cos_f32 v36, v34
    v_sin_f32_e64 v37, v34
    v_pk_mul_f32 v[38:39], v[38:39], v[32:33] op_sel:[0,1] op_sel_hi:[1,1]
    s_waitcnt lgkmcnt(0)
    buffer_store_dwordx4 v[64:67], v102, s[4:7], s97 offen sc1
    s_add_u32 s97, s97, 262144
    v_pk_mul_f32 v[36:37], v[36:37], v[32:33] op_sel:[0,0] op_sel_hi:[1,0]
    v_pk_mul_f32 v[34:35], v[38:39], v[206:207] op_sel:[0,0] op_sel_hi:[1,0]
    v_cvt_pk_f16_f32 v136, v36, -v37
    v_pk_fma_f32 v[34:35], v[38:39], v[206:207], v[34:35] op_sel:[1,1,0] op_sel_hi:[0,1,1] neg_lo:[1,0,0]
    v_cvt_pk_f16_f32 v140, v34, v35
    v_mov_b32_dpp v40, v136 row_newbcast:8 row_mask:0xf bank_mask:0xf
    v_mov_b32_dpp v41, v136 row_newbcast:9 row_mask:0xf bank_mask:0xf
    v_mov_b32_dpp v42, v136 row_newbcast:10 row_mask:0xf bank_mask:0xf
    v_pk_mul_f16 v43, v140, v40 op_sel:[0,0] op_sel_hi:[1,0]
    v_pk_mul_f16 v44, v140, v41 op_sel:[0,0] op_sel_hi:[1,0]
    buffer_store_dwordx4 v[68:71], v102, s[4:7], s97 offen sc1
    s_add_u32 s97, s97, 262144
    v_pk_mul_f16 v45, v140, v42 op_sel:[0,0] op_sel_hi:[1,0]
    v_pk_fma_f16 v144, v140, v40, v43 op_sel:[1,1,0] op_sel_hi:[0,1,1] neg_hi:[1,0,0]
    v_pk_fma_f16 v148, v140, v41, v44 op_sel:[1,1,0] op_sel_hi:[0,1,1] neg_hi:[1,0,0]
    v_pk_fma_f16 v152, v140, v42, v45 op_sel:[1,1,0] op_sel_hi:[0,1,1] neg_hi:[1,0,0]
    v_pk_mul_f32 v[34:35], v[208:209], v[92:93] op_sel:[1,0] op_sel_hi:[1,1]
    v_pk_mul_f32 v[32:33], v[208:209], v[92:93] op_sel:[0,0] op_sel_hi:[0,1]
    v_fract_f32 v34, v34
    v_cos_f32 v38, v35
    v_sin_f32 v39, v35
    v_exp_f32 v33, v33
    s_cmp_eq_u32 s3, 3
    s_cselect_b32 s97, 2146435072, s97
    buffer_store_dwordx4 v[72:75], v102, s[4:7], s97 offen sc1
    v_exp_f32 v32, v32
    v_cos_f32 v36, v34
    v_sin_f32_e64 v37, v34
    v_pk_mul_f32 v[38:39], v[38:39], v[32:33] op_sel:[0,1] op_sel_hi:[1,1]
    v_pk_mul_f32 v[36:37], v[36:37], v[32:33] op_sel:[0,0] op_sel_hi:[1,0]
    v_pk_mul_f32 v[34:35], v[38:39], v[210:211] op_sel:[0,0] op_sel_hi:[1,0]
    v_cvt_pk_f16_f32 v137, v36, -v37
    v_pk_fma_f32 v[34:35], v[38:39], v[210:211], v[34:35] op_sel:[1,1,0] op_sel_hi:[0,1,1] neg_lo:[1,0,0]
    v_cvt_pk_f16_f32 v141, v34, v35
    v_mov_b32_dpp v40, v137 row_newbcast:8 row_mask:0xf bank_mask:0xf
    buffer_store_dwordx4 v[76:79], v2, s[4:7], s99 offen offset:0 sc1
    v_mov_b32_dpp v41, v137 row_newbcast:9 row_mask:0xf bank_mask:0xf
    v_mov_b32_dpp v42, v137 row_newbcast:10 row_mask:0xf bank_mask:0xf
    v_pk_mul_f16 v43, v141, v40 op_sel:[0,0] op_sel_hi:[1,0]
    v_pk_mul_f16 v44, v141, v41 op_sel:[0,0] op_sel_hi:[1,0]
    v_pk_mul_f16 v45, v141, v42 op_sel:[0,0] op_sel_hi:[1,0]
    v_pk_fma_f16 v145, v141, v40, v43 op_sel:[1,1,0] op_sel_hi:[0,1,1] neg_hi:[1,0,0]
    v_pk_fma_f16 v149, v141, v41, v44 op_sel:[1,1,0] op_sel_hi:[0,1,1] neg_hi:[1,0,0]
    v_pk_fma_f16 v153, v141, v42, v45 op_sel:[1,1,0] op_sel_hi:[0,1,1] neg_hi:[1,0,0]
    v_pk_mul_f32 v[34:35], v[212:213], v[92:93] op_sel:[1,0] op_sel_hi:[1,1]
    v_pk_mul_f32 v[32:33], v[212:213], v[92:93] op_sel:[0,0] op_sel_hi:[0,1]
    buffer_store_dwordx4 v[80:83], v2, s[4:7], s99 offen offset:1024 sc1
    v_fract_f32 v34, v34
    v_cos_f32 v38, v35
    v_sin_f32 v39, v35
    v_exp_f32 v33, v33
    v_exp_f32 v32, v32
    v_cos_f32 v36, v34
    v_sin_f32_e64 v37, v34
    v_pk_mul_f32 v[38:39], v[38:39], v[32:33] op_sel:[0,1] op_sel_hi:[1,1]
    v_pk_mul_f32 v[36:37], v[36:37], v[32:33] op_sel:[0,0] op_sel_hi:[1,0]
    v_pk_mul_f32 v[34:35], v[38:39], v[214:215] op_sel:[0,0] op_sel_hi:[1,0]
    buffer_store_dwordx4 v[84:87], v23, s[4:7], s99 offen offset:0 sc1
    v_cvt_pk_f16_f32 v138, v36, -v37
    v_pk_fma_f32 v[34:35], v[38:39], v[214:215], v[34:35] op_sel:[1,1,0] op_sel_hi:[0,1,1] neg_lo:[1,0,0]
    v_cvt_pk_f16_f32 v142, v34, v35
    v_mov_b32_dpp v40, v138 row_newbcast:8 row_mask:0xf bank_mask:0xf
    v_mov_b32_dpp v41, v138 row_newbcast:9 row_mask:0xf bank_mask:0xf
    v_mov_b32_dpp v42, v138 row_newbcast:10 row_mask:0xf bank_mask:0xf
    v_pk_mul_f16 v43, v142, v40 op_sel:[0,0] op_sel_hi:[1,0]
    v_pk_mul_f16 v44, v142, v41 op_sel:[0,0] op_sel_hi:[1,0]
    v_pk_mul_f16 v45, v142, v42 op_sel:[0,0] op_sel_hi:[1,0]
    v_pk_fma_f16 v146, v142, v40, v43 op_sel:[1,1,0] op_sel_hi:[0,1,1] neg_hi:[1,0,0]
    buffer_store_dwordx4 v[88:91], v23, s[4:7], s99 offen offset:1024 sc1
    v_pk_fma_f16 v150, v142, v41, v44 op_sel:[1,1,0] op_sel_hi:[0,1,1] neg_hi:[1,0,0]
    v_pk_fma_f16 v154, v142, v42, v45 op_sel:[1,1,0] op_sel_hi:[0,1,1] neg_hi:[1,0,0]
    v_pk_mul_f32 v[34:35], v[216:217], v[92:93] op_sel:[1,0] op_sel_hi:[1,1]
    v_pk_mul_f32 v[32:33], v[216:217], v[92:93] op_sel:[0,0] op_sel_hi:[0,1]
    v_fract_f32 v34, v34
    v_cos_f32 v38, v35
    v_sin_f32 v39, v35
    v_exp_f32 v33, v33
    v_exp_f32 v32, v32
    v_cos_f32 v36, v34
    v_sin_f32_e64 v37, v34
    v_pk_mul_f32 v[38:39], v[38:39], v[32:33] op_sel:[0,1] op_sel_hi:[1,1]
    v_pk_mul_f32 v[36:37], v[36:37], v[32:33] op_sel:[0,0] op_sel_hi:[1,0]
    v_pk_mul_f32 v[34:35], v[38:39], v[218:219] op_sel:[0,0] op_sel_hi:[1,0]
    v_cvt_pk_f16_f32 v139, v36, -v37
    v_pk_fma_f32 v[34:35], v[38:39], v[218:219], v[34:35] op_sel:[1,1,0] op_sel_hi:[0,1,1] neg_lo:[1,0,0]
    v_cvt_pk_f16_f32 v143, v34, v35
    v_mov_b32_dpp v40, v139 row_newbcast:8 row_mask:0xf bank_mask:0xf
    v_mov_b32_dpp v41, v139 row_newbcast:9 row_mask:0xf bank_mask:0xf
    v_mov_b32_dpp v42, v139 row_newbcast:10 row_mask:0xf bank_mask:0xf
    v_pk_mul_f16 v43, v143, v40 op_sel:[0,0] op_sel_hi:[1,0]
    v_pk_mul_f16 v44, v143, v41 op_sel:[0,0] op_sel_hi:[1,0]
    v_pk_mul_f16 v45, v143, v42 op_sel:[0,0] op_sel_hi:[1,0]
    v_pk_fma_f16 v147, v143, v40, v43 op_sel:[1,1,0] op_sel_hi:[0,1,1] neg_hi:[1,0,0]
    v_pk_fma_f16 v151, v143, v41, v44 op_sel:[1,1,0] op_sel_hi:[0,1,1] neg_hi:[1,0,0]
    v_pk_fma_f16 v155, v143, v42, v45 op_sel:[1,1,0] op_sel_hi:[0,1,1] neg_hi:[1,0,0]
    v_mfma_f32_16x16x32_f16 v[156:159], v[136:139], v[140:143], v[156:159]
    v_add_u32 v10, 131072, v10
    v_lshlrev_b32 v26, 4, v26
    v_mfma_f32_16x16x32_f16 v[160:163], v[136:139], v[144:147], v[160:163]
    v_lshrrev_b32 v12, v26, s92
    v_lshlrev_b32 v12, 16, v12
    v_mfma_f32_16x16x32_f16 v[164:167], v[136:139], v[148:151], v[164:167]
    v_and_b32 v24, 14, v1
    v_lshl_add_u32 v24, v98, 3, v24
    v_mfma_f32_16x16x32_f16 v[168:171], v[136:139], v[152:155], v[168:171]
    v_sub_u32 v24, 38, v24
    v_and_b32 v26, 1, v1
    v_xor_b32 v26, 1, v26
    v_mul_u32_u24 v26, 4160, v26
    v_lshl_add_u32 v7, v24, 1, v26
    s_and_b32 s37, s2, 7
    s_lshl_b32 s37, s37, 8
    s_add_u32 s37, s37, 16220160
    v_mov_b32 v20, 0
    buffer_atomic_add v20, v17, s[4:7], s37 offen sc0 sc1
    v_pk_mul_f32 v[34:35], v[220:221], v[92:93] op_sel:[1,0] op_sel_hi:[1,1]
    v_pk_mul_f32 v[32:33], v[220:221], v[92:93] op_sel:[0,0] op_sel_hi:[0,1]
    v_fract_f32 v34, v34
    v_cos_f32 v38, v35
    v_sin_f32 v39, v35
    v_exp_f32 v33, v33
    v_exp_f32 v32, v32
    v_cos_f32 v36, v34
    v_sin_f32_e64 v37, v34
    v_pk_mul_f32 v[38:39], v[38:39], v[32:33] op_sel:[0,1] op_sel_hi:[1,1]
    v_pk_mul_f32 v[36:37], v[36:37], v[32:33] op_sel:[0,0] op_sel_hi:[1,0]
    v_pk_mul_f32 v[34:35], v[38:39], v[222:223] op_sel:[0,0] op_sel_hi:[1,0]
    v_cvt_pk_f16_f32 v136, v36, -v37
    v_pk_fma_f32 v[34:35], v[38:39], v[222:223], v[34:35] op_sel:[1,1,0] op_sel_hi:[0,1,1] neg_lo:[1,0,0]
    v_cvt_pk_f16_f32 v140, v34, v35
    v_mov_b32_dpp v40, v136 row_newbcast:8 row_mask:0xf bank_mask:0xf
    v_mov_b32_dpp v41, v136 row_newbcast:9 row_mask:0xf bank_mask:0xf
    v_mov_b32_dpp v42, v136 row_newbcast:10 row_mask:0xf bank_mask:0xf
    v_pk_mul_f16 v43, v140, v40 op_sel:[0,0] op_sel_hi:[1,0]
    v_pk_mul_f16 v44, v140, v41 op_sel:[0,0] op_sel_hi:[1,0]
    v_pk_mul_f16 v45, v140, v42 op_sel:[0,0] op_sel_hi:[1,0]
    v_pk_fma_f16 v144, v140, v40, v43 op_sel:[1,1,0] op_sel_hi:[0,1,1] neg_hi:[1,0,0]
    v_pk_fma_f16 v148, v140, v41, v44 op_sel:[1,1,0] op_sel_hi:[0,1,1] neg_hi:[1,0,0]
    v_pk_fma_f16 v152, v140, v42, v45 op_sel:[1,1,0] op_sel_hi:[0,1,1] neg_hi:[1,0,0]
    v_pk_mul_f32 v[34:35], v[224:225], v[92:93] op_sel:[1,0] op_sel_hi:[1,1]
    v_pk_mul_f32 v[32:33], v[224:225], v[92:93] op_sel:[0,0] op_sel_hi:[0,1]
    v_fract_f32 v34, v34
    v_cos_f32 v38, v35
    v_sin_f32 v39, v35
    v_exp_f32 v33, v33
    v_exp_f32 v32, v32
    v_cos_f32 v36, v34
    v_sin_f32_e64 v37, v34
    v_pk_mul_f32 v[38:39], v[38:39], v[32:33] op_sel:[0,1] op_sel_hi:[1,1]
    v_pk_mul_f32 v[36:37], v[36:37], v[32:33] op_sel:[0,0] op_sel_hi:[1,0]
    v_pk_mul_f32 v[34:35], v[38:39], v[226:227] op_sel:[0,0] op_sel_hi:[1,0]
    v_cvt_pk_f16_f32 v137, v36, -v37
    v_pk_fma_f32 v[34:35], v[38:39], v[226:227], v[34:35] op_sel:[1,1,0] op_sel_hi:[0,1,1] neg_lo:[1,0,0]
    v_cvt_pk_f16_f32 v141, v34, v35
    v_mov_b32_dpp v40, v137 row_newbcast:8 row_mask:0xf bank_mask:0xf
    v_mov_b32_dpp v41, v137 row_newbcast:9 row_mask:0xf bank_mask:0xf
    v_mov_b32_dpp v42, v137 row_newbcast:10 row_mask:0xf bank_mask:0xf
    v_pk_mul_f16 v43, v141, v40 op_sel:[0,0] op_sel_hi:[1,0]
    v_pk_mul_f16 v44, v141, v41 op_sel:[0,0] op_sel_hi:[1,0]
    v_pk_mul_f16 v45, v141, v42 op_sel:[0,0] op_sel_hi:[1,0]
    v_pk_fma_f16 v145, v141, v40, v43 op_sel:[1,1,0] op_sel_hi:[0,1,1] neg_hi:[1,0,0]
    v_pk_fma_f16 v149, v141, v41, v44 op_sel:[1,1,0] op_sel_hi:[0,1,1] neg_hi:[1,0,0]
    v_pk_fma_f16 v153, v141, v42, v45 op_sel:[1,1,0] op_sel_hi:[0,1,1] neg_hi:[1,0,0]
    v_pk_mul_f32 v[34:35], v[228:229], v[92:93] op_sel:[1,0] op_sel_hi:[1,1]
    v_pk_mul_f32 v[32:33], v[228:229], v[92:93] op_sel:[0,0] op_sel_hi:[0,1]
    v_fract_f32 v34, v34
    v_cos_f32 v38, v35
    v_sin_f32 v39, v35
    v_exp_f32 v33, v33
    v_exp_f32 v32, v32
    v_cos_f32 v36, v34
    v_sin_f32_e64 v37, v34
    v_pk_mul_f32 v[38:39], v[38:39], v[32:33] op_sel:[0,1] op_sel_hi:[1,1]
    v_pk_mul_f32 v[36:37], v[36:37], v[32:33] op_sel:[0,0] op_sel_hi:[1,0]
    v_pk_mul_f32 v[34:35], v[38:39], v[230:231] op_sel:[0,0] op_sel_hi:[1,0]
    v_cvt_pk_f16_f32 v138, v36, -v37
    v_pk_fma_f32 v[34:35], v[38:39], v[230:231], v[34:35] op_sel:[1,1,0] op_sel_hi:[0,1,1] neg_lo:[1,0,0]
    v_cvt_pk_f16_f32 v142, v34, v35
    v_mov_b32_dpp v40, v138 row_newbcast:8 row_mask:0xf bank_mask:0xf
    v_mov_b32_dpp v41, v138 row_newbcast:9 row_mask:0xf bank_mask:0xf
    v_mov_b32_dpp v42, v138 row_newbcast:10 row_mask:0xf bank_mask:0xf
    v_pk_mul_f16 v43, v142, v40 op_sel:[0,0] op_sel_hi:[1,0]
    v_pk_mul_f16 v44, v142, v41 op_sel:[0,0] op_sel_hi:[1,0]
    v_pk_mul_f16 v45, v142, v42 op_sel:[0,0] op_sel_hi:[1,0]
    v_pk_fma_f16 v146, v142, v40, v43 op_sel:[1,1,0] op_sel_hi:[0,1,1] neg_hi:[1,0,0]
    v_pk_fma_f16 v150, v142, v41, v44 op_sel:[1,1,0] op_sel_hi:[0,1,1] neg_hi:[1,0,0]
    v_pk_fma_f16 v154, v142, v42, v45 op_sel:[1,1,0] op_sel_hi:[0,1,1] neg_hi:[1,0,0]
    v_pk_mul_f32 v[34:35], v[232:233], v[92:93] op_sel:[1,0] op_sel_hi:[1,1]
    v_pk_mul_f32 v[32:33], v[232:233], v[92:93] op_sel:[0,0] op_sel_hi:[0,1]
    v_fract_f32 v34, v34
    v_cos_f32 v38, v35
    v_sin_f32 v39, v35
    v_exp_f32 v33, v33
    v_exp_f32 v32, v32
    v_cos_f32 v36, v34
    v_sin_f32_e64 v37, v34
    v_pk_mul_f32 v[38:39], v[38:39], v[32:33] op_sel:[0,1] op_sel_hi:[1,1]
    v_pk_mul_f32 v[36:37], v[36:37], v[32:33] op_sel:[0,0] op_sel_hi:[1,0]
    v_pk_mul_f32 v[34:35], v[38:39], v[234:235] op_sel:[0,0] op_sel_hi:[1,0]
    v_cvt_pk_f16_f32 v139, v36, -v37
    v_pk_fma_f32 v[34:35], v[38:39], v[234:235], v[34:35] op_sel:[1,1,0] op_sel_hi:[0,1,1] neg_lo:[1,0,0]
    v_cvt_pk_f16_f32 v143, v34, v35
    v_mov_b32_dpp v40, v139 row_newbcast:8 row_mask:0xf bank_mask:0xf
    v_mov_b32_dpp v41, v139 row_newbcast:9 row_mask:0xf bank_mask:0xf
    v_mov_b32_dpp v42, v139 row_newbcast:10 row_mask:0xf bank_mask:0xf
    v_pk_mul_f16 v43, v143, v40 op_sel:[0,0] op_sel_hi:[1,0]
    v_pk_mul_f16 v44, v143, v41 op_sel:[0,0] op_sel_hi:[1,0]
    v_pk_mul_f16 v45, v143, v42 op_sel:[0,0] op_sel_hi:[1,0]
    v_pk_fma_f16 v147, v143, v40, v43 op_sel:[1,1,0] op_sel_hi:[0,1,1] neg_hi:[1,0,0]
    v_pk_fma_f16 v151, v143, v41, v44 op_sel:[1,1,0] op_sel_hi:[0,1,1] neg_hi:[1,0,0]
    v_pk_fma_f16 v155, v143, v42, v45 op_sel:[1,1,0] op_sel_hi:[0,1,1] neg_hi:[1,0,0]
    v_mfma_f32_16x16x32_f16 v[156:159], v[136:139], v[140:143], v[156:159]
    s_lshl_b32 s32, s89, 6
    s_mul_i32 s33, s90, 8320
    v_mfma_f32_16x16x32_f16 v[160:163], v[136:139], v[144:147], v[160:163]
    s_sub_u32 s33, s33, s32
    s_add_u32 s33, s33, 64
    v_mfma_f32_16x16x32_f16 v[164:167], v[136:139], v[148:151], v[164:167]
    v_add_u32 v7, s33, v7
    v_lshlrev_b32 v24, 5, v97
    v_mfma_f32_16x16x32_f16 v[168:171], v[136:139], v[152:155], v[168:171]
    v_lshlrev_b32 v26, 4, v98
    v_sub_u32 v8, v24, v26
    s_mul_i32 s33, s90, 4608
    s_add_u32 s33, s33, 16784
    s_sub_u32 s33, s33, s32
    v_add_u32 v32, s40, v2
    s_lshl_b32 s38, s90, 13
    s_lshl_b32 s39, s89, 11
    s_add_u32 s38, s38, s39
    v_add_u32 v33, s38, v2
    ds_write_b128 v32, v[156:159] offset:47616
    ds_write_b128 v32, v[160:163] offset:48640
    ds_write_b128 v32, v[164:167] offset:49664
    ds_write_b128 v32, v[168:171] offset:50688
    v_add_u32 v8, s33, v8
    s_mul_i32 s33, s3, 4608
    s_add_u32 s33, s33, 131072
    v_lshrrev_b32 v24, 5, v1
    v_lshlrev_b32 v26, 7, v24
    v_add3_u32 v9, s33, v26, v2
    s_and_b32 s31, s2, 7
    s_lshr_b32 s32, s2, 3
    s_and_b32 s33, s31, 3
    s_mul_i32 s33, s33, 31
    s_add_u32 s33, s33, s32
    s_cmp_lt_u32 s33, 121
    s_cselect_b32 s30, 1, 0
    s_cmp_lt_u32 s32, 31
    s_cselect_b32 s30, s30, 0
    s_mul_i32 s20, s33, 373
    s_waitcnt vmcnt(0)
    v_cmp_gt_u32 vcc, 16, v20
    s_nop 0
    s_and_b64 vcc, vcc, s[54:55]
    s_cbranch_scc1 mk_ps4
mk_po5:
    s_waitcnt lgkmcnt(0)
    s_barrier
    ds_read_b128 v[140:143], v33 offset:47616
    ds_read_b128 v[144:147], v33 offset:51712
    ds_read_b128 v[148:151], v33 offset:48640
    ds_read_b128 v[152:155], v33 offset:52736
    s_add_u32 s38, s26, 16187392
    buffer_atomic_add v21, v17, s[4:7], s38 offen sc1
    s_lshl_b32 s39, s3, 11
    s_add_u32 m0, s39, 151552
    s_add_u32 s39, s39, 15728640
    buffer_load_dwordx4 v2, s[4:7], s39 offen offset:0 sc1 lds
    buffer_load_dwordx4 v2, s[4:7], s39 offen offset:1024 sc1 lds
    buffer_load_dwordx4 v[244:247], v4, s[4:7], 0 offen sc1
    s_lshr_b32 s20, s20, 12
    s_mul_i32 s34, s20, 11
    s_sub_u32 s21, s33, s34
    s_lshr_b32 s34, s31, 2
    s_mul_i32 s34, s34, 11
    s_add_u32 s21, s21, s34
    s_lshl_b32 s21, s21, 2
    s_add_u32 s21, s21, s3
    s_sub_u32 s38, s89, 1
    s_and_b32 s39, s38, 0x10000
    s_waitcnt lgkmcnt(0)
    v_pk_add_f32 v[140:141], v[140:141], v[144:145]
    v_pk_add_f32 v[142:143], v[142:143], v[146:147]
    v_pk_add_f32 v[148:149], v[148:149], v[152:153]
    v_pk_add_f32 v[150:151], v[150:151], v[154:155]
    v_mul_f32 v140, v140, v104
    v_mul_f32 v141, v141, v104
    v_mul_f32 v142, v142, v104
    v_mul_f32 v143, v143, v104
    v_mul_f32 v148, v148, v104
    v_mul_f32 v149, v149, v104
    v_mul_f32 v150, v150, v104
    v_mul_f32 v151, v151, v104
    v_cvt_pk_bf16_f32 v140, v140, v141
    v_cvt_pk_bf16_f32 v142, v142, v143
    v_cvt_pk_bf16_f32 v148, v148, v149
    v_cvt_pk_bf16_f32 v150, v150, v151
    s_mov_b32 exec_hi, 0xffff0000
    ds_write_b16 v112, v140 offset:8704
    ds_write_b16 v116, v148 offset:8704
    s_mov_b32 exec_hi, s39
    ds_write_b16 v114, v142 offset:8704
    s_mov_b32 exec_hi, 0
    ds_write_b16 v118, v150 offset:8704
    s_mov_b32 exec_hi, 0xffff0000
    s_mov_b32 exec_lo, s38
    ds_write_b16_d16_hi v113, v140 offset:8704
    ds_write_b16_d16_hi v117, v148 offset:8704
    s_mov_b32 exec_hi, -1
    ds_write_b16_d16_hi v115, v142 offset:8704
    ds_write_b16_d16_hi v119, v150 offset:8704
    s_mov_b32 exec_lo, -1
    s_lshl_b32 s22, s31, 2
    s_and_b32 s34, s32, 3
    s_add_u32 s22, s22, s34
    s_lshr_b32 s23, s32, 2
    s_lshl_b32 s41, s3, 12
    s_lshl_b32 s28, s20, 11
    s_lshr_b32 s34, s31, 2
    s_lshl_b32 s34, s34, 7
    s_add_u32 s28, s28, s34
    s_cmp_eq_u32 s30, 0
    s_cselect_b32 s28, 1073217536, s28
    s_waitcnt lgkmcnt(0)
    s_barrier
    ds_read_u16 v172, v120 offset:8704
    ds_read_u16 v173, v121 offset:8704
    ds_read_u16 v174, v122 offset:8704
    ds_read_u16 v175, v123 offset:8704
    ds_read_u16 v176, v124 offset:8704
    ds_read_u16 v177, v125 offset:8704
    ds_read_u16 v178, v126 offset:8704
    ds_read_u16 v179, v127 offset:8704
    ds_read_u16 v180, v128 offset:8704
    ds_read_u16 v188, v120 offset:12032
    ds_read_u16 v189, v121 offset:12032
    ds_read_u16 v190, v122 offset:12032
    ds_read_u16 v191, v123 offset:12032
    ds_read_u16 v192, v124 offset:12032
    ds_read_u16 v193, v125 offset:12032
    ds_read_u16 v194, v126 offset:12032
    ds_read_u16 v195, v127 offset:12032
    ds_read_u16 v196, v128 offset:12032
    s_mul_i32 s29, s22, 43
    s_lshr_b32 s29, s29, 7
    s_lshl_b32 s29, s29, 11
    s_lshl_b32 s34, s23, 8
    s_add_u32 s29, s29, s34
    s_lshl_b32 s36, s21, 15
    s_add_u32 s36, s36, 16777216
    s_cmp_ge_u32 s21, 86
    s_cselect_b32 s36, 2146435072, s36
    s_cmp_eq_u32 s30, 0
    s_cselect_b32 s36, 2146435072, s36
    s_and_b32 s33, s31, 3
    s_mul_i32 s33, s33, 3
    s_lshr_b32 s34, s31, 2
    s_add_u32 s33, s33, s34
    s_mul_i32 s34, s32, 3
    s_sub_u32 s34, s34, 82
    s_cmp_eq_u32 s32, 31
    s_cselect_b32 s33, s33, s34
    s_cselect_b32 s44, 0, s31
    s_mov_b32 s34, 32768
    s_cmp_eq_u32 s44, 7
    s_cselect_b32 s44, 2146435072, s34
    s_cmp_eq_u32 s30, 0
    s_cselect_b32 s20, s33, s20
    s_cselect_b32 s44, s44, 0
    v_cmp_eq_u32 vcc, 255, v0
    s_waitcnt lgkmcnt(9)
    s_nop 0
    v_cndmask_b32 v180, v180, v132, vcc
    v_lshl_or_b32 v204, v173, 16, v172
    v_lshl_or_b32 v205, v175, 16, v174
    v_lshl_or_b32 v206, v177, 16, v176
    v_lshl_or_b32 v207, v179, 16, v178
    ds_write_b128 v3, v[204:207] offset:0
    v_lshl_or_b32 v208, v174, 16, v173
    v_lshl_or_b32 v209, v176, 16, v175
    v_lshl_or_b32 v210, v178, 16, v177
    v_lshl_or_b32 v211, v180, 16, v179
    ds_write_b128 v3, v[208:211] offset:4160
    s_waitcnt lgkmcnt(2)
    v_cndmask_b32 v196, v196, v132, vcc
    v_lshl_or_b32 v212, v189, 16, v188
    v_lshl_or_b32 v213, v191, 16, v190
    v_lshl_or_b32 v214, v193, 16, v192
    v_lshl_or_b32 v215, v195, 16, v194
    ds_write_b128 v3, v[212:215] offset:8320
    v_lshl_or_b32 v216, v190, 16, v189
    v_lshl_or_b32 v217, v192, 16, v191
    v_lshl_or_b32 v218, v194, 16, v193
    v_lshl_or_b32 v219, v196, 16, v195
    ds_write_b128 v3, v[216:219] offset:12480
    v_add_u32 v14, 1024, v7
    v_add_u32 v15, 2048, v7
    v_add_u32 v16, 3072, v7
    v_and_b32 v11, 0xfe0, v5
    v_lshlrev_b32 v11, 1, v11
    v_add_u32 v11, 151552, v11
    s_waitcnt vmcnt(1)
    ds_read_b128 v[248:251], v11 offset:0
    ds_read_b128 v[252:255], v11 offset:16
    ds_read_b128 v[84:87], v11 offset:32
    ds_read_b128 v[88:91], v11 offset:48
    s_waitcnt vmcnt(0)
    v_lshlrev_b32 v92, 16, v244
    v_and_b32 v93, 0xffff0000, v244
    v_lshlrev_b32 v94, 16, v245
    v_and_b32 v95, 0xffff0000, v245
    v_lshlrev_b32 v96, 16, v246
    v_and_b32 v97, 0xffff0000, v246
    v_lshlrev_b32 v98, 16, v247
    v_and_b32 v99, 0xffff0000, v247
    s_waitcnt lgkmcnt(0)
    v_pk_fma_f32 v[100:101], v[92:93], v[250:251], v[248:249]
    v_pk_fma_f32 v[102:103], v[94:95], v[254:255], v[252:253]
    v_pk_fma_f32 v[104:105], v[96:97], v[86:87], v[84:85]
    v_pk_fma_f32 v[106:107], v[98:99], v[90:91], v[88:89]
    v_cvt_pk_bf16_f32 v108, v100, v101
    v_cvt_pk_bf16_f32 v109, v102, v103
    v_cvt_pk_bf16_f32 v110, v104, v105
    v_cvt_pk_bf16_f32 v111, v106, v107
    ds_write_b128 v6, v[108:111] offset:17152
    s_lshr_b32 s31, s41, 1
    s_add_u32 m0, s31, 151552
    s_add_u32 s31, s31, 15736832
    buffer_load_dwordx4 v2, s[4:7], s31 offen offset:0 sc1 lds
    buffer_load_dwordx4 v2, s[4:7], s31 offen offset:1024 sc1 lds
    s_mov_b32 s31, 1048576
    buffer_load_dwordx4 v[244:247], v4, s[4:7], s31 offen sc1
    s_waitcnt lgkmcnt(0)
    s_barrier
    ds_read2_b32 v[208:209], v16 offset0:224 offset1:225
    ds_read2_b32 v[210:211], v16 offset0:226 offset1:227
    ds_read2_b32 v[212:213], v16 offset0:192 offset1:193
    ds_read2_b32 v[214:215], v16 offset0:194 offset1:195
    ds_read2_b32 v[216:217], v16 offset0:160 offset1:161
    ds_read2_b32 v[218:219], v16 offset0:162 offset1:163
    ds_read2_b32 v[220:221], v16 offset0:128 offset1:129
    ds_read2_b32 v[222:223], v16 offset0:130 offset1:131
    ds_read2_b32 v[224:225], v16 offset0:96 offset1:97
    ds_read2_b32 v[226:227], v16 offset0:98 offset1:99
    ds_read2_b32 v[228:229], v16 offset0:64 offset1:65
    ds_read2_b32 v[230:231], v16 offset0:66 offset1:67
    ds_read_b128 v[188:191], v8 offset:1920
    ds_read_b128 v[172:175], v8 offset:1408
    ds_read_b128 v[156:159], v8 offset:896
    ds_read_b128 v[140:143], v8 offset:384
    ds_read_b128 v[184:187], v8 offset:1792
    ds_read_b128 v[168:171], v8 offset:1280
    ds_read_b128 v[152:155], v8 offset:768
    ds_read_b128 v[136:139], v8 offset:256
    ds_read_b128 v[180:183], v8 offset:1664
    ds_read_b128 v[164:167], v8 offset:1152
    ds_read_b128 v[148:151], v8 offset:640
    ds_read_b128 v[132:135], v8 offset:128
    ds_read_b128 v[176:179], v8 offset:1536
    ds_read_b128 v[160:163], v8 offset:1024
    ds_read_b128 v[144:147], v8 offset:512
    ds_read_b128 v[128:131], v8 offset:0
    v_fma_f32 v100, v12, v100, v92
    v_fma_f32 v101, v12, v101, v93
    v_fma_f32 v102, v12, v102, v94
    v_fma_f32 v103, v12, v103, v95
    v_fma_f32 v104, v12, v104, v96
    v_fma_f32 v105, v12, v105, v97
    v_fma_f32 v106, v12, v106, v98
    v_fma_f32 v107, v12, v107, v99
    s_add_u32 s37, s27, 16187392
    v_mov_b32 v20, 0
    buffer_atomic_add v20, v19, s[4:7], s37 offen sc0 sc1
    s_waitcnt lgkmcnt(14)
    v_mfma_f32_16x16x32_bf16 v[124:127], v[208:211], v[188:191], 0
    ds_read2_b32 v[232:233], v16 offset0:32 offset1:33
    ds_read2_b32 v[234:235], v16 offset0:34 offset1:35
    v_mfma_f32_16x16x32_bf16 v[120:123], v[208:211], v[172:175], 0
    s_waitcnt lgkmcnt(14)
    v_mfma_f32_16x16x32_bf16 v[116:119], v[208:211], v[156:159], 0
    v_mfma_f32_16x16x32_bf16 v[112:115], v[208:211], v[140:143], 0
    s_waitcnt lgkmcnt(12)
    v_mfma_f32_16x16x32_bf16 v[124:127], v[212:215], v[184:187], v[124:127]
    ds_read2_b32 v[208:209], v16 offset0:0 offset1:1
    ds_read2_b32 v[210:211], v16 offset0:2 offset1:3
    v_mfma_f32_16x16x32_bf16 v[120:123], v[212:215], v[168:171], v[120:123]
    s_waitcnt lgkmcnt(12)
    v_mfma_f32_16x16x32_bf16 v[116:119], v[212:215], v[152:155], v[116:119]
    v_mfma_f32_16x16x32_bf16 v[112:115], v[212:215], v[136:139], v[112:115]
    s_waitcnt lgkmcnt(10)
    v_mfma_f32_16x16x32_bf16 v[124:127], v[216:219], v[180:183], v[124:127]
    ds_read2_b32 v[212:213], v15 offset0:224 offset1:225
    ds_read2_b32 v[214:215], v15 offset0:226 offset1:227
    v_mfma_f32_16x16x32_bf16 v[120:123], v[216:219], v[164:167], v[120:123]
    s_waitcnt lgkmcnt(10)
    v_mfma_f32_16x16x32_bf16 v[116:119], v[216:219], v[148:151], v[116:119]
    v_mfma_f32_16x16x32_bf16 v[112:115], v[216:219], v[132:135], v[112:115]
    s_waitcnt lgkmcnt(8)
    v_mfma_f32_16x16x32_bf16 v[124:127], v[220:223], v[176:179], v[124:127]
    ds_read2_b32 v[216:217], v15 offset0:192 offset1:193
    ds_read2_b32 v[218:219], v15 offset0:194 offset1:195
    v_mfma_f32_16x16x32_bf16 v[120:123], v[220:223], v[160:163], v[120:123]
    s_waitcnt lgkmcnt(8)
    v_mfma_f32_16x16x32_bf16 v[116:119], v[220:223], v[144:147], v[116:119]
    v_mfma_f32_16x16x32_bf16 v[112:115], v[220:223], v[128:131], v[112:115]
    v_mfma_f32_16x16x32_bf16 v[124:127], v[224:227], v[172:175], v[124:127]
    ds_read2_b32 v[220:221], v15 offset0:160 offset1:161
    ds_read2_b32 v[222:223], v15 offset0:162 offset1:163
    v_mfma_f32_16x16x32_bf16 v[120:123], v[224:227], v[156:159], v[120:123]
    v_mfma_f32_16x16x32_bf16 v[116:119], v[224:227], v[140:143], v[116:119]
    v_mfma_f32_16x16x32_bf16 v[124:127], v[228:231], v[168:171], v[124:127]
    ds_read2_b32 v[224:225], v15 offset0:128 offset1:129
    ds_read2_b32 v[226:227], v15 offset0:130 offset1:131
    v_mfma_f32_16x16x32_bf16 v[120:123], v[228:231], v[152:155], v[120:123]
    ds_write_b128 v9, v[112:115] offset:0
    v_mfma_f32_16x16x32_bf16 v[116:119], v[228:231], v[136:139], v[116:119]
    s_waitcnt lgkmcnt(11)
    v_mfma_f32_16x16x32_bf16 v[124:127], v[232:235], v[164:167], v[124:127]
    ds_read2_b32 v[228:229], v15 offset0:96 offset1:97
    ds_read2_b32 v[230:231], v15 offset0:98 offset1:99
    v_mfma_f32_16x16x32_bf16 v[120:123], v[232:235], v[148:151], v[120:123]
    v_mfma_f32_16x16x32_bf16 v[116:119], v[232:235], v[132:135], v[116:119]
    s_waitcnt lgkmcnt(11)
    v_mfma_f32_16x16x32_bf16 v[124:127], v[208:211], v[160:163], v[124:127]
    ds_read2_b32 v[232:233], v15 offset0:64 offset1:65
    ds_read2_b32 v[234:235], v15 offset0:66 offset1:67
    v_mfma_f32_16x16x32_bf16 v[120:123], v[208:211], v[144:147], v[120:123]
    v_mfma_f32_16x16x32_bf16 v[116:119], v[208:211], v[128:131], v[116:119]
    s_waitcnt lgkmcnt(11)
    v_mfma_f32_16x16x32_bf16 v[124:127], v[212:215], v[156:159], v[124:127]
    ds_read2_b32 v[208:209], v15 offset0:32 offset1:33
    ds_read2_b32 v[210:211], v15 offset0:34 offset1:35
    v_mfma_f32_16x16x32_bf16 v[120:123], v[212:215], v[140:143], v[120:123]
    s_waitcnt lgkmcnt(11)
    v_mfma_f32_16x16x32_bf16 v[124:127], v[216:219], v[152:155], v[124:127]
    ds_read2_b32 v[212:213], v15 offset0:0 offset1:1
    ds_read2_b32 v[214:215], v15 offset0:2 offset1:3
    v_mfma_f32_16x16x32_bf16 v[120:123], v[216:219], v[136:139], v[120:123]
    ds_write_b128 v9, v[116:119] offset:1152
    s_waitcnt lgkmcnt(12)
    v_mfma_f32_16x16x32_bf16 v[124:127], v[220:223], v[148:151], v[124:127]
    v_mfma_f32_16x16x32_bf16 v[120:123], v[220:223], v[132:135], v[120:123]
    s_waitcnt lgkmcnt(10)
    v_mfma_f32_16x16x32_bf16 v[124:127], v[224:227], v[144:147], v[124:127]
    v_mfma_f32_16x16x32_bf16 v[120:123], v[224:227], v[128:131], v[120:123]
    s_waitcnt lgkmcnt(7)
    v_mfma_f32_16x16x32_bf16 v[124:127], v[228:231], v[140:143], v[124:127]
    s_waitcnt lgkmcnt(5)
    v_mfma_f32_16x16x32_bf16 v[124:127], v[232:235], v[136:139], v[124:127]
    s_waitcnt lgkmcnt(3)
    v_mfma_f32_16x16x32_bf16 v[124:127], v[208:211], v[132:135], v[124:127]
    s_waitcnt lgkmcnt(1)
    v_mfma_f32_16x16x32_bf16 v[124:127], v[212:215], v[128:131], v[124:127]
    ds_write_b128 v9, v[120:123] offset:2304
    s_nop 6
    ds_write_b128 v9, v[124:127] offset:3456
    s_waitcnt vmcnt(0)
    v_cmp_gt_u32 vcc, 16, v20
    s_nop 0
    s_and_b64 vcc, vcc, s[54:55]
    s_cbranch_scc1 mk_ps7
mk_po8:
    s_waitcnt lgkmcnt(0)
    s_barrier
    ds_read_b128 v[192:195], v10 offset:0
    ds_read_b128 v[196:199], v10 offset:256
    ds_read_b128 v[200:203], v10 offset:4608
    ds_read_b128 v[204:207], v10 offset:4864
    ds_read2_b32 v[216:217], v16 offset0:96 offset1:97
    ds_read2_b32 v[218:219], v16 offset0:98 offset1:99
    ds_read2_b32 v[220:221], v16 offset0:64 offset1:65
    ds_read2_b32 v[222:223], v16 offset0:66 offset1:67
    ds_read2_b32 v[224:225], v16 offset0:32 offset1:33
    ds_read2_b32 v[226:227], v16 offset0:34 offset1:35
    ds_read2_b32 v[228:229], v16 offset0:0 offset1:1
    ds_read2_b32 v[230:231], v16 offset0:2 offset1:3
    ds_read2_b32 v[232:233], v15 offset0:224 offset1:225
    ds_read2_b32 v[234:235], v15 offset0:226 offset1:227
    ds_read2_b32 v[208:209], v15 offset0:192 offset1:193
    ds_read2_b32 v[210:211], v15 offset0:194 offset1:195
    s_mov_b32 s31, 4194304
    s_waitcnt lgkmcnt(12)
    buffer_load_dwordx4 a[0:3], v2, s[4:7], s36 offen offset:0 sc1
    v_pk_add_f32 v[192:193], v[192:193], v[100:101]
    v_pk_add_f32 v[194:195], v[194:195], v[102:103]
    v_pk_add_f32 v[196:197], v[196:197], v[104:105]
    v_pk_add_f32 v[198:199], v[198:199], v[106:107]
    v_pk_add_f32 v[192:193], v[192:193], v[200:201]
    v_pk_add_f32 v[194:195], v[194:195], v[202:203]
    v_pk_add_f32 v[196:197], v[196:197], v[204:205]
    v_pk_add_f32 v[198:199], v[198:199], v[206:207]
    v_cvt_pk_bf16_f32 v108, v192, v193
    v_cvt_pk_bf16_f32 v109, v194, v195
    v_cvt_pk_bf16_f32 v110, v196, v197
    v_cvt_pk_bf16_f32 v111, v198, v199
    buffer_load_dwordx4 a[4:7], v2, s[4:7], s36 offen offset:1024 sc1
    buffer_store_dwordx4 v[108:111], v4, s[4:7], s31 offen sc1
    s_waitcnt lgkmcnt(10)
    v_mfma_f32_16x16x32_bf16 v[112:115], v[216:219], v[188:191], 0
    ds_read2_b32 v[212:213], v15 offset0:160 offset1:161
    ds_read2_b32 v[214:215], v15 offset0:162 offset1:163
    s_waitcnt lgkmcnt(10)
    v_mfma_f32_16x16x32_bf16 v[112:115], v[220:223], v[184:187], v[112:115]
    ds_read2_b32 v[216:217], v15 offset0:128 offset1:129
    ds_read2_b32 v[218:219], v15 offset0:130 offset1:131
    buffer_load_dwordx4 a[8:11], v2, s[4:7], s36 offen offset:2048 sc1
    s_waitcnt lgkmcnt(10)
    v_mfma_f32_16x16x32_bf16 v[112:115], v[224:227], v[180:183], v[112:115]
    ds_read2_b32 v[220:221], v15 offset0:96 offset1:97
    ds_read2_b32 v[222:223], v15 offset0:98 offset1:99
    s_waitcnt lgkmcnt(10)
    v_mfma_f32_16x16x32_bf16 v[112:115], v[228:231], v[176:179], v[112:115]
    ds_read2_b32 v[224:225], v15 offset0:64 offset1:65
    ds_read2_b32 v[226:227], v15 offset0:66 offset1:67
    s_waitcnt lgkmcnt(10)
    v_mfma_f32_16x16x32_bf16 v[112:115], v[232:235], v[172:175], v[112:115]
    ds_read2_b32 v[228:229], v15 offset0:32 offset1:33
    ds_read2_b32 v[230:231], v15 offset0:34 offset1:35
    buffer_load_dwordx4 a[12:15], v2, s[4:7], s36 offen offset:3072 sc1
    s_add_u32 s36, s36, 4096
    v_mfma_f32_16x16x32_bf16 v[116:119], v[232:235], v[188:191], 0
    v_lshrrev_b32 v24, 5, v1
    s_waitcnt lgkmcnt(10)
    v_mfma_f32_16x16x32_bf16 v[112:115], v[208:211], v[168:171], v[112:115]
    ds_read2_b32 v[232:233], v15 offset0:0 offset1:1
    ds_read2_b32 v[234:235], v15 offset0:2 offset1:3
    v_mfma_f32_16x16x32_bf16 v[116:119], v[208:211], v[184:187], v[116:119]
    v_lshlrev_b32 v26, 3, v24
    buffer_load_dwordx4 a[16:19], v2, s[4:7], s36 offen offset:0 sc1
    s_waitcnt lgkmcnt(10)
    v_mfma_f32_16x16x32_bf16 v[112:115], v[212:215], v[164:167], v[112:115]
    ds_read2_b32 v[208:209], v14 offset0:224 offset1:225
    ds_read2_b32 v[210:211], v14 offset0:226 offset1:227
    v_mfma_f32_16x16x32_bf16 v[116:119], v[212:215], v[180:183], v[116:119]
    v_bfe_u32 v25, v1, 2, 2
    s_waitcnt lgkmcnt(10)
    v_mfma_f32_16x16x32_bf16 v[112:115], v[216:219], v[160:163], v[112:115]
    ds_read2_b32 v[212:213], v14 offset0:192 offset1:193
    ds_read2_b32 v[214:215], v14 offset0:194 offset1:195
    buffer_load_dwordx4 a[20:23], v2, s[4:7], s36 offen offset:1024 sc1
    v_mfma_f32_16x16x32_bf16 v[116:119], v[216:219], v[176:179], v[116:119]
    v_add_u32 v26, v26, v25
    s_waitcnt lgkmcnt(10)
    v_mfma_f32_16x16x32_bf16 v[112:115], v[220:223], v[156:159], v[112:115]
    ds_read2_b32 v[216:217], v14 offset0:160 offset1:161
    ds_read2_b32 v[218:219], v14 offset0:162 offset1:163
    v_mfma_f32_16x16x32_bf16 v[116:119], v[220:223], v[172:175], v[116:119]
    v_lshlrev_b32 v26, 6, v26
    buffer_load_dwordx4 a[24:27], v2, s[4:7], s36 offen offset:2048 sc1
    v_mfma_f32_16x16x32_bf16 v[120:123], v[220:223], v[188:191], 0
    v_bfe_u32 v25, v1, 4, 1
    s_waitcnt lgkmcnt(10)
    v_mfma_f32_16x16x32_bf16 v[112:115], v[224:227], v[152:155], v[112:115]
    ds_read2_b32 v[220:221], v14 offset0:128 offset1:129
    ds_read2_b32 v[222:223], v14 offset0:130 offset1:131
    v_mfma_f32_16x16x32_bf16 v[116:119], v[224:227], v[168:171], v[116:119]
    v_lshl_add_u32 v26, v25, 5, v26
    buffer_load_dwordx4 a[28:31], v2, s[4:7], s36 offen offset:3072 sc1
    s_add_u32 s36, s36, 4096
    v_mfma_f32_16x16x32_bf16 v[120:123], v[224:227], v[184:187], v[120:123]
    v_and_b32 v25, 3, v1
    s_waitcnt lgkmcnt(10)
    v_mfma_f32_16x16x32_bf16 v[112:115], v[228:231], v[148:151], v[112:115]
    ds_read2_b32 v[224:225], v14 offset0:96 offset1:97
    ds_read2_b32 v[226:227], v14 offset0:98 offset1:99
    v_mfma_f32_16x16x32_bf16 v[116:119], v[228:231], v[164:167], v[116:119]
    v_lshl_add_u32 v26, v25, 3, v26
    buffer_load_dwordx4 a[32:35], v2, s[4:7], s36 offen offset:0 sc1
    v_mfma_f32_16x16x32_bf16 v[120:123], v[228:231], v[180:183], v[120:123]
    v_add_u32 v28, 32768, v26
    s_waitcnt lgkmcnt(10)
    v_mfma_f32_16x16x32_bf16 v[112:115], v[232:235], v[144:147], v[112:115]
    ds_read2_b32 v[228:229], v14 offset0:64 offset1:65
    ds_read2_b32 v[230:231], v14 offset0:66 offset1:67
    v_mfma_f32_16x16x32_bf16 v[116:119], v[232:235], v[160:163], v[116:119]
    v_add_u32 v29, 98304, v26
    buffer_load_dwordx4 a[36:39], v2, s[4:7], s36 offen offset:1024 sc1
    v_mfma_f32_16x16x32_bf16 v[120:123], v[232:235], v[176:179], v[120:123]
    v_and_b32 v30, 0x1f0, v2
    s_waitcnt lgkmcnt(10)
    v_mfma_f32_16x16x32_bf16 v[112:115], v[208:211], v[140:143], v[112:115]
    ds_read2_b32 v[232:233], v14 offset0:32 offset1:33
    ds_read2_b32 v[234:235], v14 offset0:34 offset1:35
    v_mfma_f32_16x16x32_bf16 v[116:119], v[208:211], v[156:159], v[116:119]
    v_lshrrev_b32 v24, 2, v1
    buffer_load_dwordx4 a[40:43], v2, s[4:7], s36 offen offset:2048 sc1
    v_mfma_f32_16x16x32_bf16 v[120:123], v[208:211], v[172:175], v[120:123]
    v_lshrrev_b32 v25, 4, v1
    v_mfma_f32_16x16x32_bf16 v[124:127], v[208:211], v[188:191], 0
    v_xor_b32 v24, v24, v25
    s_waitcnt lgkmcnt(10)
    v_mfma_f32_16x16x32_bf16 v[112:115], v[212:215], v[136:139], v[112:115]
    ds_read2_b32 v[208:209], v14 offset0:0 offset1:1
    ds_read2_b32 v[210:211], v14 offset0:2 offset1:3
    buffer_load_dwordx4 a[44:47], v2, s[4:7], s36 offen offset:3072 sc1
    s_add_u32 s36, s36, 4096
    v_mfma_f32_16x16x32_bf16 v[116:119], v[212:215], v[152:155], v[116:119]
    v_and_b32 v24, 1, v24
    v_mfma_f32_16x16x32_bf16 v[120:123], v[212:215], v[168:171], v[120:123]
    v_subrev_u32 v24, 1, v24
    v_mfma_f32_16x16x32_bf16 v[124:127], v[212:215], v[184:187], v[124:127]
    v_and_b32 v76, s24, v24
    buffer_load_dwordx4 a[48:51], v2, s[4:7], s36 offen offset:0 sc1
    s_waitcnt lgkmcnt(10)
    v_mfma_f32_16x16x32_bf16 v[112:115], v[216:219], v[132:135], v[112:115]
    ds_read2_b32 v[212:213], v7 offset0:224 offset1:225
    ds_read2_b32 v[214:215], v7 offset0:226 offset1:227
    v_mfma_f32_16x16x32_bf16 v[116:119], v[216:219], v[148:151], v[116:119]
    v_mov_b32 v77, v76
    v_mfma_f32_16x16x32_bf16 v[120:123], v[216:219], v[164:167], v[120:123]
    v_mov_b32 v78, v76
    buffer_load_dwordx4 a[52:55], v2, s[4:7], s36 offen offset:1024 sc1
    v_mfma_f32_16x16x32_bf16 v[124:127], v[216:219], v[180:183], v[124:127]
    v_mov_b32 v79, v76
    s_waitcnt lgkmcnt(10)
    v_mfma_f32_16x16x32_bf16 v[112:115], v[220:223], v[128:131], v[112:115]
    ds_read2_b32 v[216:217], v7 offset0:192 offset1:193
    ds_read2_b32 v[218:219], v7 offset0:194 offset1:195
    v_mfma_f32_16x16x32_bf16 v[116:119], v[220:223], v[144:147], v[116:119]
    buffer_load_dwordx4 a[56:59], v2, s[4:7], s36 offen offset:2048 sc1
    v_mfma_f32_16x16x32_bf16 v[120:123], v[220:223], v[160:163], v[120:123]
    v_mfma_f32_16x16x32_bf16 v[124:127], v[220:223], v[176:179], v[124:127]
    s_waitcnt lgkmcnt(10)
    v_mfma_f32_16x16x32_bf16 v[116:119], v[224:227], v[140:143], v[116:119]
    ds_read2_b32 v[220:221], v7 offset0:160 offset1:161
    ds_read2_b32 v[222:223], v7 offset0:162 offset1:163
    s_waitcnt vmcnt(13)
    s_barrier
    s_add_u32 s38, s26, 15990784
    buffer_atomic_add v21, v17, s[4:7], s38 offen sc1
    buffer_load_dwordx4 a[60:63], v2, s[4:7], s36 offen offset:3072 sc1
    s_add_u32 s36, s36, 4096
    v_mfma_f32_16x16x32_bf16 v[120:123], v[224:227], v[156:159], v[120:123]
    v_mfma_f32_16x16x32_bf16 v[124:127], v[224:227], v[172:175], v[124:127]
    s_waitcnt lgkmcnt(10)
    v_mfma_f32_16x16x32_bf16 v[116:119], v[228:231], v[136:139], v[116:119]
    ds_read2_b32 v[224:225], v7 offset0:128 offset1:129
    ds_read2_b32 v[226:227], v7 offset0:130 offset1:131
    buffer_load_dwordx4 a[64:67], v2, s[4:7], s36 offen offset:0 sc1
    v_mfma_f32_16x16x32_bf16 v[120:123], v[228:231], v[152:155], v[120:123]
    v_mfma_f32_16x16x32_bf16 v[124:127], v[228:231], v[168:171], v[124:127]
    s_waitcnt lgkmcnt(10)
    v_mfma_f32_16x16x32_bf16 v[116:119], v[232:235], v[132:135], v[116:119]
    ds_read2_b32 v[228:229], v7 offset0:96 offset1:97
    ds_read2_b32 v[230:231], v7 offset0:98 offset1:99
    buffer_load_dwordx4 a[68:71], v2, s[4:7], s36 offen offset:1024 sc1
    v_mfma_f32_16x16x32_bf16 v[120:123], v[232:235], v[148:151], v[120:123]
    v_mfma_f32_16x16x32_bf16 v[124:127], v[232:235], v[164:167], v[124:127]
    s_waitcnt lgkmcnt(10)
    v_mfma_f32_16x16x32_bf16 v[116:119], v[208:211], v[128:131], v[116:119]
    ds_read2_b32 v[232:233], v7 offset0:64 offset1:65
    ds_read2_b32 v[234:235], v7 offset0:66 offset1:67
    buffer_load_dwordx4 a[72:75], v2, s[4:7], s36 offen offset:2048 sc1
    v_mfma_f32_16x16x32_bf16 v[120:123], v[208:211], v[144:147], v[120:123]
    v_mfma_f32_16x16x32_bf16 v[124:127], v[208:211], v[160:163], v[124:127]
    s_waitcnt lgkmcnt(10)
    v_mfma_f32_16x16x32_bf16 v[120:123], v[212:215], v[140:143], v[120:123]
    ds_read2_b32 v[208:209], v7 offset0:32 offset1:33
    ds_read2_b32 v[210:211], v7 offset0:34 offset1:35
    buffer_load_dwordx4 a[76:79], v2, s[4:7], s36 offen offset:3072 sc1
    s_add_u32 s36, s36, 4096
    v_mfma_f32_16x16x32_bf16 v[124:127], v[212:215], v[156:159], v[124:127]
    s_waitcnt lgkmcnt(10)
    v_mfma_f32_16x16x32_bf16 v[120:123], v[216:219], v[136:139], v[120:123]
    ds_read2_b32 v[212:213], v7 offset0:0 offset1:1
    ds_read2_b32 v[214:215], v7 offset0:2 offset1:3
    v_mfma_f32_16x16x32_bf16 v[124:127], v[216:219], v[152:155], v[124:127]
    buffer_load_dwordx4 a[80:83], v2, s[4:7], s36 offen offset:0 sc1
    s_waitcnt lgkmcnt(10)
    v_mfma_f32_16x16x32_bf16 v[120:123], v[220:223], v[132:135], v[120:123]
    v_mfma_f32_16x16x32_bf16 v[124:127], v[220:223], v[148:151], v[124:127]
    s_waitcnt lgkmcnt(8)
    v_mfma_f32_16x16x32_bf16 v[120:123], v[224:227], v[128:131], v[120:123]
    buffer_load_dwordx4 a[84:87], v2, s[4:7], s36 offen offset:1024 sc1
    v_mfma_f32_16x16x32_bf16 v[124:127], v[224:227], v[144:147], v[124:127]
    s_waitcnt lgkmcnt(6)
    v_mfma_f32_16x16x32_bf16 v[124:127], v[228:231], v[140:143], v[124:127]
    s_waitcnt lgkmcnt(4)
    v_mfma_f32_16x16x32_bf16 v[124:127], v[232:235], v[136:139], v[124:127]
    buffer_load_dwordx4 a[88:91], v2, s[4:7], s36 offen offset:2048 sc1
    s_waitcnt lgkmcnt(2)
    v_mfma_f32_16x16x32_bf16 v[124:127], v[208:211], v[132:135], v[124:127]
    s_waitcnt lgkmcnt(0)
    v_mfma_f32_16x16x32_bf16 v[124:127], v[212:215], v[128:131], v[124:127]
    ds_read_b128 v[248:251], v11 offset:0
    ds_read_b128 v[252:255], v11 offset:16
    ds_read_b128 v[84:87], v11 offset:32
    ds_read_b128 v[88:91], v11 offset:48
    s_mul_i32 s35, s20, 98304
    s_add_u32 s35, s35, s41
    s_add_u32 s35, s35, 4194304
    s_add_u32 s35, s35, s44
    v_lshlrev_b32 v92, 16, v244
    v_and_b32 v93, 0xffff0000, v244
    v_lshlrev_b32 v94, 16, v245
    v_and_b32 v95, 0xffff0000, v245
    v_lshlrev_b32 v96, 16, v246
    v_and_b32 v97, 0xffff0000, v246
    v_lshlrev_b32 v98, 16, v247
    v_and_b32 v99, 0xffff0000, v247
    s_waitcnt lgkmcnt(0)
    v_pk_fma_f32 v[100:101], v[92:93], v[250:251], v[248:249]
    v_pk_fma_f32 v[102:103], v[94:95], v[254:255], v[252:253]
    v_pk_fma_f32 v[104:105], v[96:97], v[86:87], v[84:85]
    buffer_load_dwordx4 a[92:95], v2, s[4:7], s36 offen offset:3072 sc1
    s_add_u32 s36, s36, 4096
    v_pk_fma_f32 v[106:107], v[98:99], v[90:91], v[88:89]
    v_cvt_pk_bf16_f32 v108, v100, v101
    v_cvt_pk_bf16_f32 v109, v102, v103
    v_cvt_pk_bf16_f32 v110, v104, v105
    v_cvt_pk_bf16_f32 v111, v106, v107
    ds_write_b128 v6, v[108:111] offset:19200
    ds_read2_b32 v[216:217], v16 offset0:224 offset1:225
    ds_read2_b32 v[218:219], v16 offset0:226 offset1:227
    ds_read2_b32 v[220:221], v16 offset0:192 offset1:193
    ds_read2_b32 v[222:223], v16 offset0:194 offset1:195
    ds_read2_b32 v[224:225], v16 offset0:160 offset1:161
    ds_read2_b32 v[226:227], v16 offset0:162 offset1:163
    ds_read2_b32 v[228:229], v16 offset0:128 offset1:129
    ds_read2_b32 v[230:231], v16 offset0:130 offset1:131
    ds_read2_b32 v[232:233], v16 offset0:96 offset1:97
    ds_read2_b32 v[234:235], v16 offset0:98 offset1:99
    ds_read2_b32 v[208:209], v16 offset0:64 offset1:65
    ds_read2_b32 v[210:211], v16 offset0:66 offset1:67
    v_mfma_f32_16x16x32_bf16 v[80:83], v[76:79], a[0:3], 0
    v_mfma_f32_16x16x32_bf16 v[80:83], v[76:79], a[4:7], v[80:83]
    s_waitcnt lgkmcnt(12)
    s_barrier
    ds_read_b128 v[188:191], v8 offset:3968
    ds_read_b128 v[172:175], v8 offset:3456
    ds_read_b128 v[156:159], v8 offset:2944
    ds_read_b128 v[140:143], v8 offset:2432
    ds_read_b128 v[184:187], v8 offset:3840
    ds_read_b128 v[168:171], v8 offset:3328
    ds_read_b128 v[152:155], v8 offset:2816
    ds_read_b128 v[136:139], v8 offset:2304
    ds_read_b128 v[180:183], v8 offset:3712
    ds_read_b128 v[164:167], v8 offset:3200
    ds_read_b128 v[148:151], v8 offset:2688
    ds_read_b128 v[132:135], v8 offset:2176
    ds_read_b128 v[176:179], v8 offset:3584
    ds_read_b128 v[160:163], v8 offset:3072
    ds_read_b128 v[144:147], v8 offset:2560
    ds_read_b128 v[128:131], v8 offset:2048
    v_fma_f32 v100, v12, v100, v92
    v_fma_f32 v101, v12, v101, v93
    v_fma_f32 v102, v12, v102, v94
    v_fma_f32 v103, v12, v103, v95
    v_fma_f32 v104, v12, v104, v96
    v_fma_f32 v105, v12, v105, v97
    v_fma_f32 v106, v12, v106, v98
    v_fma_f32 v107, v12, v107, v99
    s_add_u32 s37, s27, 15990784
    v_mov_b32 v20, 0
    buffer_atomic_add v20, v19, s[4:7], s37 offen sc0 sc1
    s_waitcnt lgkmcnt(14)
    v_mfma_f32_16x16x32_bf16 v[124:127], v[216:219], v[188:191], v[124:127]
    ds_read2_b32 v[212:213], v16 offset0:32 offset1:33
    ds_read2_b32 v[214:215], v16 offset0:34 offset1:35
    buffer_load_dwordx4 a[96:99], v2, s[4:7], s36 offen offset:0 sc1
    v_mfma_f32_16x16x32_bf16 v[120:123], v[216:219], v[172:175], v[120:123]
    s_waitcnt lgkmcnt(14)
    v_mfma_f32_16x16x32_bf16 v[116:119], v[216:219], v[156:159], v[116:119]
    v_mfma_f32_16x16x32_bf16 v[112:115], v[216:219], v[140:143], v[112:115]
    s_waitcnt lgkmcnt(12)
    v_mfma_f32_16x16x32_bf16 v[124:127], v[220:223], v[184:187], v[124:127]
    ds_read2_b32 v[216:217], v16 offset0:0 offset1:1
    ds_read2_b32 v[218:219], v16 offset0:2 offset1:3
    buffer_load_dwordx4 a[100:103], v2, s[4:7], s36 offen offset:1024 sc1
    v_mfma_f32_16x16x32_bf16 v[120:123], v[220:223], v[168:171], v[120:123]
    s_waitcnt lgkmcnt(12)
    v_mfma_f32_16x16x32_bf16 v[116:119], v[220:223], v[152:155], v[116:119]
    v_mfma_f32_16x16x32_bf16 v[112:115], v[220:223], v[136:139], v[112:115]
    s_waitcnt lgkmcnt(10)
    v_mfma_f32_16x16x32_bf16 v[124:127], v[224:227], v[180:183], v[124:127]
    ds_read2_b32 v[220:221], v15 offset0:224 offset1:225
    ds_read2_b32 v[222:223], v15 offset0:226 offset1:227
    buffer_load_dwordx4 a[104:107], v2, s[4:7], s36 offen offset:2048 sc1
    v_mfma_f32_16x16x32_bf16 v[120:123], v[224:227], v[164:167], v[120:123]
    s_waitcnt lgkmcnt(10)
    v_mfma_f32_16x16x32_bf16 v[116:119], v[224:227], v[148:151], v[116:119]
    v_mfma_f32_16x16x32_bf16 v[112:115], v[224:227], v[132:135], v[112:115]
    s_waitcnt lgkmcnt(8)
    v_mfma_f32_16x16x32_bf16 v[124:127], v[228:231], v[176:179], v[124:127]
    ds_read2_b32 v[224:225], v15 offset0:192 offset1:193
    ds_read2_b32 v[226:227], v15 offset0:194 offset1:195
    buffer_load_dwordx4 a[108:111], v2, s[4:7], s36 offen offset:3072 sc1
    s_add_u32 s36, s36, 4096
    v_mfma_f32_16x16x32_bf16 v[120:123], v[228:231], v[160:163], v[120:123]
    s_waitcnt lgkmcnt(8)
    v_mfma_f32_16x16x32_bf16 v[116:119], v[228:231], v[144:147], v[116:119]
    v_mfma_f32_16x16x32_bf16 v[112:115], v[228:231], v[128:131], v[112:115]
    v_mfma_f32_16x16x32_bf16 v[124:127], v[232:235], v[172:175], v[124:127]
    ds_read2_b32 v[228:229], v15 offset0:160 offset1:161
    ds_read2_b32 v[230:231], v15 offset0:162 offset1:163
    buffer_load_dwordx4 a[112:115], v2, s[4:7], s36 offen offset:0 sc1
    v_mfma_f32_16x16x32_bf16 v[120:123], v[232:235], v[156:159], v[120:123]
    v_mfma_f32_16x16x32_bf16 v[116:119], v[232:235], v[140:143], v[116:119]
    v_mfma_f32_16x16x32_bf16 v[124:127], v[208:211], v[168:171], v[124:127]
    ds_read2_b32 v[232:233], v15 offset0:128 offset1:129
    ds_read2_b32 v[234:235], v15 offset0:130 offset1:131
    v_mfma_f32_16x16x32_bf16 v[120:123], v[208:211], v[152:155], v[120:123]
    ds_write_b128 v9, v[112:115] offset:0
    buffer_load_dwordx4 a[116:119], v2, s[4:7], s36 offen offset:1024 sc1
    v_mfma_f32_16x16x32_bf16 v[116:119], v[208:211], v[136:139], v[116:119]
    s_waitcnt lgkmcnt(11)
    v_mfma_f32_16x16x32_bf16 v[124:127], v[212:215], v[164:167], v[124:127]
    ds_read2_b32 v[208:209], v15 offset0:96 offset1:97
    ds_read2_b32 v[210:211], v15 offset0:98 offset1:99
    v_mfma_f32_16x16x32_bf16 v[120:123], v[212:215], v[148:151], v[120:123]
    v_mfma_f32_16x16x32_bf16 v[116:119], v[212:215], v[132:135], v[116:119]
    buffer_load_dwordx4 a[120:123], v2, s[4:7], s36 offen offset:2048 sc1
    s_waitcnt lgkmcnt(11)
    v_mfma_f32_16x16x32_bf16 v[124:127], v[216:219], v[160:163], v[124:127]
    ds_read2_b32 v[212:213], v15 offset0:64 offset1:65
    ds_read2_b32 v[214:215], v15 offset0:66 offset1:67
    v_mfma_f32_16x16x32_bf16 v[120:123], v[216:219], v[144:147], v[120:123]
    v_mfma_f32_16x16x32_bf16 v[116:119], v[216:219], v[128:131], v[116:119]
    s_waitcnt lgkmcnt(11)
    v_mfma_f32_16x16x32_bf16 v[124:127], v[220:223], v[156:159], v[124:127]
    ds_read2_b32 v[216:217], v15 offset0:32 offset1:33
    ds_read2_b32 v[218:219], v15 offset0:34 offset1:35
    buffer_load_dwordx4 a[124:127], v2, s[4:7], s36 offen offset:3072 sc1
    s_add_u32 s36, s36, 4096
    v_mfma_f32_16x16x32_bf16 v[120:123], v[220:223], v[140:143], v[120:123]
    s_waitcnt lgkmcnt(11)
    v_mfma_f32_16x16x32_bf16 v[124:127], v[224:227], v[152:155], v[124:127]
    ds_read2_b32 v[220:221], v15 offset0:0 offset1:1
    ds_read2_b32 v[222:223], v15 offset0:2 offset1:3
    v_mfma_f32_16x16x32_bf16 v[120:123], v[224:227], v[136:139], v[120:123]
    ds_write_b128 v9, v[116:119] offset:1152
    s_waitcnt lgkmcnt(12)
    v_mfma_f32_16x16x32_bf16 v[124:127], v[228:231], v[148:151], v[124:127]
    v_mfma_f32_16x16x32_bf16 v[120:123], v[228:231], v[132:135], v[120:123]
    s_waitcnt lgkmcnt(10)
    v_mfma_f32_16x16x32_bf16 v[124:127], v[232:235], v[144:147], v[124:127]
    v_mfma_f32_16x16x32_bf16 v[120:123], v[232:235], v[128:131], v[120:123]
    s_waitcnt lgkmcnt(7)
    v_mfma_f32_16x16x32_bf16 v[124:127], v[208:211], v[140:143], v[124:127]
    s_waitcnt lgkmcnt(5)
    v_mfma_f32_16x16x32_bf16 v[124:127], v[212:215], v[136:139], v[124:127]
    s_waitcnt lgkmcnt(3)
    v_mfma_f32_16x16x32_bf16 v[124:127], v[216:219], v[132:135], v[124:127]
    s_waitcnt lgkmcnt(1)
    v_mfma_f32_16x16x32_bf16 v[124:127], v[220:223], v[128:131], v[124:127]
    ds_write_b128 v9, v[120:123] offset:2304
    s_nop 6
    ds_write_b128 v9, v[124:127] offset:3456
    s_waitcnt vmcnt(8)
    v_cmp_gt_u32 vcc, 16, v20
    s_nop 0
    s_and_b64 vcc, vcc, s[54:55]
    s_cbranch_scc1 mk_ps10
mk_po11:
    s_barrier
    s_add_u32 m0, s41, 32768
    s_nop 0
    buffer_load_dwordx4 v2, s[4:7], s35 offen offset:0 sc1 lds
    s_waitcnt lgkmcnt(0)
    s_barrier
    ds_read_b128 v[192:195], v10 offset:0
    ds_read_b128 v[196:199], v10 offset:256
    ds_read_b128 v[200:203], v10 offset:4608
    ds_read_b128 v[204:207], v10 offset:4864
    v_mfma_f32_16x16x32_bf16 v[80:83], v[76:79], a[8:11], v[80:83]
    v_mfma_f32_16x16x32_bf16 v[80:83], v[76:79], a[12:15], v[80:83]
    v_mfma_f32_16x16x32_bf16 v[80:83], v[76:79], a[16:19], v[80:83]
    v_mfma_f32_16x16x32_bf16 v[80:83], v[76:79], a[20:23], v[80:83]
    v_mfma_f32_16x16x32_bf16 v[80:83], v[76:79], a[24:27], v[80:83]
    v_mfma_f32_16x16x32_bf16 v[80:83], v[76:79], a[28:31], v[80:83]
    s_mov_b32 s31, 5242880
    s_waitcnt lgkmcnt(0)
    buffer_load_dwordx4 v2, s[4:7], s35 offen offset:1024 sc1 lds
    v_pk_add_f32 v[192:193], v[192:193], v[100:101]
    v_pk_add_f32 v[194:195], v[194:195], v[102:103]
    v_pk_add_f32 v[196:197], v[196:197], v[104:105]
    v_pk_add_f32 v[198:199], v[198:199], v[106:107]
    v_pk_add_f32 v[192:193], v[192:193], v[200:201]
    v_pk_add_f32 v[194:195], v[194:195], v[202:203]
    v_pk_add_f32 v[196:197], v[196:197], v[204:205]
    v_pk_add_f32 v[198:199], v[198:199], v[206:207]
    v_cvt_pk_bf16_f32 v108, v192, v193
    v_cvt_pk_bf16_f32 v109, v194, v195
    v_cvt_pk_bf16_f32 v110, v196, v197
    v_cvt_pk_bf16_f32 v111, v198, v199
    buffer_load_dwordx4 v2, s[4:7], s35 offen offset:2048 sc1 lds
    buffer_store_dwordx4 v[108:111], v4, s[4:7], s31 offen sc1
    buffer_load_dwordx4 v2, s[4:7], s35 offen offset:3072 sc1 lds
    s_add_u32 s35, s35, 16384
    v_mfma_f32_16x16x32_bf16 v[80:83], v[76:79], a[32:35], v[80:83]
    v_mfma_f32_16x16x32_bf16 v[80:83], v[76:79], a[36:39], v[80:83]
    v_mfma_f32_16x16x32_bf16 v[80:83], v[76:79], a[40:43], v[80:83]
    s_add_u32 m0, s41, 49152
    s_nop 0
    buffer_load_dwordx4 v2, s[4:7], s35 offen offset:0 sc1 lds
    v_mfma_f32_16x16x32_bf16 v[80:83], v[76:79], a[44:47], v[80:83]
    v_mfma_f32_16x16x32_bf16 v[80:83], v[76:79], a[48:51], v[80:83]
    v_mfma_f32_16x16x32_bf16 v[80:83], v[76:79], a[52:55], v[80:83]
    buffer_load_dwordx4 v2, s[4:7], s35 offen offset:1024 sc1 lds
    v_mfma_f32_16x16x32_bf16 v[80:83], v[76:79], a[56:59], v[80:83]
    v_mfma_f32_16x16x32_bf16 v[80:83], v[76:79], a[60:63], v[80:83]
    v_mfma_f32_16x16x32_bf16 v[80:83], v[76:79], a[64:67], v[80:83]
    buffer_load_dwordx4 v2, s[4:7], s35 offen offset:2048 sc1 lds
    v_mfma_f32_16x16x32_bf16 v[80:83], v[76:79], a[68:71], v[80:83]
    v_mfma_f32_16x16x32_bf16 v[80:83], v[76:79], a[72:75], v[80:83]
    v_mfma_f32_16x16x32_bf16 v[80:83], v[76:79], a[76:79], v[80:83]
    buffer_load_dwordx4 v2, s[4:7], s35 offen offset:3072 sc1 lds
    s_add_u32 s35, s35, 16384
    v_mfma_f32_16x16x32_bf16 v[80:83], v[76:79], a[80:83], v[80:83]
    v_mfma_f32_16x16x32_bf16 v[80:83], v[76:79], a[84:87], v[80:83]
    v_mfma_f32_16x16x32_bf16 v[80:83], v[76:79], a[88:91], v[80:83]
    s_add_u32 m0, s41, 65536
    s_nop 0
    buffer_load_dwordx4 v2, s[4:7], s35 offen offset:0 sc1 lds
    v_mfma_f32_16x16x32_bf16 v[80:83], v[76:79], a[92:95], v[80:83]
    buffer_load_dwordx4 v2, s[4:7], s35 offen offset:1024 sc1 lds
    buffer_load_dwordx4 v2, s[4:7], s35 offen offset:2048 sc1 lds
    s_waitcnt vmcnt(8)
    s_barrier
    s_add_u32 s38, s26, 16023552
    buffer_atomic_add v21, v17, s[4:7], s38 offen sc1
    s_cmp_eq_u32 s30, 0
    s_cbranch_scc1 mk_idle0
    buffer_load_dwordx4 v2, s[4:7], s35 offen offset:3072 sc1 lds
    s_add_u32 s35, s35, 16384
    v_mfma_f32_16x16x32_bf16 v[80:83], v[76:79], a[96:99], v[80:83]
    v_mfma_f32_16x16x32_bf16 v[80:83], v[76:79], a[100:103], v[80:83]
    v_mfma_f32_16x16x32_bf16 v[80:83], v[76:79], a[104:107], v[80:83]
    s_add_u32 m0, s41, 81920
    s_nop 0
    buffer_load_dwordx4 v2, s[4:7], s35 offen offset:0 sc1 lds
    v_mfma_f32_16x16x32_bf16 v[80:83], v[76:79], a[108:111], v[80:83]
    v_mfma_f32_16x16x32_bf16 v[80:83], v[76:79], a[112:115], v[80:83]
    v_mfma_f32_16x16x32_bf16 v[80:83], v[76:79], a[116:119], v[80:83]
    buffer_load_dwordx4 v2, s[4:7], s35 offen offset:1024 sc1 lds
    v_mfma_f32_16x16x32_bf16 v[80:83], v[76:79], a[120:123], v[80:83]
    v_mfma_f32_16x16x32_bf16 v[80:83], v[76:79], a[124:127], v[80:83]
    buffer_load_dwordx4 v2, s[4:7], s35 offen offset:2048 sc1 lds
    buffer_load_dwordx4 v2, s[4:7], s35 offen offset:3072 sc1 lds
    s_add_u32 s35, s35, 16384
    v_accvgpr_write_b32 a128, 0
    v_accvgpr_write_b32 a129, 0
    v_accvgpr_write_b32 a130, 0
    s_nop 1
    v_sub_f32 v132, 0, v80
    v_cvt_pk_bf16_f32 v133, v132, v132
    v_and_b32 v134, 0xffff0000, v133
    v_sub_f32 v135, v132, v134
    v_cvt_pk_bf16_f32 v136, v132, v135
    s_mov_b32 exec_lo, 0
    v_mov_b32 v136, 0
    s_mov_b32 exec_lo, -1
    v_accvgpr_write_b32 a131, v136
    s_mul_i32 s91, s23, 180224
    s_lshl_b32 s31, s3, 10
    s_add_u32 s91, s91, s31
    s_add_u32 s91, s91, 20971520
    s_add_u32 s92, s91, 90112
    s_mul_i32 s36, s23, 0
    s_add_u32 s36, s36, s91
    v_add_u32 v24, s41, v28
    v_mov_b32 v164, 0
    v_mov_b32 v165, 0
    v_mov_b32 v166, 0
    v_mov_b32 v167, 0
    s_waitcnt vmcnt(13)
    ds_read_b64_tr_b16 v[116:117], v24 offset:0
    ds_read_b64_tr_b16 v[118:119], v24 offset:256
    ds_read_b64_tr_b16 v[120:121], v24 offset:1024
    ds_read_b64_tr_b16 v[122:123], v24 offset:1280
    ds_read_b64_tr_b16 v[124:125], v24 offset:2048
    ds_read_b64_tr_b16 v[126:127], v24 offset:2304
    ds_read_b64_tr_b16 v[128:129], v24 offset:3072
    ds_read_b64_tr_b16 v[130:131], v24 offset:3328
    s_barrier
    ds_read_b64_tr_b16 v[132:133], v28 offset:0
    ds_read_b64_tr_b16 v[134:135], v28 offset:256
    ds_read_b64_tr_b16 v[136:137], v28 offset:1024
    ds_read_b64_tr_b16 v[138:139], v28 offset:1280
    ds_read_b64_tr_b16 v[140:141], v28 offset:2048
    ds_read_b64_tr_b16 v[142:143], v28 offset:2304
    ds_read_b64_tr_b16 v[144:145], v28 offset:3072
    ds_read_b64_tr_b16 v[146:147], v28 offset:3328
    ds_read_b64_tr_b16 v[148:149], v28 offset:4096
    ds_read_b64_tr_b16 v[150:151], v28 offset:4352
    ds_read_b64_tr_b16 v[152:153], v28 offset:5120
    ds_read_b64_tr_b16 v[154:155], v28 offset:5376
    ds_read_b64_tr_b16 v[156:157], v28 offset:6144
    ds_read_b64_tr_b16 v[158:159], v28 offset:6400
    s_waitcnt lgkmcnt(14)
    v_dot2c_f32_bf16 v164, s24, v116
    v_dot2c_f32_bf16 v166, v116, v116
    v_dot2c_f32_bf16 v165, s24, v117
    v_dot2c_f32_bf16 v167, v117, v117
    v_dot2c_f32_bf16 v164, s24, v118
    v_dot2c_f32_bf16 v166, v118, v118
    v_dot2c_f32_bf16 v165, s24, v119
    v_dot2c_f32_bf16 v167, v119, v119
    v_dot2c_f32_bf16 v164, s24, v120
    v_dot2c_f32_bf16 v166, v120, v120
    v_dot2c_f32_bf16 v165, s24, v121
    v_dot2c_f32_bf16 v167, v121, v121
    v_dot2c_f32_bf16 v164, s24, v122
    v_dot2c_f32_bf16 v166, v122, v122
    v_dot2c_f32_bf16 v165, s24, v123
    v_dot2c_f32_bf16 v167, v123, v123
    v_dot2c_f32_bf16 v164, s24, v124
    v_dot2c_f32_bf16 v166, v124, v124
    v_dot2c_f32_bf16 v165, s24, v125
    v_dot2c_f32_bf16 v167, v125, v125
    v_dot2c_f32_bf16 v164, s24, v126
    v_dot2c_f32_bf16 v166, v126, v126
    v_dot2c_f32_bf16 v165, s24, v127
    v_dot2c_f32_bf16 v167, v127, v127
    v_dot2c_f32_bf16 v164, s24, v128
    v_dot2c_f32_bf16 v166, v128, v128
    v_dot2c_f32_bf16 v165, s24, v129
    v_dot2c_f32_bf16 v167, v129, v129
    v_dot2c_f32_bf16 v164, s24, v130
    v_dot2c_f32_bf16 v166, v130, v130
    v_dot2c_f32_bf16 v165, s24, v131
    v_dot2c_f32_bf16 v167, v131, v131
    s_waitcnt lgkmcnt(12)
    v_mfma_f32_32x32x16_bf16 v[84:99], a[0:3], v[132:135], 0
    ds_read_b64_tr_b16 v[160:161], v28 offset:7168
    ds_read_b64_tr_b16 v[162:163], v28 offset:7424
    s_cmp_eq_u32 s20, 10
    s_cselect_b32 s35, 2146435072, s35
    s_add_u32 m0, s41, 98304
    s_nop 0
    buffer_load_dwordx4 v2, s[4:7], s35 offen offset:0 sc1 lds
    s_waitcnt lgkmcnt(12)
    v_mfma_f32_32x32x16_bf16 v[84:99], a[4:7], v[136:139], v[84:99]
    ds_read_b64_tr_b16 v[132:133], v28 offset:8192
    ds_read_b64_tr_b16 v[134:135], v28 offset:8448
    s_waitcnt lgkmcnt(12)
    v_mfma_f32_32x32x16_bf16 v[84:99], a[8:11], v[140:143], v[84:99]
    ds_read_b64_tr_b16 v[136:137], v28 offset:9216
    ds_read_b64_tr_b16 v[138:139], v28 offset:9472
    buffer_load_dwordx4 v2, s[4:7], s35 offen offset:1024 sc1 lds
    s_waitcnt lgkmcnt(8)
    v_mfma_f32_32x32x16_bf16 v[84:99], a[12:15], v[144:147], v[84:99]
    ds_read_b64_tr_b16 v[140:141], v28 offset:10240
    ds_read_b64_tr_b16 v[142:143], v28 offset:10496
    v_mfma_f32_32x32x16_bf16 v[84:99], a[16:19], v[148:151], v[84:99]
    ds_read_b64_tr_b16 v[144:145], v28 offset:11264
    ds_read_b64_tr_b16 v[146:147], v28 offset:11520
    buffer_load_dwordx4 v2, s[4:7], s35 offen offset:2048 sc1 lds
    v_mfma_f32_32x32x16_bf16 v[84:99], a[20:23], v[152:155], v[84:99]
    ds_read_b64_tr_b16 v[148:149], v28 offset:12288
    ds_read_b64_tr_b16 v[150:151], v28 offset:12544
    s_waitcnt lgkmcnt(8)
    v_mfma_f32_32x32x16_bf16 v[84:99], a[24:27], v[156:159], v[84:99]
    ds_read_b64_tr_b16 v[152:153], v28 offset:13312
    ds_read_b64_tr_b16 v[154:155], v28 offset:13568
    buffer_load_dwordx4 v2, s[4:7], s35 offen offset:3072 sc1 lds
    s_add_u32 s35, s35, 16384
    v_mfma_f32_32x32x16_bf16 v[84:99], a[28:31], v[160:163], v[84:99]
    ds_read_b64_tr_b16 v[156:157], v28 offset:14336
    ds_read_b64_tr_b16 v[158:159], v28 offset:14592
    v_mfma_f32_32x32x16_bf16 v[84:99], a[32:35], v[132:135], v[84:99]
    ds_read_b64_tr_b16 v[160:161], v28 offset:15360
    ds_read_b64_tr_b16 v[162:163], v28 offset:15616
    s_add_u32 m0, s41, 114688
    s_nop 0
    buffer_load_dwordx4 v2, s[4:7], s35 offen offset:0 sc1 lds
    s_waitcnt vmcnt(14)
    s_barrier
    s_waitcnt lgkmcnt(8)
    v_mfma_f32_32x32x16_bf16 v[84:99], a[36:39], v[136:139], v[84:99]
    ds_read_b64_tr_b16 v[132:133], v28 offset:16384
    ds_read_b64_tr_b16 v[134:135], v28 offset:16640
    v_mfma_f32_32x32x16_bf16 v[84:99], a[40:43], v[140:143], v[84:99]
    ds_read_b64_tr_b16 v[136:137], v28 offset:17408
    ds_read_b64_tr_b16 v[138:139], v28 offset:17664
    buffer_load_dwordx4 v2, s[4:7], s35 offen offset:1024 sc1 lds
    ds_read_b64_tr_b16 v[116:117], v24 offset:16384
    ds_read_b64_tr_b16 v[118:119], v24 offset:16640
    ds_read_b64_tr_b16 v[120:121], v24 offset:17408
    ds_read_b64_tr_b16 v[122:123], v24 offset:17664
    ds_read_b64_tr_b16 v[124:125], v24 offset:18432
    ds_read_b64_tr_b16 v[126:127], v24 offset:18688
    ds_read_b64_tr_b16 v[128:129], v24 offset:19456
    ds_read_b64_tr_b16 v[130:131], v24 offset:19712
    v_mfma_f32_32x32x16_bf16 v[84:99], a[44:47], v[144:147], v[84:99]
    ds_read_b64_tr_b16 v[140:141], v28 offset:18432
    ds_read_b64_tr_b16 v[142:143], v28 offset:18688
    s_waitcnt lgkmcnt(15)
    v_mfma_f32_32x32x16_bf16 v[84:99], a[48:51], v[148:151], v[84:99]
    ds_read_b64_tr_b16 v[144:145], v28 offset:19456
    ds_read_b64_tr_b16 v[146:147], v28 offset:19712
    buffer_load_dwordx4 v2, s[4:7], s35 offen offset:2048 sc1 lds
    v_mfma_f32_32x32x16_bf16 v[84:99], a[52:55], v[152:155], v[84:99]
    ds_read_b64_tr_b16 v[148:149], v28 offset:20480
    ds_read_b64_tr_b16 v[150:151], v28 offset:20736
    v_mfma_f32_32x32x16_bf16 v[84:99], a[56:59], v[156:159], v[84:99]
    ds_read_b64_tr_b16 v[152:153], v28 offset:21504
    ds_read_b64_tr_b16 v[154:155], v28 offset:21760
    buffer_load_dwordx4 v2, s[4:7], s35 offen offset:3072 sc1 lds
    s_add_u32 s35, s35, 16384
    s_waitcnt lgkmcnt(8)
    v_dot2c_f32_bf16 v164, s24, v116
    v_dot2c_f32_bf16 v166, v116, v116
    v_dot2c_f32_bf16 v165, s24, v117
    v_dot2c_f32_bf16 v167, v117, v117
    v_dot2c_f32_bf16 v164, s24, v118
    v_dot2c_f32_bf16 v166, v118, v118
    v_dot2c_f32_bf16 v165, s24, v119
    v_dot2c_f32_bf16 v167, v119, v119
    v_dot2c_f32_bf16 v164, s24, v120
    v_dot2c_f32_bf16 v166, v120, v120
    v_dot2c_f32_bf16 v165, s24, v121
    v_dot2c_f32_bf16 v167, v121, v121
    v_dot2c_f32_bf16 v164, s24, v122
    v_dot2c_f32_bf16 v166, v122, v122
    v_dot2c_f32_bf16 v165, s24, v123
    v_dot2c_f32_bf16 v167, v123, v123
    v_dot2c_f32_bf16 v164, s24, v124
    v_dot2c_f32_bf16 v166, v124, v124
    v_dot2c_f32_bf16 v165, s24, v125
    v_dot2c_f32_bf16 v167, v125, v125
    v_dot2c_f32_bf16 v164, s24, v126
    v_dot2c_f32_bf16 v166, v126, v126
    v_dot2c_f32_bf16 v165, s24, v127
    v_dot2c_f32_bf16 v167, v127, v127
    v_dot2c_f32_bf16 v164, s24, v128
    v_dot2c_f32_bf16 v166, v128, v128
    v_dot2c_f32_bf16 v165, s24, v129
    v_dot2c_f32_bf16 v167, v129, v129
    v_dot2c_f32_bf16 v164, s24, v130
    v_dot2c_f32_bf16 v166, v130, v130
    v_dot2c_f32_bf16 v165, s24, v131
    v_dot2c_f32_bf16 v167, v131, v131
    v_mfma_f32_32x32x16_bf16 v[84:99], a[60:63], v[160:163], v[84:99]
    ds_read_b64_tr_b16 v[156:157], v28 offset:22528
    ds_read_b64_tr_b16 v[158:159], v28 offset:22784
    v_add_f32 v164, v164, v165
    v_add_f32 v166, v166, v167
    v_lshlrev_b32 v26, 2, v0
    v_lshlrev_b32 v27, 2, v1
    v_mfma_f32_32x32x16_bf16 v[84:99], a[64:67], v[132:135], v[84:99]
    ds_read_b64_tr_b16 v[160:161], v28 offset:23552
    ds_read_b64_tr_b16 v[162:163], v28 offset:23808
    buffer_load_dwordx4 a[132:135], v2, s[4:7], s36 offen sc1
    v_permlane32_swap_b32 v164, v166
    v_add_f32 v164, v164, v166
    v_mfma_f32_32x32x16_bf16 v[84:99], a[68:71], v[136:139], v[84:99]
    ds_read_b64_tr_b16 v[132:133], v28 offset:24576
    ds_read_b64_tr_b16 v[134:135], v28 offset:24832
    ds_write_b32 v26, v164 offset:17152
    s_waitcnt lgkmcnt(9)
    v_mfma_f32_32x32x16_bf16 v[84:99], a[72:75], v[140:143], v[84:99]
    ds_read_b64_tr_b16 v[136:137], v28 offset:25600
    ds_read_b64_tr_b16 v[138:139], v28 offset:25856
    buffer_load_dwordx4 a[136:139], v23, s[4:7], s36 offen sc1
    s_add_u32 s36, s36, 4096
    v_mfma_f32_32x32x16_bf16 v[84:99], a[76:79], v[144:147], v[84:99]
    ds_read_b64_tr_b16 v[140:141], v28 offset:26624
    ds_read_b64_tr_b16 v[142:143], v28 offset:26880
    v_mfma_f32_32x32x16_bf16 v[84:99], a[80:83], v[148:151], v[84:99]
    ds_read_b64_tr_b16 v[144:145], v28 offset:27648
    ds_read_b64_tr_b16 v[146:147], v28 offset:27904
    buffer_load_dwordx4 a[140:143], v2, s[4:7], s36 offen sc1
    s_waitcnt lgkmcnt(9)
    v_mfma_f32_32x32x16_bf16 v[84:99], a[84:87], v[152:155], v[84:99]
    ds_read_b64_tr_b16 v[148:149], v28 offset:28672
    ds_read_b64_tr_b16 v[150:151], v28 offset:28928
    v_mfma_f32_32x32x16_bf16 v[84:99], a[88:91], v[156:159], v[84:99]
    ds_read_b64_tr_b16 v[152:153], v28 offset:29696
    ds_read_b64_tr_b16 v[154:155], v28 offset:29952
    buffer_load_dwordx4 a[144:147], v23, s[4:7], s36 offen sc1
    s_add_u32 s36, s36, 4096
    v_mfma_f32_32x32x16_bf16 v[84:99], a[92:95], v[160:163], v[84:99]
    ds_read_b64_tr_b16 v[156:157], v28 offset:30720
    ds_read_b64_tr_b16 v[158:159], v28 offset:30976
    s_waitcnt lgkmcnt(8)
    v_mfma_f32_32x32x16_bf16 v[84:99], a[96:99], v[132:135], v[84:99]
    ds_read_b64_tr_b16 v[160:161], v28 offset:31744
    ds_read_b64_tr_b16 v[162:163], v28 offset:32000
    buffer_load_dwordx4 a[148:151], v2, s[4:7], s36 offen sc1
    s_waitcnt vmcnt(13)
    s_barrier
    v_mfma_f32_32x32x16_bf16 v[84:99], a[100:103], v[136:139], v[84:99]
    ds_read_b64_tr_b16 v[132:133], v28 offset:32768
    ds_read_b64_tr_b16 v[134:135], v28 offset:33024
    ds_read_b32 v168, v27 offset:17152
    ds_read_b32 v169, v27 offset:17408
    ds_read_b32 v170, v27 offset:17664
    ds_read_b32 v171, v27 offset:17920
    v_mfma_f32_32x32x16_bf16 v[84:99], a[104:107], v[140:143], v[84:99]
    ds_read_b64_tr_b16 v[136:137], v28 offset:33792
    ds_read_b64_tr_b16 v[138:139], v28 offset:34048
    buffer_load_dwordx4 a[152:155], v23, s[4:7], s36 offen sc1
    s_add_u32 s36, s36, 4096
    s_waitcnt lgkmcnt(12)
    v_mfma_f32_32x32x16_bf16 v[84:99], a[108:111], v[144:147], v[84:99]
    ds_read_b64_tr_b16 v[140:141], v28 offset:34816
    ds_read_b64_tr_b16 v[142:143], v28 offset:35072
    v_mfma_f32_32x32x16_bf16 v[84:99], a[112:115], v[148:151], v[84:99]
    ds_read_b64_tr_b16 v[144:145], v28 offset:35840
    ds_read_b64_tr_b16 v[146:147], v28 offset:36096
    buffer_load_dwordx4 a[156:159], v2, s[4:7], s36 offen sc1
    v_mfma_f32_32x32x16_bf16 v[84:99], a[116:119], v[152:155], v[84:99]
    ds_read_b64_tr_b16 v[148:149], v28 offset:36864
    ds_read_b64_tr_b16 v[150:151], v28 offset:37120
    s_waitcnt lgkmcnt(8)
    v_add_f32 v168, v168, v169
    v_add_f32 v170, v170, v171
    v_add_f32 v168, v168, v170
    v_mfma_f32_32x32x16_bf16 v[84:99], a[120:123], v[156:159], v[84:99]
    ds_read_b64_tr_b16 v[152:153], v28 offset:37888
    ds_read_b64_tr_b16 v[154:155], v28 offset:38144
    buffer_load_dwordx4 a[160:163], v23, s[4:7], s36 offen sc1
    s_add_u32 s36, s36, 4096
    v_mul_f32 v164, s16, v168
    v_mul_f32 v165, s16, v168
    v_mfma_f32_32x32x16_bf16 v[84:99], a[124:127], v[160:163], v[84:99]
    ds_read_b64_tr_b16 v[156:157], v28 offset:38912
    ds_read_b64_tr_b16 v[158:159], v28 offset:39168
    v_mov_b32 v168, 0
    v_mov_b32 v169, 0
    v_mov_b32 v170, 0
    v_permlane32_swap_b32 v164, v165
    v_mfma_f32_32x32x16_bf16 v[100:115], a[0:3], v[132:135], 0
    ds_read_b64_tr_b16 v[160:161], v28 offset:39936
    ds_read_b64_tr_b16 v[162:163], v28 offset:40192
    buffer_load_dwordx4 a[164:167], v2, s[4:7], s36 offen sc1
    v_fma_f32 v165, -v164, v164, v165
    v_cvt_pk_bf16_f32 v171, v164, v164
    s_waitcnt lgkmcnt(8)
    v_mfma_f32_32x32x16_bf16 v[100:115], a[4:7], v[136:139], v[100:115]
    ds_read_b64_tr_b16 v[132:133], v28 offset:40960
    ds_read_b64_tr_b16 v[134:135], v28 offset:41216
    v_max_f32 v165, 0, v165
    v_add_f32 v174, s18, v165
    v_rsq_f32 v164, v174
    v_mfma_f32_32x32x16_bf16 v[84:99], a[128:131], v[168:171], v[84:99]
    v_mfma_f32_32x32x16_bf16 v[100:115], a[8:11], v[140:143], v[100:115]
    ds_read_b64_tr_b16 v[136:137], v28 offset:41984
    ds_read_b64_tr_b16 v[138:139], v28 offset:42240
    buffer_load_dwordx4 a[168:171], v23, s[4:7], s36 offen sc1
    s_add_u32 s36, s36, 4096
    v_mul_f32 v173, 0xc0135761, v164
    v_mul_f32 v172, v164, v164
    v_mfma_f32_32x32x16_bf16 v[100:115], a[12:15], v[144:147], v[100:115]
    ds_read_b64_tr_b16 v[140:141], v28 offset:43008
    ds_read_b64_tr_b16 v[142:143], v28 offset:43264
    v_mul_f32 v165, 0xbdd2d3e8, v164
    v_mul_f32 v172, v172, v165
    s_waitcnt lgkmcnt(8)
    v_mfma_f32_32x32x16_bf16 v[100:115], a[16:19], v[148:151], v[100:115]
    ds_read_b64_tr_b16 v[144:145], v28 offset:44032
    ds_read_b64_tr_b16 v[146:147], v28 offset:44288
    buffer_load_dwordx4 a[172:175], v2, s[4:7], s36 offen sc1
    s_add_u32 s37, s27, 16023552
    v_mov_b32 v20, 0
    buffer_atomic_add v20, v19, s[4:7], s37 offen sc0 sc1
    v_mfma_f32_32x32x16_bf16 v[100:115], a[20:23], v[152:155], v[100:115]
    ds_read_b64_tr_b16 v[148:149], v28 offset:45056
    ds_read_b64_tr_b16 v[150:151], v28 offset:45312
    v_mfma_f32_32x32x16_bf16 v[100:115], a[24:27], v[156:159], v[100:115]
    ds_read_b64_tr_b16 v[152:153], v28 offset:46080
    ds_read_b64_tr_b16 v[154:155], v28 offset:46336
    v_mul_f32 v164, v84, v84
    v_fma_f32 v164, v164, v172, v173
    v_mul_f32 v165, v85, v85
    v_mul_f32 v164, v164, v84
    s_waitcnt lgkmcnt(8)
    v_mfma_f32_32x32x16_bf16 v[100:115], a[28:31], v[160:163], v[100:115]
    ds_read_b64_tr_b16 v[156:157], v28 offset:47104
    ds_read_b64_tr_b16 v[158:159], v28 offset:47360
    v_fma_f32 v165, v165, v172, v173
    v_mul_f32 v166, v86, v86
    v_exp_f32 v164, v164
    v_mul_f32 v165, v165, v85
    v_mfma_f32_32x32x16_bf16 v[100:115], a[32:35], v[132:135], v[100:115]
    ds_read_b64_tr_b16 v[160:161], v28 offset:48128
    ds_read_b64_tr_b16 v[162:163], v28 offset:48384
    v_fma_f32 v166, v166, v172, v173
    v_mul_f32 v167, v87, v87
    v_mul_f32 v84, v84, v92
    v_exp_f32 v165, v165
    v_mfma_f32_32x32x16_bf16 v[100:115], a[36:39], v[136:139], v[100:115]
    ds_read_b64_tr_b16 v[132:133], v28 offset:49152
    ds_read_b64_tr_b16 v[134:135], v28 offset:49408
    v_mul_f32 v166, v166, v86
    v_fma_f32 v167, v167, v172, v173
    v_mul_f32 v168, v88, v88
    v_fma_f32 v164, v164, v174, v174
    s_waitcnt lgkmcnt(8)
    v_mfma_f32_32x32x16_bf16 v[100:115], a[40:43], v[140:143], v[100:115]
    ds_read_b64_tr_b16 v[136:137], v28 offset:50176
    ds_read_b64_tr_b16 v[138:139], v28 offset:50432
    v_mul_f32 v85, v85, v93
    v_exp_f32 v166, v166
    v_mul_f32 v167, v167, v87
    v_fma_f32 v168, v168, v172, v173
    v_mfma_f32_32x32x16_bf16 v[100:115], a[44:47], v[144:147], v[100:115]
    ds_read_b64_tr_b16 v[140:141], v28 offset:51200
    ds_read_b64_tr_b16 v[142:143], v28 offset:51456
    v_mul_f32 v169, v89, v89
    v_rcp_f32 v164, v164
    v_fma_f32 v165, v165, v174, v174
    v_mul_f32 v86, v86, v94
    v_mfma_f32_32x32x16_bf16 v[100:115], a[48:51], v[148:151], v[100:115]
    ds_read_b64_tr_b16 v[144:145], v28 offset:52224
    ds_read_b64_tr_b16 v[146:147], v28 offset:52480
    v_exp_f32 v167, v167
    v_mul_f32 v168, v168, v88
    v_fma_f32 v169, v169, v172, v173
    s_waitcnt lgkmcnt(8)
    v_mfma_f32_32x32x16_bf16 v[100:115], a[52:55], v[152:155], v[100:115]
    ds_read_b64_tr_b16 v[148:149], v28 offset:53248
    ds_read_b64_tr_b16 v[150:151], v28 offset:53504
    v_mul_f32 v170, v90, v90
    v_rcp_f32 v165, v165
    v_fma_f32 v166, v166, v174, v174
    v_mul_f32 v87, v87, v95
    v_mfma_f32_32x32x16_bf16 v[100:115], a[56:59], v[156:159], v[100:115]
    ds_read_b64_tr_b16 v[152:153], v28 offset:54272
    ds_read_b64_tr_b16 v[154:155], v28 offset:54528
    v_exp_f32 v168, v168
    v_mul_f32 v169, v169, v89
    v_fma_f32 v170, v170, v172, v173
    v_mul_f32 v171, v91, v91
    v_mfma_f32_32x32x16_bf16 v[100:115], a[60:63], v[160:163], v[100:115]
    ds_read_b64_tr_b16 v[156:157], v28 offset:55296
    ds_read_b64_tr_b16 v[158:159], v28 offset:55552
    v_mul_f32 v84, v84, v164
    v_rcp_f32 v166, v166
    v_fma_f32 v167, v167, v174, v174
    s_waitcnt lgkmcnt(8)
    v_mfma_f32_32x32x16_bf16 v[100:115], a[64:67], v[132:135], v[100:115]
    ds_read_b64_tr_b16 v[160:161], v28 offset:56320
    ds_read_b64_tr_b16 v[162:163], v28 offset:56576
    v_mul_f32 v88, v88, v96
    v_exp_f32 v169, v169
    v_mul_f32 v170, v170, v90
    v_fma_f32 v171, v171, v172, v173
    v_mfma_f32_32x32x16_bf16 v[100:115], a[68:71], v[136:139], v[100:115]
    ds_read_b64_tr_b16 v[132:133], v28 offset:57344
    ds_read_b64_tr_b16 v[134:135], v28 offset:57600
    v_mul_f32 v85, v85, v165
    v_rcp_f32 v167, v167
    v_fma_f32 v168, v168, v174, v174
    v_mul_f32 v89, v89, v97
    v_mfma_f32_32x32x16_bf16 v[100:115], a[72:75], v[140:143], v[100:115]
    ds_read_b64_tr_b16 v[136:137], v28 offset:58368
    ds_read_b64_tr_b16 v[138:139], v28 offset:58624
    v_exp_f32 v170, v170
    v_mul_f32 v171, v171, v91
    v_mul_f32 v86, v86, v166
    s_waitcnt lgkmcnt(8)
    v_mfma_f32_32x32x16_bf16 v[100:115], a[76:79], v[144:147], v[100:115]
    ds_read_b64_tr_b16 v[140:141], v28 offset:59392
    ds_read_b64_tr_b16 v[142:143], v28 offset:59648
    v_rcp_f32 v168, v168
    v_fma_f32 v169, v169, v174, v174
    v_mul_f32 v90, v90, v98
    v_mfma_f32_32x32x16_bf16 v[100:115], a[80:83], v[148:151], v[100:115]
    ds_read_b64_tr_b16 v[144:145], v28 offset:60416
    ds_read_b64_tr_b16 v[146:147], v28 offset:60672
    v_exp_f32 v171, v171
    v_mul_f32 v87, v87, v167
    v_rcp_f32 v169, v169
    v_mfma_f32_32x32x16_bf16 v[100:115], a[84:87], v[152:155], v[100:115]
    ds_read_b64_tr_b16 v[148:149], v28 offset:61440
    ds_read_b64_tr_b16 v[150:151], v28 offset:61696
    v_fma_f32 v170, v170, v174, v174
    v_mul_f32 v91, v91, v99
    v_mul_f32 v88, v88, v168
    s_waitcnt lgkmcnt(8)
    v_mfma_f32_32x32x16_bf16 v[100:115], a[88:91], v[156:159], v[100:115]
    ds_read_b64_tr_b16 v[152:153], v28 offset:62464
    ds_read_b64_tr_b16 v[154:155], v28 offset:62720
    s_waitcnt vmcnt(0)
    v_cmp_gt_u32 vcc, 16, v20
    s_nop 0
    s_and_b64 vcc, vcc, s[54:55]
    s_cbranch_scc1 mk_ps13
mk_po14:
    s_barrier
    s_mul_i32 s35, s20, 98304
    s_add_u32 s35, s35, s41
    s_add_u32 s35, s35, 5242880
    s_add_u32 s35, s35, s44
    v_mfma_f32_32x32x16_bf16 v[100:115], a[92:95], v[160:163], v[100:115]
    ds_read_b64_tr_b16 v[156:157], v28 offset:63488
    ds_read_b64_tr_b16 v[158:159], v28 offset:63744
    s_mul_i32 s39, s20, 1536
    s_add_u32 s39, s39, 15892480
    buffer_load_dwordx4 v[176:179], v30, s[4:7], s39 offen offset:512 sc1
    v_mfma_f32_32x32x16_bf16 v[100:115], a[96:99], v[132:135], v[100:115]
    ds_read_b64_tr_b16 v[160:161], v28 offset:64512
    ds_read_b64_tr_b16 v[162:163], v28 offset:64768
    s_add_u32 m0, s41, 131072
    s_nop 0
    buffer_load_dwordx4 v2, s[4:7], s35 offen offset:0 sc1 lds
    s_barrier
    s_waitcnt lgkmcnt(8)
    v_mfma_f32_32x32x16_bf16 v[100:115], a[100:103], v[136:139], v[100:115]
    ds_read_b64_tr_b16 v[132:133], v29 offset:0
    ds_read_b64_tr_b16 v[134:135], v29 offset:256
    v_rcp_f32 v170, v170
    v_fma_f32 v171, v171, v174, v174
    v_mul_f32 v89, v89, v169
    v_mfma_f32_32x32x16_bf16 v[100:115], a[104:107], v[140:143], v[100:115]
    ds_read_b64_tr_b16 v[136:137], v29 offset:1024
    ds_read_b64_tr_b16 v[138:139], v29 offset:1280
    buffer_load_dwordx4 v2, s[4:7], s35 offen offset:1024 sc1 lds
    v_rcp_f32 v171, v171
    v_mul_f32 v90, v90, v170
    v_mfma_f32_32x32x16_bf16 v[100:115], a[108:111], v[144:147], v[100:115]
    ds_read_b64_tr_b16 v[140:141], v29 offset:2048
    ds_read_b64_tr_b16 v[142:143], v29 offset:2304
    v_mul_f32 v91, v91, v171
    v_cvt_pk_bf16_f32 v92, v84, v85
    v_cvt_pk_bf16_f32 v93, v86, v87
    v_cvt_pk_bf16_f32 v94, v88, v89
    s_waitcnt lgkmcnt(8)
    v_mfma_f32_32x32x16_bf16 v[100:115], a[112:115], v[148:151], v[100:115]
    ds_read_b64_tr_b16 v[144:145], v29 offset:3072
    ds_read_b64_tr_b16 v[146:147], v29 offset:3328
    buffer_load_dwordx4 v2, s[4:7], s35 offen offset:2048 sc1 lds
    v_cvt_pk_bf16_f32 v95, v90, v91
    v_mfma_f32_32x32x16_bf16 v[100:115], a[116:119], v[152:155], v[100:115]
    ds_read_b64_tr_b16 v[148:149], v29 offset:4096
    ds_read_b64_tr_b16 v[150:151], v29 offset:4352
    s_mul_i32 s43, s20, 270336
    s_lshl_b32 s32, s21, 10
    s_add_u32 s43, s43, s32
    s_add_u32 s43, s43, 25165824
    buffer_store_dwordx4 v[92:95], v2, s[4:7], s43 offen sc1
    s_add_u32 s43, s43, 90112
    v_mfma_f32_32x32x16_bf16 v[100:115], a[120:123], v[156:159], v[100:115]
    ds_read_b64_tr_b16 v[152:153], v29 offset:5120
    ds_read_b64_tr_b16 v[154:155], v29 offset:5376
    buffer_load_dwordx4 v2, s[4:7], s35 offen offset:3072 sc1 lds
    s_add_u32 s35, s35, 16384
    s_waitcnt lgkmcnt(8)
    v_mfma_f32_32x32x16_bf16 v[100:115], a[124:127], v[160:163], v[100:115]
    ds_read_b64_tr_b16 v[156:157], v29 offset:6144
    ds_read_b64_tr_b16 v[158:159], v29 offset:6400
    v_mfma_f32_32x32x16_bf16 v[116:131], a[0:3], v[132:135], 0
    ds_read_b64_tr_b16 v[160:161], v29 offset:7168
    ds_read_b64_tr_b16 v[162:163], v29 offset:7424
    s_add_u32 m0, s41, 147456
    s_nop 0
    buffer_load_dwordx4 v2, s[4:7], s35 offen offset:0 sc1 lds
    v_mfma_f32_32x32x16_bf16 v[116:131], a[4:7], v[136:139], v[116:131]
    ds_read_b64_tr_b16 v[132:133], v29 offset:8192
    ds_read_b64_tr_b16 v[134:135], v29 offset:8448
    s_waitcnt lgkmcnt(8)
    v_mfma_f32_32x32x16_bf16 v[116:131], a[8:11], v[140:143], v[116:131]
    ds_read_b64_tr_b16 v[136:137], v29 offset:9216
    ds_read_b64_tr_b16 v[138:139], v29 offset:9472
    buffer_load_dwordx4 v2, s[4:7], s35 offen offset:1024 sc1 lds
    v_mfma_f32_32x32x16_bf16 v[116:131], a[12:15], v[144:147], v[116:131]
    ds_read_b64_tr_b16 v[140:141], v29 offset:10240
    ds_read_b64_tr_b16 v[142:143], v29 offset:10496
    v_mfma_f32_32x32x16_bf16 v[116:131], a[16:19], v[148:151], v[116:131]
    ds_read_b64_tr_b16 v[144:145], v29 offset:11264
    ds_read_b64_tr_b16 v[146:147], v29 offset:11520
    buffer_load_dwordx4 v2, s[4:7], s35 offen offset:2048 sc1 lds
    s_waitcnt vmcnt(8)
    v_cmp_eq_u32 vcc, 0, v176
    s_cbranch_vccnz mk_qs16
mk_qo17:
    v_mfma_f32_32x32x16_bf16 v[100:115], a[128:131], v[176:179], v[100:115]
    s_waitcnt lgkmcnt(8)
    v_mfma_f32_32x32x16_bf16 v[116:131], a[20:23], v[152:155], v[116:131]
    ds_read_b64_tr_b16 v[148:149], v29 offset:12288
    ds_read_b64_tr_b16 v[150:151], v29 offset:12544
    v_mfma_f32_32x32x16_bf16 v[116:131], a[24:27], v[156:159], v[116:131]
    ds_read_b64_tr_b16 v[152:153], v29 offset:13312
    ds_read_b64_tr_b16 v[154:155], v29 offset:13568
    buffer_load_dwordx4 v2, s[4:7], s35 offen offset:3072 sc1 lds
    s_add_u32 s35, s35, 16384
    v_mfma_f32_32x32x16_bf16 v[116:131], a[28:31], v[160:163], v[116:131]
    ds_read_b64_tr_b16 v[156:157], v29 offset:14336
    ds_read_b64_tr_b16 v[158:159], v29 offset:14592
    v_mul_f32 v164, v100, v100
    v_fma_f32 v164, v164, v176, v177
    v_mul_f32 v165, v101, v101
    v_mul_f32 v164, v164, v100
    s_waitcnt lgkmcnt(8)
    v_mfma_f32_32x32x16_bf16 v[116:131], a[32:35], v[132:135], v[116:131]
    ds_read_b64_tr_b16 v[160:161], v29 offset:15360
    ds_read_b64_tr_b16 v[162:163], v29 offset:15616
    s_add_u32 m0, s41, 32768
    s_nop 0
    buffer_load_dwordx4 v2, s[4:7], s35 offen offset:0 sc1 lds
    v_fma_f32 v165, v165, v176, v177
    v_mul_f32 v166, v102, v102
    v_mfma_f32_32x32x16_bf16 v[116:131], a[36:39], v[136:139], v[116:131]
    ds_read_b64_tr_b16 v[132:133], v29 offset:16384
    ds_read_b64_tr_b16 v[134:135], v29 offset:16640
    v_exp_f32 v164, v164
    v_mul_f32 v165, v165, v101
    v_fma_f32 v166, v166, v176, v177
    v_mul_f32 v167, v103, v103
    v_mfma_f32_32x32x16_bf16 v[116:131], a[40:43], v[140:143], v[116:131]
    ds_read_b64_tr_b16 v[136:137], v29 offset:17408
    ds_read_b64_tr_b16 v[138:139], v29 offset:17664
    buffer_load_dwordx4 v2, s[4:7], s35 offen offset:1024 sc1 lds
    v_mul_f32 v100, v100, v108
    s_waitcnt lgkmcnt(8)
    v_mfma_f32_32x32x16_bf16 v[116:131], a[44:47], v[144:147], v[116:131]
    ds_read_b64_tr_b16 v[140:141], v29 offset:18432
    ds_read_b64_tr_b16 v[142:143], v29 offset:18688
    v_exp_f32 v165, v165
    v_mul_f32 v166, v166, v102
    v_fma_f32 v167, v167, v176, v177
    v_mul_f32 v168, v104, v104
    v_mfma_f32_32x32x16_bf16 v[116:131], a[48:51], v[148:151], v[116:131]
    ds_read_b64_tr_b16 v[144:145], v29 offset:19456
    ds_read_b64_tr_b16 v[146:147], v29 offset:19712
    buffer_load_dwordx4 v2, s[4:7], s35 offen offset:2048 sc1 lds
    v_fma_f32 v164, v164, v178, v178
    v_mul_f32 v101, v101, v109
    v_mfma_f32_32x32x16_bf16 v[116:131], a[52:55], v[152:155], v[116:131]
    ds_read_b64_tr_b16 v[148:149], v29 offset:20480
    ds_read_b64_tr_b16 v[150:151], v29 offset:20736
    v_exp_f32 v166, v166
    v_mul_f32 v167, v167, v103
    v_fma_f32 v168, v168, v176, v177
    s_waitcnt lgkmcnt(8)
    v_mfma_f32_32x32x16_bf16 v[116:131], a[56:59], v[156:159], v[116:131]
    ds_read_b64_tr_b16 v[152:153], v29 offset:21504
    ds_read_b64_tr_b16 v[154:155], v29 offset:21760
    buffer_load_dwordx4 v2, s[4:7], s35 offen offset:3072 sc1 lds
    s_add_u32 s35, s35, 16384
    v_mul_f32 v169, v105, v105
    v_mfma_f32_32x32x16_bf16 v[116:131], a[60:63], v[160:163], v[116:131]
    ds_read_b64_tr_b16 v[156:157], v29 offset:22528
    ds_read_b64_tr_b16 v[158:159], v29 offset:22784
    buffer_load_dwordx4 v[180:183], v30, s[4:7], s39 offen offset:1024 sc1
    v_rcp_f32 v164, v164
    v_fma_f32 v165, v165, v178, v178
    v_mfma_f32_32x32x16_bf16 v[116:131], a[64:67], v[132:135], v[116:131]
    ds_read_b64_tr_b16 v[160:161], v29 offset:23552
    ds_read_b64_tr_b16 v[162:163], v29 offset:23808
    s_add_u32 m0, s41, 49152
    s_nop 0
    buffer_load_dwordx4 v2, s[4:7], s35 offen offset:0 sc1 lds
    v_mul_f32 v102, v102, v110
    s_waitcnt lgkmcnt(8)
    v_mfma_f32_32x32x16_bf16 v[116:131], a[68:71], v[136:139], v[116:131]
    ds_read_b64_tr_b16 v[132:133], v29 offset:24576
    ds_read_b64_tr_b16 v[134:135], v29 offset:24832
    v_exp_f32 v167, v167
    v_mul_f32 v168, v168, v104
    v_fma_f32 v169, v169, v176, v177
    v_mul_f32 v170, v106, v106
    v_mfma_f32_32x32x16_bf16 v[116:131], a[72:75], v[140:143], v[116:131]
    ds_read_b64_tr_b16 v[136:137], v29 offset:25600
    ds_read_b64_tr_b16 v[138:139], v29 offset:25856
    buffer_load_dwordx4 v2, s[4:7], s35 offen offset:1024 sc1 lds
    v_rcp_f32 v165, v165
    v_fma_f32 v166, v166, v178, v178
    v_mfma_f32_32x32x16_bf16 v[116:131], a[76:79], v[144:147], v[116:131]
    ds_read_b64_tr_b16 v[140:141], v29 offset:26624
    ds_read_b64_tr_b16 v[142:143], v29 offset:26880
    v_mul_f32 v103, v103, v111
    v_exp_f32 v168, v168
    v_mul_f32 v169, v169, v105
    s_waitcnt lgkmcnt(8)
    v_mfma_f32_32x32x16_bf16 v[116:131], a[80:83], v[148:151], v[116:131]
    ds_read_b64_tr_b16 v[144:145], v29 offset:27648
    ds_read_b64_tr_b16 v[146:147], v29 offset:27904
    buffer_load_dwordx4 v2, s[4:7], s35 offen offset:2048 sc1 lds
    v_fma_f32 v170, v170, v176, v177
    v_mul_f32 v171, v107, v107
    v_mul_f32 v100, v100, v164
    v_mfma_f32_32x32x16_bf16 v[116:131], a[84:87], v[152:155], v[116:131]
    ds_read_b64_tr_b16 v[148:149], v29 offset:28672
    ds_read_b64_tr_b16 v[150:151], v29 offset:28928
    v_rcp_f32 v166, v166
    v_fma_f32 v167, v167, v178, v178
    v_mul_f32 v104, v104, v112
    v_mfma_f32_32x32x16_bf16 v[116:131], a[88:91], v[156:159], v[116:131]
    ds_read_b64_tr_b16 v[152:153], v29 offset:29696
    ds_read_b64_tr_b16 v[154:155], v29 offset:29952
    buffer_load_dwordx4 v2, s[4:7], s35 offen offset:3072 sc1 lds
    s_add_u32 s35, s35, 16384
    s_waitcnt lgkmcnt(8)
    v_mfma_f32_32x32x16_bf16 v[116:131], a[92:95], v[160:163], v[116:131]
    ds_read_b64_tr_b16 v[156:157], v29 offset:30720
    ds_read_b64_tr_b16 v[158:159], v29 offset:30976
    v_exp_f32 v169, v169
    v_mul_f32 v170, v170, v106
    v_fma_f32 v171, v171, v176, v177
    v_mul_f32 v101, v101, v165
    v_mfma_f32_32x32x16_bf16 v[116:131], a[96:99], v[132:135], v[116:131]
    ds_read_b64_tr_b16 v[160:161], v29 offset:31744
    ds_read_b64_tr_b16 v[162:163], v29 offset:32000
    buffer_load_dwordx4 a[176:179], v23, s[4:7], s36 offen sc1
    s_add_u32 s36, s36, 4096
    v_rcp_f32 v167, v167
    s_waitcnt vmcnt(10)
    s_barrier
    v_mfma_f32_32x32x16_bf16 v[116:131], a[100:103], v[136:139], v[116:131]
    ds_read_b64_tr_b16 v[132:133], v29 offset:32768
    ds_read_b64_tr_b16 v[134:135], v29 offset:33024
    v_fma_f32 v168, v168, v178, v178
    v_mul_f32 v105, v105, v113
    v_exp_f32 v170, v170
    s_waitcnt lgkmcnt(8)
    v_mfma_f32_32x32x16_bf16 v[116:131], a[104:107], v[140:143], v[116:131]
    ds_read_b64_tr_b16 v[136:137], v29 offset:33792
    ds_read_b64_tr_b16 v[138:139], v29 offset:34048
    s_cmp_eq_u32 s20, 10
    s_cselect_b32 s35, 2146435072, s35
    s_add_u32 m0, s41, 65536
    s_nop 0
    buffer_load_dwordx4 v2, s[4:7], s35 offen offset:0 sc1 lds
    v_mfma_f32_32x32x16_bf16 v[116:131], a[108:111], v[144:147], v[116:131]
    ds_read_b64_tr_b16 v[140:141], v29 offset:34816
    ds_read_b64_tr_b16 v[142:143], v29 offset:35072
    v_mul_f32 v171, v171, v107
    v_mul_f32 v102, v102, v166
    v_rcp_f32 v168, v168
    v_fma_f32 v169, v169, v178, v178
    v_mfma_f32_32x32x16_bf16 v[116:131], a[112:115], v[148:151], v[116:131]
    ds_read_b64_tr_b16 v[144:145], v29 offset:35840
    ds_read_b64_tr_b16 v[146:147], v29 offset:36096
    buffer_load_dwordx4 v2, s[4:7], s35 offen offset:1024 sc1 lds
    s_waitcnt vmcnt(7)
    v_cmp_eq_u32 vcc, 0, v180
    s_cbranch_vccnz mk_qs19
mk_qo20:
    v_mfma_f32_32x32x16_bf16 v[116:131], a[128:131], v[180:183], v[116:131]
    s_waitcnt lgkmcnt(8)
    v_mfma_f32_32x32x16_bf16 v[116:131], a[116:119], v[152:155], v[116:131]
    ds_read_b64_tr_b16 v[148:149], v29 offset:36864
    ds_read_b64_tr_b16 v[150:151], v29 offset:37120
    v_mul_f32 v106, v106, v114
    v_exp_f32 v171, v171
    v_mul_f32 v103, v103, v167
    v_mfma_f32_32x32x16_bf16 v[116:131], a[120:123], v[156:159], v[116:131]
    ds_read_b64_tr_b16 v[152:153], v29 offset:37888
    ds_read_b64_tr_b16 v[154:155], v29 offset:38144
    buffer_load_dwordx4 v2, s[4:7], s35 offen offset:2048 sc1 lds
    v_rcp_f32 v169, v169
    v_fma_f32 v170, v170, v178, v178
    v_mfma_f32_32x32x16_bf16 v[116:131], a[124:127], v[160:163], v[116:131]
    ds_read_b64_tr_b16 v[156:157], v29 offset:38912
    ds_read_b64_tr_b16 v[158:159], v29 offset:39168
    v_mul_f32 v107, v107, v115
    v_mul_f32 v104, v104, v168
    v_rcp_f32 v170, v170
    s_waitcnt lgkmcnt(8)
    v_mfma_f32_32x32x16_bf16 v[84:99], a[0:3], v[132:135], 0
    ds_read_b64_tr_b16 v[160:161], v29 offset:39936
    ds_read_b64_tr_b16 v[162:163], v29 offset:40192
    buffer_load_dwordx4 v2, s[4:7], s35 offen offset:3072 sc1 lds
    s_add_u32 s35, s35, 16384
    v_fma_f32 v171, v171, v178, v178
    v_mul_f32 v105, v105, v169
    v_mfma_f32_32x32x16_bf16 v[84:99], a[4:7], v[136:139], v[84:99]
    ds_read_b64_tr_b16 v[132:133], v29 offset:40960
    ds_read_b64_tr_b16 v[134:135], v29 offset:41216
    v_rcp_f32 v171, v171
    v_mul_f32 v106, v106, v170
    v_mul_f32 v107, v107, v171
    v_cvt_pk_bf16_f32 v108, v100, v101
    v_mfma_f32_32x32x16_bf16 v[84:99], a[8:11], v[140:143], v[84:99]
    ds_read_b64_tr_b16 v[136:137], v29 offset:41984
    ds_read_b64_tr_b16 v[138:139], v29 offset:42240
    s_add_u32 m0, s41, 81920
    s_nop 0
    buffer_load_dwordx4 v2, s[4:7], s35 offen offset:0 sc1 lds
    v_cvt_pk_bf16_f32 v109, v102, v103
    s_waitcnt lgkmcnt(8)
    v_mfma_f32_32x32x16_bf16 v[84:99], a[12:15], v[144:147], v[84:99]
    ds_read_b64_tr_b16 v[140:141], v29 offset:43008
    ds_read_b64_tr_b16 v[142:143], v29 offset:43264
    v_cvt_pk_bf16_f32 v110, v104, v105
    v_cvt_pk_bf16_f32 v111, v106, v107
    v_mfma_f32_32x32x16_bf16 v[84:99], a[16:19], v[148:151], v[84:99]
    ds_read_b64_tr_b16 v[144:145], v29 offset:44032
    ds_read_b64_tr_b16 v[146:147], v29 offset:44288
    buffer_load_dwordx4 v2, s[4:7], s35 offen offset:1024 sc1 lds
    v_mfma_f32_32x32x16_bf16 v[84:99], a[20:23], v[152:155], v[84:99]
    ds_read_b64_tr_b16 v[148:149], v29 offset:45056
    ds_read_b64_tr_b16 v[150:151], v29 offset:45312
    buffer_store_dwordx4 v[108:111], v2, s[4:7], s43 offen sc1
    s_add_u32 s43, s43, 90112
    s_waitcnt lgkmcnt(8)
    v_mfma_f32_32x32x16_bf16 v[84:99], a[24:27], v[156:159], v[84:99]
    ds_read_b64_tr_b16 v[152:153], v29 offset:46080
    ds_read_b64_tr_b16 v[154:155], v29 offset:46336
    buffer_load_dwordx4 v2, s[4:7], s35 offen offset:2048 sc1 lds
    v_mul_f32 v164, v116, v116
    v_fma_f32 v164, v164, v180, v181
    v_mul_f32 v165, v117, v117
    v_mfma_f32_32x32x16_bf16 v[84:99], a[28:31], v[160:163], v[84:99]
    ds_read_b64_tr_b16 v[156:157], v29 offset:47104
    ds_read_b64_tr_b16 v[158:159], v29 offset:47360
    v_mul_f32 v164, v164, v116
    v_fma_f32 v165, v165, v180, v181
    v_mul_f32 v166, v118, v118
    v_exp_f32 v164, v164
    v_mfma_f32_32x32x16_bf16 v[84:99], a[32:35], v[132:135], v[84:99]
    ds_read_b64_tr_b16 v[160:161], v29 offset:48128
    ds_read_b64_tr_b16 v[162:163], v29 offset:48384
    buffer_load_dwordx4 v2, s[4:7], s35 offen offset:3072 sc1 lds
    s_add_u32 s35, s35, 16384
    v_mul_f32 v165, v165, v117
    s_waitcnt lgkmcnt(8)
    v_mfma_f32_32x32x16_bf16 v[84:99], a[36:39], v[136:139], v[84:99]
    ds_read_b64_tr_b16 v[132:133], v29 offset:49152
    ds_read_b64_tr_b16 v[134:135], v29 offset:49408
    v_fma_f32 v166, v166, v180, v181
    v_mul_f32 v167, v119, v119
    v_mul_f32 v116, v116, v124
    v_exp_f32 v165, v165
    v_mfma_f32_32x32x16_bf16 v[84:99], a[40:43], v[140:143], v[84:99]
    ds_read_b64_tr_b16 v[136:137], v29 offset:50176
    ds_read_b64_tr_b16 v[138:139], v29 offset:50432
    buffer_load_dwordx4 a[180:183], v2, s[4:7], s36 offen sc1
    v_mul_f32 v166, v166, v118
    v_fma_f32 v167, v167, v180, v181
    v_mul_f32 v168, v120, v120
    v_mfma_f32_32x32x16_bf16 v[84:99], a[44:47], v[144:147], v[84:99]
    ds_read_b64_tr_b16 v[140:141], v29 offset:51200
    ds_read_b64_tr_b16 v[142:143], v29 offset:51456
    v_fma_f32 v164, v164, v182, v182
    v_mul_f32 v117, v117, v125
    v_exp_f32 v166, v166
    s_waitcnt lgkmcnt(8)
    v_mfma_f32_32x32x16_bf16 v[84:99], a[48:51], v[148:151], v[84:99]
    ds_read_b64_tr_b16 v[144:145], v29 offset:52224
    ds_read_b64_tr_b16 v[146:147], v29 offset:52480
    buffer_load_dwordx4 a[184:187], v23, s[4:7], s36 offen sc1
    s_add_u32 s36, s36, 4096
    v_mul_f32 v167, v167, v119
    v_fma_f32 v168, v168, v180, v181
    v_mfma_f32_32x32x16_bf16 v[84:99], a[52:55], v[152:155], v[84:99]
    ds_read_b64_tr_b16 v[148:149], v29 offset:53248
    ds_read_b64_tr_b16 v[150:151], v29 offset:53504
    v_mul_f32 v169, v121, v121
    v_rcp_f32 v164, v164
    v_fma_f32 v165, v165, v182, v182
    v_mul_f32 v118, v118, v126
    v_mfma_f32_32x32x16_bf16 v[84:99], a[56:59], v[156:159], v[84:99]
    ds_read_b64_tr_b16 v[152:153], v29 offset:54272
    ds_read_b64_tr_b16 v[154:155], v29 offset:54528
    buffer_load_dwordx4 a[188:191], v2, s[4:7], s36 offen sc1
    v_exp_f32 v167, v167
    s_waitcnt lgkmcnt(8)
    v_mfma_f32_32x32x16_bf16 v[84:99], a[60:63], v[160:163], v[84:99]
    ds_read_b64_tr_b16 v[156:157], v29 offset:55296
    ds_read_b64_tr_b16 v[158:159], v29 offset:55552
    v_mul_f32 v168, v168, v120
    v_fma_f32 v169, v169, v180, v181
    v_mul_f32 v170, v122, v122
    v_rcp_f32 v165, v165
    v_mfma_f32_32x32x16_bf16 v[84:99], a[64:67], v[132:135], v[84:99]
    ds_read_b64_tr_b16 v[160:161], v29 offset:56320
    ds_read_b64_tr_b16 v[162:163], v29 offset:56576
    buffer_load_dwordx4 a[192:195], v23, s[4:7], s36 offen sc1
    s_add_u32 s36, s36, 4096
    v_fma_f32 v166, v166, v182, v182
    v_mul_f32 v119, v119, v127
    v_mfma_f32_32x32x16_bf16 v[84:99], a[68:71], v[136:139], v[84:99]
    ds_read_b64_tr_b16 v[132:133], v29 offset:57344
    ds_read_b64_tr_b16 v[134:135], v29 offset:57600
    v_exp_f32 v168, v168
    v_mul_f32 v169, v169, v121
    v_fma_f32 v170, v170, v180, v181
    s_waitcnt lgkmcnt(8)
    v_mfma_f32_32x32x16_bf16 v[84:99], a[72:75], v[140:143], v[84:99]
    ds_read_b64_tr_b16 v[136:137], v29 offset:58368
    ds_read_b64_tr_b16 v[138:139], v29 offset:58624
    buffer_load_dwordx4 a[196:199], v2, s[4:7], s36 offen sc1
    v_mul_f32 v171, v123, v123
    v_mul_f32 v116, v116, v164
    v_mfma_f32_32x32x16_bf16 v[84:99], a[76:79], v[144:147], v[84:99]
    ds_read_b64_tr_b16 v[140:141], v29 offset:59392
    ds_read_b64_tr_b16 v[142:143], v29 offset:59648
    s_mul_i32 s39, s20, 1536
    s_add_u32 s39, s39, 15909376
    buffer_load_dwordx4 v[172:175], v30, s[4:7], s39 offen offset:0 sc1
    v_mfma_f32_32x32x16_bf16 v[84:99], a[80:83], v[148:151], v[84:99]
    ds_read_b64_tr_b16 v[144:145], v29 offset:60416
    ds_read_b64_tr_b16 v[146:147], v29 offset:60672
    buffer_load_dwordx4 a[200:203], v23, s[4:7], s36 offen sc1
    s_add_u32 s36, s36, 4096
    s_waitcnt lgkmcnt(8)
    v_mfma_f32_32x32x16_bf16 v[84:99], a[84:87], v[152:155], v[84:99]
    ds_read_b64_tr_b16 v[148:149], v29 offset:61440
    ds_read_b64_tr_b16 v[150:151], v29 offset:61696
    v_rcp_f32 v166, v166
    v_fma_f32 v167, v167, v182, v182
    v_mul_f32 v120, v120, v128
    v_mfma_f32_32x32x16_bf16 v[84:99], a[88:91], v[156:159], v[84:99]
    ds_read_b64_tr_b16 v[152:153], v29 offset:62464
    ds_read_b64_tr_b16 v[154:155], v29 offset:62720
    buffer_load_dwordx4 a[204:207], v2, s[4:7], s36 offen sc1
    v_exp_f32 v169, v169
    v_mul_f32 v170, v170, v122
    v_mfma_f32_32x32x16_bf16 v[84:99], a[92:95], v[160:163], v[84:99]
    ds_read_b64_tr_b16 v[156:157], v29 offset:63488
    ds_read_b64_tr_b16 v[158:159], v29 offset:63744
    v_fma_f32 v171, v171, v180, v181
    v_mul_f32 v117, v117, v165
    v_rcp_f32 v167, v167
    s_waitcnt lgkmcnt(8)
    v_mfma_f32_32x32x16_bf16 v[84:99], a[96:99], v[132:135], v[84:99]
    ds_read_b64_tr_b16 v[160:161], v29 offset:64512
    ds_read_b64_tr_b16 v[162:163], v29 offset:64768
    buffer_load_dwordx4 a[208:211], v23, s[4:7], s36 offen sc1
    s_add_u32 s36, s36, 4096
    v_fma_f32 v168, v168, v182, v182
    v_mul_f32 v121, v121, v129
    s_waitcnt vmcnt(19)
    s_barrier
    v_mfma_f32_32x32x16_bf16 v[84:99], a[100:103], v[136:139], v[84:99]
    ds_read_b64_tr_b16 v[132:133], v28 offset:0
    ds_read_b64_tr_b16 v[134:135], v28 offset:256
    v_exp_f32 v170, v170
    v_mul_f32 v171, v171, v123
    v_mul_f32 v118, v118, v166
    v_mfma_f32_32x32x16_bf16 v[84:99], a[104:107], v[140:143], v[84:99]
    ds_read_b64_tr_b16 v[136:137], v28 offset:1024
    ds_read_b64_tr_b16 v[138:139], v28 offset:1280
    buffer_load_dwordx4 a[212:215], v2, s[4:7], s36 offen sc1
    v_rcp_f32 v168, v168
    s_waitcnt lgkmcnt(8)
    v_mfma_f32_32x32x16_bf16 v[84:99], a[108:111], v[144:147], v[84:99]
    ds_read_b64_tr_b16 v[140:141], v28 offset:2048
    ds_read_b64_tr_b16 v[142:143], v28 offset:2304
    v_fma_f32 v169, v169, v182, v182
    v_mul_f32 v122, v122, v130
    v_exp_f32 v171, v171
    v_mul_f32 v119, v119, v167
    v_mfma_f32_32x32x16_bf16 v[84:99], a[112:115], v[148:151], v[84:99]
    ds_read_b64_tr_b16 v[144:145], v28 offset:3072
    ds_read_b64_tr_b16 v[146:147], v28 offset:3328
    buffer_load_dwordx4 a[216:219], v23, s[4:7], s36 offen sc1
    s_add_u32 s36, s36, 4096
    v_rcp_f32 v169, v169
    v_mfma_f32_32x32x16_bf16 v[84:99], a[116:119], v[152:155], v[84:99]
    ds_read_b64_tr_b16 v[148:149], v28 offset:4096
    ds_read_b64_tr_b16 v[150:151], v28 offset:4352
    v_fma_f32 v170, v170, v182, v182
    v_mul_f32 v123, v123, v131
    v_mul_f32 v120, v120, v168
    s_waitcnt lgkmcnt(8)
    v_mfma_f32_32x32x16_bf16 v[84:99], a[120:123], v[156:159], v[84:99]
    ds_read_b64_tr_b16 v[152:153], v28 offset:5120
    ds_read_b64_tr_b16 v[154:155], v28 offset:5376
    buffer_load_dwordx4 a[220:223], v2, s[4:7], s36 offen sc1
    v_rcp_f32 v170, v170
    v_fma_f32 v171, v171, v182, v182
    v_mfma_f32_32x32x16_bf16 v[84:99], a[124:127], v[160:163], v[84:99]
    ds_read_b64_tr_b16 v[156:157], v28 offset:6144
    ds_read_b64_tr_b16 v[158:159], v28 offset:6400
    v_mul_f32 v121, v121, v169
    v_rcp_f32 v171, v171
    v_mul_f32 v122, v122, v170
    v_mul_f32 v123, v123, v171
    v_mfma_f32_32x32x16_bf16 v[100:115], a[0:3], v[132:135], 0
    ds_read_b64_tr_b16 v[160:161], v28 offset:7168
    ds_read_b64_tr_b16 v[162:163], v28 offset:7424
    buffer_load_dwordx4 a[224:227], v23, s[4:7], s36 offen sc1
    s_add_u32 s36, s36, 4096
    s_waitcnt vmcnt(7)
    v_cmp_eq_u32 vcc, 0, v172
    s_cbranch_vccnz mk_qs22
mk_qo23:
    v_mfma_f32_32x32x16_bf16 v[84:99], a[128:131], v[172:175], v[84:99]
    s_waitcnt lgkmcnt(8)
    v_mfma_f32_32x32x16_bf16 v[100:115], a[4:7], v[136:139], v[100:115]
    ds_read_b64_tr_b16 v[132:133], v28 offset:8192
    ds_read_b64_tr_b16 v[134:135], v28 offset:8448
    v_cvt_pk_bf16_f32 v124, v116, v117
    v_cvt_pk_bf16_f32 v125, v118, v119
    v_cvt_pk_bf16_f32 v126, v120, v121
    v_cvt_pk_bf16_f32 v127, v122, v123
    v_mfma_f32_32x32x16_bf16 v[100:115], a[8:11], v[140:143], v[100:115]
    ds_read_b64_tr_b16 v[136:137], v28 offset:9216
    ds_read_b64_tr_b16 v[138:139], v28 offset:9472
    buffer_load_dwordx4 a[228:231], v2, s[4:7], s36 offen sc1
    v_mfma_f32_32x32x16_bf16 v[100:115], a[12:15], v[144:147], v[100:115]
    ds_read_b64_tr_b16 v[140:141], v28 offset:10240
    ds_read_b64_tr_b16 v[142:143], v28 offset:10496
    s_cmp_eq_u32 s20, 10
    s_cselect_b32 s43, 2146435072, s43
    buffer_store_dwordx4 v[124:127], v2, s[4:7], s43 offen sc1
    s_waitcnt lgkmcnt(8)
    v_mfma_f32_32x32x16_bf16 v[100:115], a[16:19], v[148:151], v[100:115]
    ds_read_b64_tr_b16 v[144:145], v28 offset:11264
    ds_read_b64_tr_b16 v[146:147], v28 offset:11520
    buffer_load_dwordx4 a[232:235], v23, s[4:7], s36 offen sc1
    s_add_u32 s36, s36, 4096
    v_mul_f32 v164, v84, v84
    v_fma_f32 v164, v164, v172, v173
    v_mfma_f32_32x32x16_bf16 v[100:115], a[20:23], v[152:155], v[100:115]
    ds_read_b64_tr_b16 v[148:149], v28 offset:12288
    ds_read_b64_tr_b16 v[150:151], v28 offset:12544
    v_mul_f32 v165, v85, v85
    v_mul_f32 v164, v164, v84
    v_fma_f32 v165, v165, v172, v173
    v_mul_f32 v166, v86, v86
    v_mfma_f32_32x32x16_bf16 v[100:115], a[24:27], v[156:159], v[100:115]
    ds_read_b64_tr_b16 v[152:153], v28 offset:13312
    ds_read_b64_tr_b16 v[154:155], v28 offset:13568
    buffer_load_dwordx4 a[236:239], v2, s[4:7], s36 offen sc1
    v_exp_f32 v164, v164
    s_waitcnt lgkmcnt(8)
    v_mfma_f32_32x32x16_bf16 v[100:115], a[28:31], v[160:163], v[100:115]
    ds_read_b64_tr_b16 v[156:157], v28 offset:14336
    ds_read_b64_tr_b16 v[158:159], v28 offset:14592
    v_mul_f32 v165, v165, v85
    v_fma_f32 v166, v166, v172, v173
    v_mul_f32 v167, v87, v87
    v_mul_f32 v84, v84, v92
    v_mfma_f32_32x32x16_bf16 v[100:115], a[32:35], v[132:135], v[100:115]
    ds_read_b64_tr_b16 v[160:161], v28 offset:15360
    ds_read_b64_tr_b16 v[162:163], v28 offset:15616
    buffer_load_dwordx4 a[240:243], v23, s[4:7], s36 offen sc1
    s_add_u32 s36, s36, 4096
    v_exp_f32 v165, v165
    v_mfma_f32_32x32x16_bf16 v[100:115], a[36:39], v[136:139], v[100:115]
    ds_read_b64_tr_b16 v[132:133], v28 offset:16384
    ds_read_b64_tr_b16 v[134:135], v28 offset:16640
    v_mul_f32 v166, v166, v86
    v_fma_f32 v167, v167, v172, v173
    v_mul_f32 v168, v88, v88
    v_fma_f32 v164, v164, v174, v174
    s_waitcnt lgkmcnt(8)
    v_mfma_f32_32x32x16_bf16 v[100:115], a[40:43], v[140:143], v[100:115]
    ds_read_b64_tr_b16 v[136:137], v28 offset:17408
    ds_read_b64_tr_b16 v[138:139], v28 offset:17664
    buffer_load_dwordx4 a[244:247], v2, s[4:7], s36 offen sc1
    v_mul_f32 v85, v85, v93
    v_exp_f32 v166, v166
    v_mfma_f32_32x32x16_bf16 v[100:115], a[44:47], v[144:147], v[100:115]
    ds_read_b64_tr_b16 v[140:141], v28 offset:18432
    ds_read_b64_tr_b16 v[142:143], v28 offset:18688
    v_mul_f32 v167, v167, v87
    v_fma_f32 v168, v168, v172, v173
    v_mul_f32 v169, v89, v89
    v_rcp_f32 v164, v164
    v_mfma_f32_32x32x16_bf16 v[100:115], a[48:51], v[148:151], v[100:115]
    ds_read_b64_tr_b16 v[144:145], v28 offset:19456
    ds_read_b64_tr_b16 v[146:147], v28 offset:19712
    buffer_load_dwordx4 a[248:251], v23, s[4:7], s36 offen sc1
    s_add_u32 s36, s36, 4096
    v_fma_f32 v165, v165, v174, v174
    s_waitcnt lgkmcnt(8)
    v_mfma_f32_32x32x16_bf16 v[100:115], a[52:55], v[152:155], v[100:115]
    ds_read_b64_tr_b16 v[148:149], v28 offset:20480
    ds_read_b64_tr_b16 v[150:151], v28 offset:20736
    v_mul_f32 v86, v86, v94
    v_exp_f32 v167, v167
    v_mul_f32 v168, v168, v88
    v_fma_f32 v169, v169, v172, v173
    v_mfma_f32_32x32x16_bf16 v[100:115], a[56:59], v[156:159], v[100:115]
    ds_read_b64_tr_b16 v[152:153], v28 offset:21504
    ds_read_b64_tr_b16 v[154:155], v28 offset:21760
    buffer_load_dwordx4 a[252:255], v2, s[4:7], s36 offen sc1
    v_mul_f32 v170, v90, v90
    v_rcp_f32 v165, v165
    v_mfma_f32_32x32x16_bf16 v[100:115], a[60:63], v[160:163], v[100:115]
    ds_read_b64_tr_b16 v[156:157], v28 offset:22528
    ds_read_b64_tr_b16 v[158:159], v28 offset:22784
    v_fma_f32 v166, v166, v174, v174
    v_mul_f32 v87, v87, v95
    v_exp_f32 v168, v168
    s_waitcnt lgkmcnt(8)
    v_mfma_f32_32x32x16_bf16 v[100:115], a[64:67], v[132:135], v[100:115]
    ds_read_b64_tr_b16 v[160:161], v28 offset:23552
    ds_read_b64_tr_b16 v[162:163], v28 offset:23808
    buffer_load_dwordx4 v[32:35], v23, s[4:7], s36 offen sc1
    s_add_u32 s36, s36, 4096
    v_mul_f32 v169, v169, v89
    v_fma_f32 v170, v170, v172, v173
    v_mfma_f32_32x32x16_bf16 v[100:115], a[68:71], v[136:139], v[100:115]
    ds_read_b64_tr_b16 v[132:133], v28 offset:24576
    ds_read_b64_tr_b16 v[134:135], v28 offset:24832
    v_mul_f32 v171, v91, v91
    v_mul_f32 v84, v84, v164
    v_rcp_f32 v166, v166
    v_fma_f32 v167, v167, v174, v174
    v_mfma_f32_32x32x16_bf16 v[100:115], a[72:75], v[140:143], v[100:115]
    ds_read_b64_tr_b16 v[136:137], v28 offset:25600
    ds_read_b64_tr_b16 v[138:139], v28 offset:25856
    buffer_load_dwordx4 v[36:39], v2, s[4:7], s36 offen sc1
    buffer_load_dwordx4 v[176:179], v30, s[4:7], s39 offen offset:512 sc1
    s_waitcnt lgkmcnt(8)
    v_mfma_f32_32x32x16_bf16 v[100:115], a[76:79], v[144:147], v[100:115]
    ds_read_b64_tr_b16 v[140:141], v28 offset:26624
    ds_read_b64_tr_b16 v[142:143], v28 offset:26880
    v_mul_f32 v88, v88, v96
    v_exp_f32 v169, v169
    v_mul_f32 v170, v170, v90
    v_fma_f32 v171, v171, v172, v173
    v_mfma_f32_32x32x16_bf16 v[100:115], a[80:83], v[148:151], v[100:115]
    ds_read_b64_tr_b16 v[144:145], v28 offset:27648
    ds_read_b64_tr_b16 v[146:147], v28 offset:27904
    buffer_load_dwordx4 v[40:43], v23, s[4:7], s36 offen sc1
    s_add_u32 s36, s36, 4096
    v_mul_f32 v85, v85, v165
    v_mfma_f32_32x32x16_bf16 v[100:115], a[84:87], v[152:155], v[100:115]
    ds_read_b64_tr_b16 v[148:149], v28 offset:28672
    ds_read_b64_tr_b16 v[150:151], v28 offset:28928
    s_waitcnt vmcnt(10)
    s_barrier
    s_add_u32 s38, s28, 16252928
    buffer_atomic_add v21, v18, s[4:7], s38 offen sc1
    s_waitcnt lgkmcnt(8)
    v_mfma_f32_32x32x16_bf16 v[100:115], a[88:91], v[156:159], v[100:115]
    ds_read_b64_tr_b16 v[152:153], v28 offset:29696
    ds_read_b64_tr_b16 v[154:155], v28 offset:29952
    buffer_load_dwordx4 v[44:47], v2, s[4:7], s36 offen sc1
    v_rcp_f32 v167, v167
    v_fma_f32 v168, v168, v174, v174
    v_mfma_f32_32x32x16_bf16 v[100:115], a[92:95], v[160:163], v[100:115]
    ds_read_b64_tr_b16 v[156:157], v28 offset:30720
    ds_read_b64_tr_b16 v[158:159], v28 offset:30976
    v_mul_f32 v89, v89, v97
    v_exp_f32 v170, v170
    v_mul_f32 v171, v171, v91
    v_mul_f32 v86, v86, v166
    v_mfma_f32_32x32x16_bf16 v[100:115], a[96:99], v[132:135], v[100:115]
    ds_read_b64_tr_b16 v[160:161], v28 offset:31744
    ds_read_b64_tr_b16 v[162:163], v28 offset:32000
    buffer_load_dwordx4 v[48:51], v23, s[4:7], s36 offen sc1
    s_add_u32 s36, s36, 4096
    s_barrier
    s_waitcnt lgkmcnt(8)
    v_mfma_f32_32x32x16_bf16 v[100:115], a[100:103], v[136:139], v[100:115]
    ds_read_b64_tr_b16 v[132:133], v28 offset:32768
    ds_read_b64_tr_b16 v[134:135], v28 offset:33024
    v_rcp_f32 v168, v168
    v_fma_f32 v169, v169, v174, v174
    v_mul_f32 v90, v90, v98
    v_mfma_f32_32x32x16_bf16 v[100:115], a[104:107], v[140:143], v[100:115]
    ds_read_b64_tr_b16 v[136:137], v28 offset:33792
    ds_read_b64_tr_b16 v[138:139], v28 offset:34048
    buffer_load_dwordx4 v[52:55], v2, s[4:7], s36 offen sc1
    v_exp_f32 v171, v171
    v_mul_f32 v87, v87, v167
    v_mfma_f32_32x32x16_bf16 v[100:115], a[108:111], v[144:147], v[100:115]
    ds_read_b64_tr_b16 v[140:141], v28 offset:34816
    ds_read_b64_tr_b16 v[142:143], v28 offset:35072
    v_rcp_f32 v169, v169
    v_fma_f32 v170, v170, v174, v174
    v_mul_f32 v91, v91, v99
    s_waitcnt lgkmcnt(8)
    v_mfma_f32_32x32x16_bf16 v[100:115], a[112:115], v[148:151], v[100:115]
    ds_read_b64_tr_b16 v[144:145], v28 offset:35840
    ds_read_b64_tr_b16 v[146:147], v28 offset:36096
    buffer_load_dwordx4 v[56:59], v23, s[4:7], s36 offen sc1
    s_add_u32 s36, s36, 4096
    v_mul_f32 v88, v88, v168
    v_mfma_f32_32x32x16_bf16 v[100:115], a[116:119], v[152:155], v[100:115]
    ds_read_b64_tr_b16 v[148:149], v28 offset:36864
    ds_read_b64_tr_b16 v[150:151], v28 offset:37120
    v_rcp_f32 v170, v170
    v_fma_f32 v171, v171, v174, v174
    v_mul_f32 v89, v89, v169
    v_mfma_f32_32x32x16_bf16 v[100:115], a[120:123], v[156:159], v[100:115]
    ds_read_b64_tr_b16 v[152:153], v28 offset:37888
    ds_read_b64_tr_b16 v[154:155], v28 offset:38144
    buffer_load_dwordx4 v[60:63], v2, s[4:7], s36 offen sc1
    v_rcp_f32 v171, v171
    s_waitcnt lgkmcnt(8)
    v_mfma_f32_32x32x16_bf16 v[100:115], a[124:127], v[160:163], v[100:115]
    ds_read_b64_tr_b16 v[156:157], v28 offset:38912
    ds_read_b64_tr_b16 v[158:159], v28 offset:39168
    s_waitcnt vmcnt(7)
    v_cmp_eq_u32 vcc, 0, v176
    s_cbranch_vccnz mk_qs25
mk_qo26:
    v_mfma_f32_32x32x16_bf16 v[100:115], a[128:131], v[176:179], v[100:115]
    v_mul_f32 v90, v90, v170
    v_mfma_f32_32x32x16_bf16 v[116:131], a[0:3], v[132:135], 0
    ds_read_b64_tr_b16 v[160:161], v28 offset:39936
    ds_read_b64_tr_b16 v[162:163], v28 offset:40192
    buffer_load_dwordx4 v[64:67], v23, s[4:7], s36 offen sc1
    s_add_u32 s36, s36, 4096
    v_mul_f32 v91, v91, v171
    v_cvt_pk_bf16_f32 v92, v84, v85
    v_mfma_f32_32x32x16_bf16 v[116:131], a[4:7], v[136:139], v[116:131]
    ds_read_b64_tr_b16 v[132:133], v28 offset:40960
    ds_read_b64_tr_b16 v[134:135], v28 offset:41216
    v_cvt_pk_bf16_f32 v93, v86, v87
    v_cvt_pk_bf16_f32 v94, v88, v89
    v_cvt_pk_bf16_f32 v95, v90, v91
    s_waitcnt lgkmcnt(8)
    v_mfma_f32_32x32x16_bf16 v[116:131], a[8:11], v[140:143], v[116:131]
    ds_read_b64_tr_b16 v[136:137], v28 offset:41984
    ds_read_b64_tr_b16 v[138:139], v28 offset:42240
    buffer_load_dwordx4 v[68:71], v2, s[4:7], s36 offen sc1
    v_mfma_f32_32x32x16_bf16 v[116:131], a[12:15], v[144:147], v[116:131]
    ds_read_b64_tr_b16 v[140:141], v28 offset:43008
    ds_read_b64_tr_b16 v[142:143], v28 offset:43264
    s_add_u32 s37, s29, 16252928
    v_mov_b32 v20, 0
    buffer_atomic_add v20, v13, s[4:7], s37 offen sc0 sc1
    s_mul_i32 s93, s22, 90112
    s_lshl_b32 s33, s3, 10
    s_add_u32 s93, s93, s33
    s_add_u32 s93, s93, 25165824
    s_add_u32 s94, s93, 90112
    s_mul_i32 s40, s23, 0
    s_add_u32 s40, s40, s93
    v_mfma_f32_32x32x16_bf16 v[116:131], a[16:19], v[148:151], v[116:131]
    ds_read_b64_tr_b16 v[144:145], v28 offset:44032
    ds_read_b64_tr_b16 v[146:147], v28 offset:44288
    s_mul_i32 s43, s20, 270336
    s_lshl_b32 s32, s21, 10
    s_add_u32 s43, s43, s32
    s_add_u32 s43, s43, 28049408
    buffer_store_dwordx4 v[92:95], v2, s[4:7], s43 offen sc1
    s_add_u32 s43, s43, 90112
    s_waitcnt lgkmcnt(8)
    v_mfma_f32_32x32x16_bf16 v[116:131], a[20:23], v[152:155], v[116:131]
    ds_read_b64_tr_b16 v[148:149], v28 offset:45056
    ds_read_b64_tr_b16 v[150:151], v28 offset:45312
    v_mul_f32 v164, v100, v100
    v_fma_f32 v164, v164, v176, v177
    v_mul_f32 v165, v101, v101
    v_mul_f32 v164, v164, v100
    v_fma_f32 v165, v165, v176, v177
    v_mfma_f32_32x32x16_bf16 v[116:131], a[24:27], v[156:159], v[116:131]
    ds_read_b64_tr_b16 v[152:153], v28 offset:46080
    ds_read_b64_tr_b16 v[154:155], v28 offset:46336
    v_mul_f32 v166, v102, v102
    v_exp_f32 v164, v164
    v_mul_f32 v165, v165, v101
    v_fma_f32 v166, v166, v176, v177
    v_mfma_f32_32x32x16_bf16 v[116:131], a[28:31], v[160:163], v[116:131]
    ds_read_b64_tr_b16 v[156:157], v28 offset:47104
    ds_read_b64_tr_b16 v[158:159], v28 offset:47360
    v_mul_f32 v167, v103, v103
    v_mul_f32 v100, v100, v108
    v_exp_f32 v165, v165
    s_waitcnt lgkmcnt(8)
    v_mfma_f32_32x32x16_bf16 v[116:131], a[32:35], v[132:135], v[116:131]
    ds_read_b64_tr_b16 v[160:161], v28 offset:48128
    ds_read_b64_tr_b16 v[162:163], v28 offset:48384
    v_mul_f32 v166, v166, v102
    v_fma_f32 v167, v167, v176, v177
    v_mul_f32 v168, v104, v104
    v_fma_f32 v164, v164, v178, v178
    v_mul_f32 v101, v101, v109
    v_mfma_f32_32x32x16_bf16 v[116:131], a[36:39], v[136:139], v[116:131]
    ds_read_b64_tr_b16 v[132:133], v28 offset:49152
    ds_read_b64_tr_b16 v[134:135], v28 offset:49408
    v_exp_f32 v166, v166
    v_mul_f32 v167, v167, v103
    v_fma_f32 v168, v168, v176, v177
    v_mul_f32 v169, v105, v105
    v_mfma_f32_32x32x16_bf16 v[116:131], a[40:43], v[140:143], v[116:131]
    ds_read_b64_tr_b16 v[136:137], v28 offset:50176
    ds_read_b64_tr_b16 v[138:139], v28 offset:50432
    v_rcp_f32 v164, v164
    v_fma_f32 v165, v165, v178, v178
    v_mul_f32 v102, v102, v110
    s_waitcnt lgkmcnt(8)
    v_mfma_f32_32x32x16_bf16 v[116:131], a[44:47], v[144:147], v[116:131]
    ds_read_b64_tr_b16 v[140:141], v28 offset:51200
    ds_read_b64_tr_b16 v[142:143], v28 offset:51456
    buffer_load_dwordx4 v[180:183], v30, s[4:7], s39 offen offset:1024 sc1
    v_exp_f32 v167, v167
    v_mul_f32 v168, v168, v104
    v_mfma_f32_32x32x16_bf16 v[116:131], a[48:51], v[148:151], v[116:131]
    ds_read_b64_tr_b16 v[144:145], v28 offset:52224
    ds_read_b64_tr_b16 v[146:147], v28 offset:52480
    v_fma_f32 v169, v169, v176, v177
    v_mul_f32 v170, v106, v106
    v_rcp_f32 v165, v165
    v_fma_f32 v166, v166, v178, v178
    v_mfma_f32_32x32x16_bf16 v[116:131], a[52:55], v[152:155], v[116:131]
    ds_read_b64_tr_b16 v[148:149], v28 offset:53248
    ds_read_b64_tr_b16 v[150:151], v28 offset:53504
    v_mul_f32 v103, v103, v111
    v_exp_f32 v168, v168
    v_mul_f32 v169, v169, v105
    s_waitcnt lgkmcnt(8)
    v_mfma_f32_32x32x16_bf16 v[116:131], a[56:59], v[156:159], v[116:131]
    ds_read_b64_tr_b16 v[152:153], v28 offset:54272
    ds_read_b64_tr_b16 v[154:155], v28 offset:54528
    v_fma_f32 v170, v170, v176, v177
    v_mul_f32 v171, v107, v107
    v_mul_f32 v100, v100, v164
    v_rcp_f32 v166, v166
    v_mfma_f32_32x32x16_bf16 v[116:131], a[60:63], v[160:163], v[116:131]
    ds_read_b64_tr_b16 v[156:157], v28 offset:55296
    ds_read_b64_tr_b16 v[158:159], v28 offset:55552
    v_fma_f32 v167, v167, v178, v178
    v_mul_f32 v104, v104, v112
    v_exp_f32 v169, v169
    v_mul_f32 v170, v170, v106
    v_mfma_f32_32x32x16_bf16 v[116:131], a[64:67], v[132:135], v[116:131]
    ds_read_b64_tr_b16 v[160:161], v28 offset:56320
    ds_read_b64_tr_b16 v[162:163], v28 offset:56576
    v_fma_f32 v171, v171, v176, v177
    v_mul_f32 v101, v101, v165
    v_rcp_f32 v167, v167
    s_waitcnt lgkmcnt(8)
    v_mfma_f32_32x32x16_bf16 v[116:131], a[68:71], v[136:139], v[116:131]
    ds_read_b64_tr_b16 v[132:133], v28 offset:57344
    ds_read_b64_tr_b16 v[134:135], v28 offset:57600
    v_fma_f32 v168, v168, v178, v178
    v_mul_f32 v105, v105, v113
    v_exp_f32 v170, v170
    v_mul_f32 v171, v171, v107
    v_mfma_f32_32x32x16_bf16 v[116:131], a[72:75], v[140:143], v[116:131]
    ds_read_b64_tr_b16 v[136:137], v28 offset:58368
    ds_read_b64_tr_b16 v[138:139], v28 offset:58624
    v_mul_f32 v102, v102, v166
    v_rcp_f32 v168, v168
    v_fma_f32 v169, v169, v178, v178
    v_mul_f32 v106, v106, v114
    v_mfma_f32_32x32x16_bf16 v[116:131], a[76:79], v[144:147], v[116:131]
    ds_read_b64_tr_b16 v[140:141], v28 offset:59392
    ds_read_b64_tr_b16 v[142:143], v28 offset:59648
    s_waitcnt vmcnt(2)
    v_cmp_gt_u32 vcc, 11, v20
    s_nop 0
    s_and_b64 vcc, vcc, s[52:53]
    s_cbranch_scc1 mk_ps28
mk_po29:
    s_barrier
    s_waitcnt lgkmcnt(8)
    v_mfma_f32_32x32x16_bf16 v[116:131], a[80:83], v[148:151], v[116:131]
    ds_read_b64_tr_b16 v[144:145], v28 offset:60416
    ds_read_b64_tr_b16 v[146:147], v28 offset:60672
    buffer_load_dwordx4 v[252:255], v2, s[4:7], s40 offen sc1
    s_add_u32 s40, s40, 4096
    v_exp_f32 v171, v171
    v_mfma_f32_32x32x16_bf16 v[116:131], a[84:87], v[152:155], v[116:131]
    ds_read_b64_tr_b16 v[148:149], v28 offset:61440
    ds_read_b64_tr_b16 v[150:151], v28 offset:61696
    v_mul_f32 v103, v103, v167
    v_rcp_f32 v169, v169
    v_fma_f32 v170, v170, v178, v178
    v_mul_f32 v107, v107, v115
    v_mfma_f32_32x32x16_bf16 v[116:131], a[88:91], v[156:159], v[116:131]
    ds_read_b64_tr_b16 v[152:153], v28 offset:62464
    ds_read_b64_tr_b16 v[154:155], v28 offset:62720
    buffer_load_dwordx4 v[248:251], v2, s[4:7], s40 offen sc1
    s_add_u32 s40, s40, 4096
    v_mul_f32 v104, v104, v168
    s_waitcnt lgkmcnt(8)
    v_mfma_f32_32x32x16_bf16 v[116:131], a[92:95], v[160:163], v[116:131]
    ds_read_b64_tr_b16 v[156:157], v28 offset:63488
    ds_read_b64_tr_b16 v[158:159], v28 offset:63744
    v_rcp_f32 v170, v170
    v_fma_f32 v171, v171, v178, v178
    v_mul_f32 v105, v105, v169
    v_mfma_f32_32x32x16_bf16 v[116:131], a[96:99], v[132:135], v[116:131]
    ds_read_b64_tr_b16 v[160:161], v28 offset:64512
    ds_read_b64_tr_b16 v[162:163], v28 offset:64768
    buffer_load_dwordx4 v[244:247], v2, s[4:7], s40 offen sc1
    s_add_u32 s40, s40, 4096
    s_waitcnt vmcnt(3)
    v_cmp_eq_u32 vcc, 0, v180
    s_cbranch_vccnz mk_qs31
mk_qo32:
    v_mfma_f32_32x32x16_bf16 v[116:131], a[128:131], v[180:183], v[116:131]
    v_mfma_f32_32x32x16_bf16 v[116:131], a[100:103], v[136:139], v[116:131]
    v_rcp_f32 v171, v171
    v_mul_f32 v106, v106, v170
    v_mul_f32 v107, v107, v171
    v_cvt_pk_bf16_f32 v108, v100, v101
    v_cvt_pk_bf16_f32 v109, v102, v103
    s_waitcnt lgkmcnt(6)
    v_mfma_f32_32x32x16_bf16 v[116:131], a[104:107], v[140:143], v[116:131]
    buffer_load_dwordx4 v[240:243], v2, s[4:7], s40 offen sc1
    s_add_u32 s40, s40, 4096
    v_cvt_pk_bf16_f32 v110, v104, v105
    v_cvt_pk_bf16_f32 v111, v106, v107
    v_mfma_f32_32x32x16_bf16 v[116:131], a[108:111], v[144:147], v[116:131]
    buffer_store_dwordx4 v[108:111], v2, s[4:7], s43 offen sc1
    s_add_u32 s43, s43, 90112
    v_mfma_f32_32x32x16_bf16 v[116:131], a[112:115], v[148:151], v[116:131]
    buffer_load_dwordx4 v[236:239], v2, s[4:7], s40 offen sc1
    s_add_u32 s40, s40, 4096
    s_waitcnt lgkmcnt(0)
    v_mfma_f32_32x32x16_bf16 v[116:131], a[116:119], v[152:155], v[116:131]
    v_mfma_f32_32x32x16_bf16 v[116:131], a[120:123], v[156:159], v[116:131]
    buffer_load_dwordx4 v[232:235], v2, s[4:7], s40 offen sc1
    s_add_u32 s40, s40, 4096
    v_mfma_f32_32x32x16_bf16 v[116:131], a[124:127], v[160:163], v[116:131]
    s_nop 11
    v_pk_mul_f32 v[164:165], v[116:117], v[116:117]
    v_pk_mul_f32 v[166:167], v[118:119], v[118:119]
    v_pk_mul_f32 v[168:169], v[120:121], v[120:121]
    v_pk_mul_f32 v[170:171], v[122:123], v[122:123]
    v_pk_fma_f32 v[164:165], v[164:165], v[180:181], v[180:181] op_sel:[0,0,1] op_sel_hi:[1,0,1]
    v_pk_fma_f32 v[166:167], v[166:167], v[180:181], v[180:181] op_sel:[0,0,1] op_sel_hi:[1,0,1]
    v_pk_fma_f32 v[168:169], v[168:169], v[180:181], v[180:181] op_sel:[0,0,1] op_sel_hi:[1,0,1]
    v_pk_fma_f32 v[170:171], v[170:171], v[180:181], v[180:181] op_sel:[0,0,1] op_sel_hi:[1,0,1]
    v_pk_mul_f32 v[164:165], v[164:165], v[116:117]
    v_pk_mul_f32 v[166:167], v[166:167], v[118:119]
    v_pk_mul_f32 v[168:169], v[168:169], v[120:121]
    v_pk_mul_f32 v[170:171], v[170:171], v[122:123]
    buffer_load_dwordx4 v[228:231], v2, s[4:7], s40 offen sc1
    s_add_u32 s40, s40, 4096
    v_exp_f32 v164, v164
    v_exp_f32 v165, v165
    v_exp_f32 v166, v166
    v_exp_f32 v167, v167
    v_exp_f32 v168, v168
    v_exp_f32 v169, v169
    v_exp_f32 v170, v170
    v_exp_f32 v171, v171
    v_pk_mul_f32 v[116:117], v[116:117], v[124:125]
    v_pk_mul_f32 v[118:119], v[118:119], v[126:127]
    v_pk_mul_f32 v[120:121], v[120:121], v[128:129]
    v_pk_mul_f32 v[122:123], v[122:123], v[130:131]
    buffer_load_dwordx4 v[224:227], v2, s[4:7], s40 offen sc1
    s_add_u32 s40, s40, 4096
    v_pk_fma_f32 v[164:165], v[164:165], v[182:183], v[182:183] op_sel:[0,0,0] op_sel_hi:[1,0,0]
    v_pk_fma_f32 v[166:167], v[166:167], v[182:183], v[182:183] op_sel:[0,0,0] op_sel_hi:[1,0,0]
    v_pk_fma_f32 v[168:169], v[168:169], v[182:183], v[182:183] op_sel:[0,0,0] op_sel_hi:[1,0,0]
    v_pk_fma_f32 v[170:171], v[170:171], v[182:183], v[182:183] op_sel:[0,0,0] op_sel_hi:[1,0,0]
    v_rcp_f32 v164, v164
    v_rcp_f32 v165, v165
    v_rcp_f32 v166, v166
    v_rcp_f32 v167, v167
    v_rcp_f32 v168, v168
    v_rcp_f32 v169, v169
    v_rcp_f32 v170, v170
    v_rcp_f32 v171, v171
    buffer_load_dwordx4 v[220:223], v2, s[4:7], s40 offen sc1
    s_add_u32 s40, s40, 4096
    v_pk_mul_f32 v[116:117], v[116:117], v[164:165]
    v_pk_mul_f32 v[118:119], v[118:119], v[166:167]
    v_pk_mul_f32 v[120:121], v[120:121], v[168:169]
    v_pk_mul_f32 v[122:123], v[122:123], v[170:171]
    v_cvt_pk_bf16_f32 v124, v116, v117
    v_cvt_pk_bf16_f32 v125, v118, v119
    v_cvt_pk_bf16_f32 v126, v120, v121
    v_cvt_pk_bf16_f32 v127, v122, v123
    s_cmp_eq_u32 s20, 10
    s_cselect_b32 s43, 2146435072, s43
    buffer_store_dwordx4 v[124:127], v2, s[4:7], s43 offen sc1
    buffer_load_dwordx4 v[72:75], v23, s[4:7], s36 offen sc1
    s_add_u32 s36, s36, 4096
    buffer_load_dwordx4 v[76:79], v2, s[4:7], s36 offen sc1
    buffer_load_dwordx4 v[80:83], v23, s[4:7], s36 offen sc1
    buffer_load_dwordx4 v[216:219], v2, s[4:7], s40 offen sc1
    s_add_u32 s40, s40, 4096
    buffer_load_dwordx4 v[212:215], v2, s[4:7], s40 offen sc1
    s_add_u32 s40, s40, 4096
    buffer_load_dwordx4 v[208:211], v2, s[4:7], s40 offen sc1
    s_add_u32 s40, s40, 4096
    buffer_load_dwordx4 v[204:207], v2, s[4:7], s40 offen sc1
    s_add_u32 s40, s40, 4096
    buffer_load_dwordx4 v[200:203], v2, s[4:7], s40 offen sc1
    s_add_u32 s40, s40, 4096
mk_B0:
    s_lshl_b32 s42, s22, 15
    s_lshl_b32 s31, s23, 12
    s_add_u32 s42, s42, s31
    s_add_u32 s42, s42, 4194304
    s_waitcnt vmcnt(18)
    v_mfma_f32_32x32x16_bf16 v[84:99], v[252:255], a[132:135], 0
    v_lshrrev_b32 v117, 2, v0
    v_and_b32 v118, 3, v0
    v_and_b32 v116, 31, v1
    v_mul_u32_u24 v116, 144, v116
    buffer_load_dwordx4 v[196:199], v2, s[4:7], s40 offen sc1
    s_add_u32 s40, s40, 4096
    s_waitcnt vmcnt(18)
    v_mfma_f32_32x32x16_bf16 v[84:99], v[248:251], a[140:143], v[84:99]
    v_lshrrev_b32 v119, 5, v1
    v_lshl_add_u32 v116, v119, 4, v116
    s_mul_i32 s31, s3, 9216
    s_add_u32 s31, s31, 98304
    s_waitcnt vmcnt(17)
    v_mfma_f32_32x32x16_bf16 v[84:99], v[244:247], a[148:151], v[84:99]
    v_add_u32 v14, s31, v116
    v_mul_u32_u24 v116, 144, v117
    v_lshl_add_u32 v15, v118, 5, v116
    v_add_u32 v15, 98304, v15
    buffer_load_dwordx4 v[192:195], v2, s[4:7], s40 offen sc1
    s_add_u32 s40, s40, 4096
    s_waitcnt vmcnt(17)
    v_mfma_f32_32x32x16_bf16 v[84:99], v[240:243], a[156:159], v[84:99]
    v_lshlrev_b32 v26, 7, v119
    v_lshl_add_u32 v26, v118, 5, v26
    v_and_b32 v116, 16, v1
    v_add_u32 v26, v26, v116
    s_waitcnt vmcnt(15)
    v_mfma_f32_32x32x16_bf16 v[84:99], v[236:239], a[164:167], v[84:99]
    s_lshl_b32 s31, s3, 8
    s_add_u32 s31, s31, 25856
    v_add_u32 v26, s31, v26
    v_lshlrev_b32 v27, 2, v1
    buffer_load_dwordx4 v[188:191], v2, s[4:7], s40 offen sc1
    s_add_u32 s40, s40, 4096
    s_waitcnt vmcnt(15)
    v_mfma_f32_32x32x16_bf16 v[84:99], v[232:235], a[172:175], v[84:99]
    v_add_u32 v27, 25856, v27
    v_and_b32 v116, 31, v1
    v_lshlrev_b32 v25, 4, v116
    v_lshl_add_u32 v25, v119, 3, v25
    v_mfma_f32_32x32x16_bf16 v[100:115], v[252:255], a[136:139], 0
    s_min_u32 s31, s3, 1
    s_mul_i32 s31, s31, 2146435072
    v_add_u32 v25, s31, v25
    s_lshl_b32 s43, s22, 15
    buffer_load_dwordx4 v[184:187], v2, s[4:7], s40 offen sc1
    s_add_u32 s40, s40, 4096
    s_waitcnt vmcnt(15)
    v_mfma_f32_32x32x16_bf16 v[84:99], v[228:231], a[180:183], v[84:99]
    s_lshl_b32 s33, s23, 12
    s_add_u32 s43, s43, s33
    s_add_u32 s43, s43, 2097152
    v_mfma_f32_32x32x16_bf16 v[100:115], v[248:251], a[144:147], v[100:115]
    buffer_load_dwordx4 v[136:139], v2, s[4:7], s40 offen sc1
    s_add_u32 s40, s40, 4096
    s_waitcnt vmcnt(15)
    v_mfma_f32_32x32x16_bf16 v[84:99], v[224:227], a[188:191], v[84:99]
    v_mfma_f32_32x32x16_bf16 v[100:115], v[244:247], a[152:155], v[100:115]
    buffer_load_dwordx4 v[140:143], v2, s[4:7], s40 offen sc1
    s_add_u32 s40, s40, 4096
    s_waitcnt vmcnt(15)
    v_mfma_f32_32x32x16_bf16 v[84:99], v[220:223], a[196:199], v[84:99]
    v_mfma_f32_32x32x16_bf16 v[100:115], v[240:243], a[160:163], v[100:115]
    buffer_load_dwordx4 v[144:147], v2, s[4:7], s40 offen sc1
    s_add_u32 s40, s40, 4096
    s_waitcnt vmcnt(11)
    v_mfma_f32_32x32x16_bf16 v[84:99], v[216:219], a[204:207], v[84:99]
    v_mfma_f32_32x32x16_bf16 v[100:115], v[236:239], a[168:171], v[100:115]
    buffer_load_dwordx4 v[148:151], v2, s[4:7], s40 offen sc1
    s_waitcnt vmcnt(11)
    v_mfma_f32_32x32x16_bf16 v[84:99], v[212:215], a[212:215], v[84:99]
    v_mfma_f32_32x32x16_bf16 v[100:115], v[232:235], a[176:179], v[100:115]
    buffer_load_dwordx4 v[132:135], v3, s[4:7], s42 offen sc1
    s_waitcnt vmcnt(11)
    v_mfma_f32_32x32x16_bf16 v[84:99], v[208:211], a[220:223], v[84:99]
    v_mfma_f32_32x32x16_bf16 v[100:115], v[228:231], a[184:187], v[100:115]
    s_waitcnt vmcnt(10)
    v_mfma_f32_32x32x16_bf16 v[84:99], v[204:207], a[228:231], v[84:99]
    v_mfma_f32_32x32x16_bf16 v[100:115], v[224:227], a[192:195], v[100:115]
    s_waitcnt vmcnt(9)
    v_mfma_f32_32x32x16_bf16 v[84:99], v[200:203], a[236:239], v[84:99]
    v_mfma_f32_32x32x16_bf16 v[100:115], v[220:223], a[200:203], v[100:115]
    s_barrier
    s_add_u32 s38, s28, 16275456
    buffer_atomic_add v21, v18, s[4:7], s38 offen sc1
    s_waitcnt vmcnt(9)
    v_mfma_f32_32x32x16_bf16 v[84:99], v[196:199], a[244:247], v[84:99]
    v_mfma_f32_32x32x16_bf16 v[100:115], v[216:219], a[208:211], v[100:115]
    s_waitcnt vmcnt(8)
    v_mfma_f32_32x32x16_bf16 v[84:99], v[192:195], a[252:255], v[84:99]
    v_mfma_f32_32x32x16_bf16 v[100:115], v[212:215], a[216:219], v[100:115]
    s_waitcnt vmcnt(7)
    v_mfma_f32_32x32x16_bf16 v[84:99], v[188:191], v[36:39], v[84:99]
    v_mfma_f32_32x32x16_bf16 v[100:115], v[208:211], a[224:227], v[100:115]
    s_waitcnt vmcnt(6)
    v_mfma_f32_32x32x16_bf16 v[84:99], v[184:187], v[44:47], v[84:99]
    v_mfma_f32_32x32x16_bf16 v[100:115], v[204:207], a[232:235], v[100:115]
    s_waitcnt vmcnt(5)
    v_mfma_f32_32x32x16_bf16 v[84:99], v[136:139], v[52:55], v[84:99]
    v_mfma_f32_32x32x16_bf16 v[100:115], v[200:203], a[240:243], v[100:115]
    s_waitcnt vmcnt(4)
    v_mfma_f32_32x32x16_bf16 v[84:99], v[140:143], v[60:63], v[84:99]
    v_mfma_f32_32x32x16_bf16 v[100:115], v[196:199], a[248:251], v[100:115]
    s_waitcnt vmcnt(3)
    v_mfma_f32_32x32x16_bf16 v[84:99], v[144:147], v[68:71], v[84:99]
    v_mfma_f32_32x32x16_bf16 v[100:115], v[192:195], v[32:35], v[100:115]
    s_waitcnt vmcnt(2)
    v_mfma_f32_32x32x16_bf16 v[84:99], v[148:151], v[76:79], v[84:99]
    v_mfma_f32_32x32x16_bf16 v[100:115], v[188:191], v[40:43], v[100:115]
    v_mfma_f32_32x32x16_bf16 v[100:115], v[184:187], v[48:51], v[100:115]
    v_mfma_f32_32x32x16_bf16 v[100:115], v[136:139], v[56:59], v[100:115]
    s_nop 8
    ds_write_b128 v14, v[84:87] offset:0
    v_mfma_f32_32x32x16_bf16 v[100:115], v[140:143], v[64:67], v[100:115]
    ds_write_b128 v14, v[88:91] offset:32
    v_mfma_f32_32x32x16_bf16 v[100:115], v[144:147], v[72:75], v[100:115]
    ds_write_b128 v14, v[92:95] offset:64
    v_mfma_f32_32x32x16_bf16 v[100:115], v[148:151], v[80:83], v[100:115]
    ds_write_b128 v14, v[96:99] offset:96
    s_nop 10
    ds_write_b128 v14, v[100:103] offset:4608
    ds_write_b128 v14, v[104:107] offset:4640
    ds_write_b128 v14, v[108:111] offset:4672
    ds_write_b128 v14, v[112:115] offset:4704
    s_mul_i32 s93, s22, 90112
    s_lshl_b32 s33, s3, 10
    s_add_u32 s93, s93, s33
    s_add_u32 s93, s93, 28049408
    s_add_u32 s94, s93, 90112
    s_mul_i32 s40, s23, 0
    s_add_u32 s40, s40, s93
    s_add_u32 s37, s29, 16275456
    v_mov_b32 v20, 0
    buffer_atomic_add v20, v13, s[4:7], s37 offen sc0 sc1
    s_waitcnt lgkmcnt(0)
    s_barrier
    ds_read_b128 v[84:87], v15 offset:0
    ds_read_b128 v[88:91], v15 offset:16
    ds_read_b128 v[92:95], v15 offset:9216
    ds_read_b128 v[96:99], v15 offset:9232
    ds_read_b128 v[100:103], v15 offset:18432
    ds_read_b128 v[104:107], v15 offset:18448
    ds_read_b128 v[108:111], v15 offset:27648
    ds_read_b128 v[112:115], v15 offset:27664
    s_waitcnt vmcnt(2)
    v_lshlrev_b32 v124, 16, v132
    v_and_b32 v125, 0xffff0000, v132
    v_lshlrev_b32 v126, 16, v133
    v_and_b32 v127, 0xffff0000, v133
    v_lshlrev_b32 v128, 16, v134
    v_and_b32 v129, 0xffff0000, v134
    v_lshlrev_b32 v130, 16, v135
    v_and_b32 v131, 0xffff0000, v135
    s_waitcnt lgkmcnt(4)
    v_pk_add_f32 v[84:85], v[84:85], v[92:93]
    v_pk_add_f32 v[86:87], v[86:87], v[94:95]
    v_pk_add_f32 v[88:89], v[88:89], v[96:97]
    v_pk_add_f32 v[90:91], v[90:91], v[98:99]
    s_waitcnt lgkmcnt(0)
    v_pk_add_f32 v[100:101], v[100:101], v[108:109]
    v_pk_add_f32 v[102:103], v[102:103], v[110:111]
    v_pk_add_f32 v[104:105], v[104:105], v[112:113]
    v_pk_add_f32 v[106:107], v[106:107], v[114:115]
    v_pk_add_f32 v[84:85], v[84:85], v[100:101]
    v_pk_add_f32 v[86:87], v[86:87], v[102:103]
    v_pk_add_f32 v[88:89], v[88:89], v[104:105]
    v_pk_add_f32 v[90:91], v[90:91], v[106:107]
    v_pk_add_f32 v[84:85], v[84:85], v[124:125]
    v_pk_add_f32 v[86:87], v[86:87], v[126:127]
    v_pk_add_f32 v[88:89], v[88:89], v[128:129]
    v_pk_add_f32 v[90:91], v[90:91], v[130:131]
    v_cvt_pk_bf16_f32 v120, v84, v85
    v_cvt_pk_bf16_f32 v121, v86, v87
    v_cvt_pk_bf16_f32 v122, v88, v89
    v_cvt_pk_bf16_f32 v123, v90, v91
    buffer_store_dwordx4 v[120:123], v3, s[4:7], s43 offen sc1
    s_waitcnt vmcnt(1)
    v_cmp_gt_u32 vcc, 11, v20
    s_nop 0
    s_and_b64 vcc, vcc, s[52:53]
    s_cbranch_scc1 mk_ps34
mk_po35:
    s_barrier
    buffer_load_dwordx4 v[252:255], v2, s[4:7], s40 offen sc1
    s_add_u32 s40, s40, 4096
    buffer_load_dwordx4 v[248:251], v2, s[4:7], s40 offen sc1
    s_add_u32 s40, s40, 4096
    v_pk_mul_f32 v[108:109], v[84:85], v[84:85]
    v_pk_mul_f32 v[110:111], v[86:87], v[86:87]
    v_pk_mul_f32 v[112:113], v[88:89], v[88:89]
    v_pk_mul_f32 v[114:115], v[90:91], v[90:91]
    v_permlane32_swap_b32 v84, v108
    v_permlane32_swap_b32 v85, v109
    v_permlane32_swap_b32 v86, v110
    v_permlane32_swap_b32 v87, v111
    v_permlane32_swap_b32 v88, v112
    v_permlane32_swap_b32 v89, v113
    buffer_load_dwordx4 v[244:247], v2, s[4:7], s40 offen sc1
    s_add_u32 s40, s40, 4096
    v_permlane32_swap_b32 v90, v114
    v_permlane32_swap_b32 v91, v115
    v_pk_add_f32 v[84:85], v[84:85], v[108:109]
    v_pk_add_f32 v[86:87], v[86:87], v[110:111]
    v_pk_add_f32 v[88:89], v[88:89], v[112:113]
    v_pk_add_f32 v[90:91], v[90:91], v[114:115]
    s_nop 0
    v_permlane16_swap_b32 v84, v88
    v_permlane16_swap_b32 v85, v89
    v_permlane16_swap_b32 v86, v90
    v_permlane16_swap_b32 v87, v91
    buffer_load_dwordx4 v[240:243], v2, s[4:7], s40 offen sc1
    s_add_u32 s40, s40, 4096
    v_pk_add_f32 v[84:85], v[84:85], v[88:89]
    v_pk_add_f32 v[86:87], v[86:87], v[90:91]
    s_nop 0
    v_add_f32_dpp v84, v84, v84 row_ror:8 row_mask:0xf bank_mask:0xf
    v_add_f32_dpp v85, v85, v85 row_ror:8 row_mask:0xf bank_mask:0xf
    v_add_f32_dpp v86, v86, v86 row_ror:8 row_mask:0xf bank_mask:0xf
    v_add_f32_dpp v87, v87, v87 row_ror:8 row_mask:0xf bank_mask:0xf
    v_add_f32_dpp v84, v84, v84 row_ror:4 row_mask:0xf bank_mask:0xf
    v_add_f32_dpp v85, v85, v85 row_ror:4 row_mask:0xf bank_mask:0xf
    v_add_f32_dpp v86, v86, v86 row_ror:4 row_mask:0xf bank_mask:0xf
    v_add_f32_dpp v87, v87, v87 row_ror:4 row_mask:0xf bank_mask:0xf
    buffer_load_dwordx4 v[236:239], v2, s[4:7], s40 offen sc1
    s_add_u32 s40, s40, 4096
    ds_write_b128 v26, v[84:87]
    buffer_load_dwordx4 v[232:235], v2, s[4:7], s40 offen sc1
    s_add_u32 s40, s40, 4096
    buffer_load_dwordx4 v[228:231], v2, s[4:7], s40 offen sc1
    s_add_u32 s40, s40, 4096
    s_lshl_b32 s32, s22, 9
    s_add_u32 s32, s32, 15859712
    s_waitcnt lgkmcnt(0)
    s_barrier
    ds_read_b32 v84, v27
    ds_read_b32 v85, v27 offset:256
    ds_read_b32 v86, v27 offset:512
    ds_read_b32 v87, v27 offset:768
    buffer_load_dwordx4 v[224:227], v2, s[4:7], s40 offen sc1
    s_add_u32 s40, s40, 4096
    s_waitcnt lgkmcnt(0)
    v_add_f32 v84, v84, v85
    v_add_f32 v86, v86, v87
    v_add_f32 v84, v84, v86
    v_cvt_f64_f32 v[116:117], v84
    buffer_atomic_add_f64 v[116:117], v25, s[4:7], s32 offen sc1
    s_add_u32 s42, s42, 1048576
    s_add_u32 s43, s43, 1048576
    buffer_load_dwordx4 v[220:223], v2, s[4:7], s40 offen sc1
    s_add_u32 s40, s40, 4096
    buffer_load_dwordx4 v[216:219], v2, s[4:7], s40 offen sc1
    s_add_u32 s40, s40, 4096
    buffer_load_dwordx4 v[212:215], v2, s[4:7], s40 offen sc1
    s_add_u32 s40, s40, 4096
    buffer_load_dwordx4 v[208:211], v2, s[4:7], s40 offen sc1
    s_add_u32 s40, s40, 4096
    buffer_load_dwordx4 v[204:207], v2, s[4:7], s40 offen sc1
    s_add_u32 s40, s40, 4096
    buffer_load_dwordx4 v[200:203], v2, s[4:7], s40 offen sc1
    s_add_u32 s40, s40, 4096
    s_waitcnt vmcnt(14)
    v_mfma_f32_32x32x16_bf16 v[84:99], v[252:255], a[132:135], 0
    buffer_load_dwordx4 v[196:199], v2, s[4:7], s40 offen sc1
    s_add_u32 s40, s40, 4096
    s_waitcnt vmcnt(14)
    v_mfma_f32_32x32x16_bf16 v[84:99], v[248:251], a[140:143], v[84:99]
    s_waitcnt vmcnt(13)
    v_mfma_f32_32x32x16_bf16 v[84:99], v[244:247], a[148:151], v[84:99]
    buffer_load_dwordx4 v[192:195], v2, s[4:7], s40 offen sc1
    s_add_u32 s40, s40, 4096
    s_waitcnt vmcnt(13)
    v_mfma_f32_32x32x16_bf16 v[84:99], v[240:243], a[156:159], v[84:99]
    s_waitcnt vmcnt(8)
    s_barrier
    s_add_u32 s38, s26, 16056320
    buffer_atomic_add v21, v17, s[4:7], s38 offen sc1
    v_mfma_f32_32x32x16_bf16 v[84:99], v[236:239], a[164:167], v[84:99]
    buffer_load_dwordx4 v[188:191], v2, s[4:7], s40 offen sc1
    s_add_u32 s40, s40, 4096
    v_mfma_f32_32x32x16_bf16 v[84:99], v[232:235], a[172:175], v[84:99]
    v_mfma_f32_32x32x16_bf16 v[100:115], v[252:255], a[136:139], 0
    buffer_load_dwordx4 v[184:187], v2, s[4:7], s40 offen sc1
    s_add_u32 s40, s40, 4096
    v_mfma_f32_32x32x16_bf16 v[84:99], v[228:231], a[180:183], v[84:99]
    v_mfma_f32_32x32x16_bf16 v[100:115], v[248:251], a[144:147], v[100:115]
    buffer_load_dwordx4 v[136:139], v2, s[4:7], s40 offen sc1
    s_add_u32 s40, s40, 4096
    v_mfma_f32_32x32x16_bf16 v[84:99], v[224:227], a[188:191], v[84:99]
    v_mfma_f32_32x32x16_bf16 v[100:115], v[244:247], a[152:155], v[100:115]
    buffer_load_dwordx4 v[140:143], v2, s[4:7], s40 offen sc1
    s_add_u32 s40, s40, 4096
    s_waitcnt vmcnt(12)
    v_mfma_f32_32x32x16_bf16 v[84:99], v[220:223], a[196:199], v[84:99]
    v_mfma_f32_32x32x16_bf16 v[100:115], v[240:243], a[160:163], v[100:115]
    buffer_load_dwordx4 v[144:147], v2, s[4:7], s40 offen sc1
    s_add_u32 s40, s40, 4096
    s_waitcnt vmcnt(12)
    v_mfma_f32_32x32x16_bf16 v[84:99], v[216:219], a[204:207], v[84:99]
    v_mfma_f32_32x32x16_bf16 v[100:115], v[236:239], a[168:171], v[100:115]
    buffer_load_dwordx4 v[148:151], v2, s[4:7], s40 offen sc1
    s_waitcnt vmcnt(12)
    v_mfma_f32_32x32x16_bf16 v[84:99], v[212:215], a[212:215], v[84:99]
    v_mfma_f32_32x32x16_bf16 v[100:115], v[232:235], a[176:179], v[100:115]
    buffer_load_dwordx4 v[132:135], v3, s[4:7], s42 offen sc1
    s_waitcnt vmcnt(12)
    v_mfma_f32_32x32x16_bf16 v[84:99], v[208:211], a[220:223], v[84:99]
    v_mfma_f32_32x32x16_bf16 v[100:115], v[228:231], a[184:187], v[100:115]
    s_waitcnt vmcnt(11)
    v_mfma_f32_32x32x16_bf16 v[84:99], v[204:207], a[228:231], v[84:99]
    v_mfma_f32_32x32x16_bf16 v[100:115], v[224:227], a[192:195], v[100:115]
    s_waitcnt vmcnt(10)
    v_mfma_f32_32x32x16_bf16 v[84:99], v[200:203], a[236:239], v[84:99]
    v_mfma_f32_32x32x16_bf16 v[100:115], v[220:223], a[200:203], v[100:115]
    s_waitcnt vmcnt(9)
    v_mfma_f32_32x32x16_bf16 v[84:99], v[196:199], a[244:247], v[84:99]
    v_mfma_f32_32x32x16_bf16 v[100:115], v[216:219], a[208:211], v[100:115]
    s_waitcnt vmcnt(8)
    v_mfma_f32_32x32x16_bf16 v[84:99], v[192:195], a[252:255], v[84:99]
    v_mfma_f32_32x32x16_bf16 v[100:115], v[212:215], a[216:219], v[100:115]
    s_waitcnt vmcnt(6)
    v_mfma_f32_32x32x16_bf16 v[84:99], v[188:191], v[36:39], v[84:99]
    v_mfma_f32_32x32x16_bf16 v[100:115], v[208:211], a[224:227], v[100:115]
    s_waitcnt vmcnt(5)
    v_mfma_f32_32x32x16_bf16 v[84:99], v[184:187], v[44:47], v[84:99]
    v_mfma_f32_32x32x16_bf16 v[100:115], v[204:207], a[232:235], v[100:115]
    s_waitcnt vmcnt(4)
    v_mfma_f32_32x32x16_bf16 v[84:99], v[136:139], v[52:55], v[84:99]
    v_mfma_f32_32x32x16_bf16 v[100:115], v[200:203], a[240:243], v[100:115]
    s_waitcnt vmcnt(3)
    v_mfma_f32_32x32x16_bf16 v[84:99], v[140:143], v[60:63], v[84:99]
    v_mfma_f32_32x32x16_bf16 v[100:115], v[196:199], a[248:251], v[100:115]
    s_waitcnt vmcnt(2)
    v_mfma_f32_32x32x16_bf16 v[84:99], v[144:147], v[68:71], v[84:99]
    v_mfma_f32_32x32x16_bf16 v[100:115], v[192:195], v[32:35], v[100:115]
    s_waitcnt vmcnt(1)
    v_mfma_f32_32x32x16_bf16 v[84:99], v[148:151], v[76:79], v[84:99]
    v_mfma_f32_32x32x16_bf16 v[100:115], v[188:191], v[40:43], v[100:115]
    v_mfma_f32_32x32x16_bf16 v[100:115], v[184:187], v[48:51], v[100:115]
    v_mfma_f32_32x32x16_bf16 v[100:115], v[136:139], v[56:59], v[100:115]
    s_nop 8
    ds_write_b128 v14, v[84:87] offset:0
    v_mfma_f32_32x32x16_bf16 v[100:115], v[140:143], v[64:67], v[100:115]
    ds_write_b128 v14, v[88:91] offset:32
    v_mfma_f32_32x32x16_bf16 v[100:115], v[144:147], v[72:75], v[100:115]
    ds_write_b128 v14, v[92:95] offset:64
    v_mfma_f32_32x32x16_bf16 v[100:115], v[148:151], v[80:83], v[100:115]
    ds_write_b128 v14, v[96:99] offset:96
    s_nop 10
    ds_write_b128 v14, v[100:103] offset:4608
    ds_write_b128 v14, v[104:107] offset:4640
    ds_write_b128 v14, v[108:111] offset:4672
    ds_write_b128 v14, v[112:115] offset:4704
    s_add_u32 s37, s27, 16056320
    v_mov_b32 v20, 0
    buffer_atomic_add v20, v19, s[4:7], s37 offen sc0 sc1
    s_waitcnt lgkmcnt(0)
    s_barrier
    ds_read_b128 v[84:87], v15 offset:0
    ds_read_b128 v[88:91], v15 offset:16
    ds_read_b128 v[92:95], v15 offset:9216
    ds_read_b128 v[96:99], v15 offset:9232
    ds_read_b128 v[100:103], v15 offset:18432
    ds_read_b128 v[104:107], v15 offset:18448
    ds_read_b128 v[108:111], v15 offset:27648
    ds_read_b128 v[112:115], v15 offset:27664
    s_waitcnt vmcnt(1)
    v_lshlrev_b32 v124, 16, v132
    v_and_b32 v125, 0xffff0000, v132
    v_lshlrev_b32 v126, 16, v133
    v_and_b32 v127, 0xffff0000, v133
    v_lshlrev_b32 v128, 16, v134
    v_and_b32 v129, 0xffff0000, v134
    v_lshlrev_b32 v130, 16, v135
    v_and_b32 v131, 0xffff0000, v135
    s_waitcnt lgkmcnt(4)
    v_pk_add_f32 v[84:85], v[84:85], v[92:93]
    v_pk_add_f32 v[86:87], v[86:87], v[94:95]
    v_pk_add_f32 v[88:89], v[88:89], v[96:97]
    v_pk_add_f32 v[90:91], v[90:91], v[98:99]
    s_waitcnt lgkmcnt(0)
    v_pk_add_f32 v[100:101], v[100:101], v[108:109]
    v_pk_add_f32 v[102:103], v[102:103], v[110:111]
    v_pk_add_f32 v[104:105], v[104:105], v[112:113]
    v_pk_add_f32 v[106:107], v[106:107], v[114:115]
    v_pk_add_f32 v[84:85], v[84:85], v[100:101]
    v_pk_add_f32 v[86:87], v[86:87], v[102:103]
    v_pk_add_f32 v[88:89], v[88:89], v[104:105]
    v_pk_add_f32 v[90:91], v[90:91], v[106:107]
    v_pk_add_f32 v[84:85], v[84:85], v[124:125]
    v_pk_add_f32 v[86:87], v[86:87], v[126:127]
    v_pk_add_f32 v[88:89], v[88:89], v[128:129]
    v_pk_add_f32 v[90:91], v[90:91], v[130:131]
    v_cvt_pk_bf16_f32 v120, v84, v85
    v_cvt_pk_bf16_f32 v121, v86, v87
    v_cvt_pk_bf16_f32 v122, v88, v89
    v_cvt_pk_bf16_f32 v123, v90, v91
    buffer_store_dwordx4 v[120:123], v3, s[4:7], s43 offen sc1
    s_waitcnt vmcnt(1)
    v_cmp_gt_u32 vcc, 16, v20
    s_nop 0
    s_and_b64 vcc, vcc, s[54:55]
    s_cbranch_scc1 mk_ps37
mk_po38:
    s_barrier
    s_add_u32 s31, s41, 15859712
    buffer_load_dwordx4 v[236:239], v2, s[4:7], s31 offen offset:0 sc1
    buffer_load_dwordx4 v[240:243], v2, s[4:7], s31 offen offset:1024 sc1
    buffer_load_dwordx4 v[248:251], v2, s[4:7], s31 offen offset:2048 sc1
    buffer_load_dwordx4 v[252:255], v2, s[4:7], s31 offen offset:3072 sc1
    s_mov_b32 s31, 2097152
    buffer_load_dwordx4 v[244:247], v4, s[4:7], s31 offen sc1
    v_pk_mul_f32 v[108:109], v[84:85], v[84:85]
    v_pk_mul_f32 v[110:111], v[86:87], v[86:87]
    v_pk_mul_f32 v[112:113], v[88:89], v[88:89]
    v_pk_mul_f32 v[114:115], v[90:91], v[90:91]
    v_permlane32_swap_b32 v84, v108
    v_permlane32_swap_b32 v85, v109
    v_permlane32_swap_b32 v86, v110
    v_permlane32_swap_b32 v87, v111
    v_permlane32_swap_b32 v88, v112
    v_permlane32_swap_b32 v89, v113
    v_permlane32_swap_b32 v90, v114
    v_permlane32_swap_b32 v91, v115
    v_pk_add_f32 v[84:85], v[84:85], v[108:109]
    v_pk_add_f32 v[86:87], v[86:87], v[110:111]
    v_pk_add_f32 v[88:89], v[88:89], v[112:113]
    v_pk_add_f32 v[90:91], v[90:91], v[114:115]
    s_nop 0
    v_permlane16_swap_b32 v84, v88
    v_permlane16_swap_b32 v85, v89
    v_permlane16_swap_b32 v86, v90
    v_permlane16_swap_b32 v87, v91
    v_pk_add_f32 v[84:85], v[84:85], v[88:89]
    v_pk_add_f32 v[86:87], v[86:87], v[90:91]
    s_nop 0
    v_add_f32_dpp v84, v84, v84 row_ror:8 row_mask:0xf bank_mask:0xf
    v_add_f32_dpp v85, v85, v85 row_ror:8 row_mask:0xf bank_mask:0xf
    v_add_f32_dpp v86, v86, v86 row_ror:8 row_mask:0xf bank_mask:0xf
    v_add_f32_dpp v87, v87, v87 row_ror:8 row_mask:0xf bank_mask:0xf
    v_add_f32_dpp v84, v84, v84 row_ror:4 row_mask:0xf bank_mask:0xf
    v_add_f32_dpp v85, v85, v85 row_ror:4 row_mask:0xf bank_mask:0xf
    v_add_f32_dpp v86, v86, v86 row_ror:4 row_mask:0xf bank_mask:0xf
    v_add_f32_dpp v87, v87, v87 row_ror:4 row_mask:0xf bank_mask:0xf
    ds_write_b128 v26, v[84:87]
    s_lshl_b32 s32, s22, 9
    s_add_u32 s32, s32, 15876096
    s_waitcnt lgkmcnt(0)
    s_barrier
    ds_read_b32 v84, v27
    ds_read_b32 v85, v27 offset:256
    ds_read_b32 v86, v27 offset:512
    ds_read_b32 v87, v27 offset:768
    s_waitcnt lgkmcnt(0)
    v_add_f32 v84, v84, v85
    v_add_f32 v86, v86, v87
    v_add_f32 v84, v84, v86
    v_cvt_f64_f32 v[116:117], v84
    buffer_atomic_add_f64 v[116:117], v25, s[4:7], s32 offen sc1
    v_add_u32 v14, 1024, v7
    v_add_u32 v15, 2048, v7
    v_add_u32 v16, 3072, v7
    s_lshl_b32 s31, s3, 11
    s_add_u32 s31, s31, 151552
    v_lshl_add_u32 v24, v1, 2, s31
    v_and_b32 v25, 0x3e0, v5
    v_add_u32 v25, s31, v25
    s_waitcnt vmcnt(2)
    v_cvt_f32_f64 v84, v[236:237]
    v_cvt_f32_f64 v85, v[240:241]
    v_cvt_f32_f64 v86, v[248:249]
    v_cvt_f32_f64 v87, v[252:253]
    v_cvt_f32_f64 v88, v[238:239]
    v_cvt_f32_f64 v89, v[242:243]
    v_cvt_f32_f64 v90, v[250:251]
    v_cvt_f32_f64 v91, v[254:255]
    v_pk_mul_f32 v[84:85], v[84:85], s[16:17]
    v_pk_mul_f32 v[86:87], v[86:87], s[16:17]
    v_pk_mul_f32 v[88:89], v[88:89], s[16:17]
    v_pk_mul_f32 v[90:91], v[90:91], s[16:17]
    v_pk_fma_f32 v[88:89], v[84:85], v[84:85], v[88:89] neg_lo:[1,0,0] neg_hi:[1,0,0]
    v_pk_fma_f32 v[90:91], v[86:87], v[86:87], v[90:91] neg_lo:[1,0,0] neg_hi:[1,0,0]
    v_max_f32 v88, 0, v88
    v_max_f32 v89, 0, v89
    v_max_f32 v90, 0, v90
    v_max_f32 v91, 0, v91
    v_pk_add_f32 v[88:89], v[88:89], s[18:19]
    v_pk_add_f32 v[90:91], v[90:91], s[18:19]
    v_rsq_f32 v88, v88
    v_rsq_f32 v89, v89
    v_rsq_f32 v90, v90
    v_rsq_f32 v91, v91
    ds_write2st64_b32 v24, v88, v89 offset0:4 offset1:5
    ds_write2st64_b32 v24, v90, v91 offset0:6 offset1:7
    v_pk_mul_f32 v[84:85], v[84:85], v[88:89] neg_lo:[1,0] neg_hi:[1,0]
    v_pk_mul_f32 v[86:87], v[86:87], v[90:91] neg_lo:[1,0] neg_hi:[1,0]
    ds_write2st64_b32 v24, v84, v85 offset0:0 offset1:1
    ds_write2st64_b32 v24, v86, v87 offset0:2 offset1:3
    ds_read_b128 v[252:255], v25 offset:1024
    ds_read_b128 v[88:91], v25 offset:1040
    ds_read_b128 v[248:251], v25
    ds_read_b128 v[84:87], v25 offset:16
    s_waitcnt vmcnt(1)
    v_lshlrev_b32 v92, 16, v244
    v_and_b32 v93, 0xffff0000, v244
    v_lshlrev_b32 v94, 16, v245
    v_and_b32 v95, 0xffff0000, v245
    v_lshlrev_b32 v96, 16, v246
    v_and_b32 v97, 0xffff0000, v246
    v_lshlrev_b32 v98, 16, v247
    v_and_b32 v99, 0xffff0000, v247
    s_waitcnt lgkmcnt(0)
    v_pk_fma_f32 v[100:101], v[92:93], v[252:253], v[248:249]
    v_pk_fma_f32 v[102:103], v[94:95], v[254:255], v[250:251]
    v_pk_fma_f32 v[104:105], v[96:97], v[88:89], v[84:85]
    v_pk_fma_f32 v[106:107], v[98:99], v[90:91], v[86:87]
    v_cvt_pk_bf16_f32 v108, v100, v101
    v_cvt_pk_bf16_f32 v109, v102, v103
    v_cvt_pk_bf16_f32 v110, v104, v105
    v_cvt_pk_bf16_f32 v111, v106, v107
    ds_write_b128 v6, v[108:111] offset:17152
    ds_read2_b32 v[208:209], v16 offset0:224 offset1:225
    ds_read2_b32 v[210:211], v16 offset0:226 offset1:227
    ds_read2_b32 v[212:213], v16 offset0:192 offset1:193
    ds_read2_b32 v[214:215], v16 offset0:194 offset1:195
    ds_read2_b32 v[216:217], v16 offset0:160 offset1:161
    ds_read2_b32 v[218:219], v16 offset0:162 offset1:163
    ds_read2_b32 v[220:221], v16 offset0:128 offset1:129
    ds_read2_b32 v[222:223], v16 offset0:130 offset1:131
    ds_read2_b32 v[224:225], v16 offset0:96 offset1:97
    ds_read2_b32 v[226:227], v16 offset0:98 offset1:99
    ds_read2_b32 v[228:229], v16 offset0:64 offset1:65
    ds_read2_b32 v[230:231], v16 offset0:66 offset1:67
    s_waitcnt vmcnt(0)
    s_waitcnt lgkmcnt(12)
    s_barrier
    ds_read_b128 v[188:191], v8 offset:1920
    ds_read_b128 v[172:175], v8 offset:1408
    ds_read_b128 v[156:159], v8 offset:896
    ds_read_b128 v[140:143], v8 offset:384
    ds_read_b128 v[184:187], v8 offset:1792
    ds_read_b128 v[168:171], v8 offset:1280
    ds_read_b128 v[152:155], v8 offset:768
    ds_read_b128 v[136:139], v8 offset:256
    ds_read_b128 v[180:183], v8 offset:1664
    ds_read_b128 v[164:167], v8 offset:1152
    ds_read_b128 v[148:151], v8 offset:640
    ds_read_b128 v[132:135], v8 offset:128
    ds_read_b128 v[176:179], v8 offset:1536
    ds_read_b128 v[160:163], v8 offset:1024
    ds_read_b128 v[144:147], v8 offset:512
    ds_read_b128 v[128:131], v8 offset:0
    s_add_u32 s38, s26, 16089088
    buffer_atomic_add v21, v17, s[4:7], s38 offen sc1
    v_fma_f32 v100, v12, v100, v92
    v_fma_f32 v101, v12, v101, v93
    v_fma_f32 v102, v12, v102, v94
    v_fma_f32 v103, v12, v103, v95
    v_fma_f32 v104, v12, v104, v96
    v_fma_f32 v105, v12, v105, v97
    v_fma_f32 v106, v12, v106, v98
    v_fma_f32 v107, v12, v107, v99
    s_waitcnt lgkmcnt(14)
    v_mfma_f32_16x16x32_bf16 v[124:127], v[208:211], v[188:191], 0
    ds_read2_b32 v[232:233], v16 offset0:32 offset1:33
    ds_read2_b32 v[234:235], v16 offset0:34 offset1:35
    v_mfma_f32_16x16x32_bf16 v[120:123], v[208:211], v[172:175], 0
    s_waitcnt lgkmcnt(14)
    v_mfma_f32_16x16x32_bf16 v[116:119], v[208:211], v[156:159], 0
    v_mfma_f32_16x16x32_bf16 v[112:115], v[208:211], v[140:143], 0
    s_waitcnt lgkmcnt(12)
    v_mfma_f32_16x16x32_bf16 v[124:127], v[212:215], v[184:187], v[124:127]
    ds_read2_b32 v[208:209], v16 offset0:0 offset1:1
    ds_read2_b32 v[210:211], v16 offset0:2 offset1:3
    v_mfma_f32_16x16x32_bf16 v[120:123], v[212:215], v[168:171], v[120:123]
    s_waitcnt lgkmcnt(12)
    v_mfma_f32_16x16x32_bf16 v[116:119], v[212:215], v[152:155], v[116:119]
    v_mfma_f32_16x16x32_bf16 v[112:115], v[212:215], v[136:139], v[112:115]
    s_waitcnt lgkmcnt(10)
    v_mfma_f32_16x16x32_bf16 v[124:127], v[216:219], v[180:183], v[124:127]
    ds_read2_b32 v[212:213], v15 offset0:224 offset1:225
    ds_read2_b32 v[214:215], v15 offset0:226 offset1:227
    v_mfma_f32_16x16x32_bf16 v[120:123], v[216:219], v[164:167], v[120:123]
    s_waitcnt lgkmcnt(10)
    v_mfma_f32_16x16x32_bf16 v[116:119], v[216:219], v[148:151], v[116:119]
    v_mfma_f32_16x16x32_bf16 v[112:115], v[216:219], v[132:135], v[112:115]
    s_waitcnt lgkmcnt(8)
    v_mfma_f32_16x16x32_bf16 v[124:127], v[220:223], v[176:179], v[124:127]
    ds_read2_b32 v[216:217], v15 offset0:192 offset1:193
    ds_read2_b32 v[218:219], v15 offset0:194 offset1:195
    v_mfma_f32_16x16x32_bf16 v[120:123], v[220:223], v[160:163], v[120:123]
    s_waitcnt lgkmcnt(8)
    v_mfma_f32_16x16x32_bf16 v[116:119], v[220:223], v[144:147], v[116:119]
    v_mfma_f32_16x16x32_bf16 v[112:115], v[220:223], v[128:131], v[112:115]
    v_mfma_f32_16x16x32_bf16 v[124:127], v[224:227], v[172:175], v[124:127]
    ds_read2_b32 v[220:221], v15 offset0:160 offset1:161
    ds_read2_b32 v[222:223], v15 offset0:162 offset1:163
    v_mfma_f32_16x16x32_bf16 v[120:123], v[224:227], v[156:159], v[120:123]
    v_mfma_f32_16x16x32_bf16 v[116:119], v[224:227], v[140:143], v[116:119]
    v_mfma_f32_16x16x32_bf16 v[124:127], v[228:231], v[168:171], v[124:127]
    ds_read2_b32 v[224:225], v15 offset0:128 offset1:129
    ds_read2_b32 v[226:227], v15 offset0:130 offset1:131
    v_mfma_f32_16x16x32_bf16 v[120:123], v[228:231], v[152:155], v[120:123]
    ds_write_b128 v9, v[112:115] offset:0
    v_mfma_f32_16x16x32_bf16 v[116:119], v[228:231], v[136:139], v[116:119]
    s_waitcnt lgkmcnt(11)
    v_mfma_f32_16x16x32_bf16 v[124:127], v[232:235], v[164:167], v[124:127]
    ds_read2_b32 v[228:229], v15 offset0:96 offset1:97
    ds_read2_b32 v[230:231], v15 offset0:98 offset1:99
    v_mfma_f32_16x16x32_bf16 v[120:123], v[232:235], v[148:151], v[120:123]
    v_mfma_f32_16x16x32_bf16 v[116:119], v[232:235], v[132:135], v[116:119]
    s_waitcnt lgkmcnt(11)
    v_mfma_f32_16x16x32_bf16 v[124:127], v[208:211], v[160:163], v[124:127]
    ds_read2_b32 v[232:233], v15 offset0:64 offset1:65
    ds_read2_b32 v[234:235], v15 offset0:66 offset1:67
    v_mfma_f32_16x16x32_bf16 v[120:123], v[208:211], v[144:147], v[120:123]
    v_mfma_f32_16x16x32_bf16 v[116:119], v[208:211], v[128:131], v[116:119]
    s_waitcnt lgkmcnt(11)
    v_mfma_f32_16x16x32_bf16 v[124:127], v[212:215], v[156:159], v[124:127]
    ds_read2_b32 v[208:209], v15 offset0:32 offset1:33
    ds_read2_b32 v[210:211], v15 offset0:34 offset1:35
    v_mfma_f32_16x16x32_bf16 v[120:123], v[212:215], v[140:143], v[120:123]
    s_waitcnt lgkmcnt(11)
    v_mfma_f32_16x16x32_bf16 v[124:127], v[216:219], v[152:155], v[124:127]
    ds_read2_b32 v[212:213], v15 offset0:0 offset1:1
    ds_read2_b32 v[214:215], v15 offset0:2 offset1:3
    v_mfma_f32_16x16x32_bf16 v[120:123], v[216:219], v[136:139], v[120:123]
    ds_write_b128 v9, v[116:119] offset:1152
    s_waitcnt lgkmcnt(12)
    v_mfma_f32_16x16x32_bf16 v[124:127], v[220:223], v[148:151], v[124:127]
    v_mfma_f32_16x16x32_bf16 v[120:123], v[220:223], v[132:135], v[120:123]
    s_waitcnt lgkmcnt(10)
    v_mfma_f32_16x16x32_bf16 v[124:127], v[224:227], v[144:147], v[124:127]
    v_mfma_f32_16x16x32_bf16 v[120:123], v[224:227], v[128:131], v[120:123]
    s_waitcnt lgkmcnt(7)
    v_mfma_f32_16x16x32_bf16 v[124:127], v[228:231], v[140:143], v[124:127]
    s_waitcnt lgkmcnt(5)
    v_mfma_f32_16x16x32_bf16 v[124:127], v[232:235], v[136:139], v[124:127]
    s_waitcnt lgkmcnt(3)
    v_mfma_f32_16x16x32_bf16 v[124:127], v[208:211], v[132:135], v[124:127]
    s_waitcnt lgkmcnt(1)
    v_mfma_f32_16x16x32_bf16 v[124:127], v[212:215], v[128:131], v[124:127]
    ds_write_b128 v9, v[120:123] offset:2304
    s_nop 6
    ds_write_b128 v9, v[124:127] offset:3456
    s_waitcnt lgkmcnt(0)
    s_barrier
    ds_read_b128 v[192:195], v10 offset:0
    ds_read_b128 v[196:199], v10 offset:256
    ds_read_b128 v[200:203], v10 offset:4608
    ds_read_b128 v[204:207], v10 offset:4864
    ds_read2_b32 v[216:217], v16 offset0:96 offset1:97
    ds_read2_b32 v[218:219], v16 offset0:98 offset1:99
    ds_read2_b32 v[220:221], v16 offset0:64 offset1:65
    ds_read2_b32 v[222:223], v16 offset0:66 offset1:67
    ds_read2_b32 v[224:225], v16 offset0:32 offset1:33
    ds_read2_b32 v[226:227], v16 offset0:34 offset1:35
    ds_read2_b32 v[228:229], v16 offset0:0 offset1:1
    ds_read2_b32 v[230:231], v16 offset0:2 offset1:3
    ds_read2_b32 v[232:233], v15 offset0:224 offset1:225
    ds_read2_b32 v[234:235], v15 offset0:226 offset1:227
    ds_read2_b32 v[208:209], v15 offset0:192 offset1:193
    ds_read2_b32 v[210:211], v15 offset0:194 offset1:195
    s_mov_b32 s31, 7340032
    s_waitcnt lgkmcnt(12)
    v_pk_add_f32 v[192:193], v[192:193], v[100:101]
    v_pk_add_f32 v[194:195], v[194:195], v[102:103]
    v_pk_add_f32 v[196:197], v[196:197], v[104:105]
    v_pk_add_f32 v[198:199], v[198:199], v[106:107]
    v_pk_add_f32 v[192:193], v[192:193], v[200:201]
    v_pk_add_f32 v[194:195], v[194:195], v[202:203]
    v_pk_add_f32 v[196:197], v[196:197], v[204:205]
    v_pk_add_f32 v[198:199], v[198:199], v[206:207]
    v_cvt_pk_bf16_f32 v108, v192, v193
    v_cvt_pk_bf16_f32 v109, v194, v195
    v_cvt_pk_bf16_f32 v110, v196, v197
    v_cvt_pk_bf16_f32 v111, v198, v199
    buffer_store_dwordx4 v[108:111], v4, s[4:7], s31 offen sc1
    s_waitcnt lgkmcnt(10)
    v_mfma_f32_16x16x32_bf16 v[112:115], v[216:219], v[188:191], 0
    ds_read2_b32 v[212:213], v15 offset0:160 offset1:161
    ds_read2_b32 v[214:215], v15 offset0:162 offset1:163
    s_waitcnt lgkmcnt(10)
    v_mfma_f32_16x16x32_bf16 v[112:115], v[220:223], v[184:187], v[112:115]
    ds_read2_b32 v[216:217], v15 offset0:128 offset1:129
    ds_read2_b32 v[218:219], v15 offset0:130 offset1:131
    s_waitcnt lgkmcnt(10)
    v_mfma_f32_16x16x32_bf16 v[112:115], v[224:227], v[180:183], v[112:115]
    ds_read2_b32 v[220:221], v15 offset0:96 offset1:97
    ds_read2_b32 v[222:223], v15 offset0:98 offset1:99
    s_waitcnt lgkmcnt(10)
    v_mfma_f32_16x16x32_bf16 v[112:115], v[228:231], v[176:179], v[112:115]
    ds_read2_b32 v[224:225], v15 offset0:64 offset1:65
    ds_read2_b32 v[226:227], v15 offset0:66 offset1:67
    s_waitcnt lgkmcnt(10)
    v_mfma_f32_16x16x32_bf16 v[112:115], v[232:235], v[172:175], v[112:115]
    ds_read2_b32 v[228:229], v15 offset0:32 offset1:33
    ds_read2_b32 v[230:231], v15 offset0:34 offset1:35
    s_add_u32 s37, s27, 16089088
    v_mov_b32 v20, 0
    buffer_atomic_add v20, v19, s[4:7], s37 offen sc0 sc1
    v_mfma_f32_16x16x32_bf16 v[116:119], v[232:235], v[188:191], 0
    s_waitcnt lgkmcnt(10)
    v_mfma_f32_16x16x32_bf16 v[112:115], v[208:211], v[168:171], v[112:115]
    ds_read2_b32 v[232:233], v15 offset0:0 offset1:1
    ds_read2_b32 v[234:235], v15 offset0:2 offset1:3
    v_mfma_f32_16x16x32_bf16 v[116:119], v[208:211], v[184:187], v[116:119]
    s_waitcnt lgkmcnt(10)
    v_mfma_f32_16x16x32_bf16 v[112:115], v[212:215], v[164:167], v[112:115]
    ds_read2_b32 v[208:209], v14 offset0:224 offset1:225
    ds_read2_b32 v[210:211], v14 offset0:226 offset1:227
    v_mfma_f32_16x16x32_bf16 v[116:119], v[212:215], v[180:183], v[116:119]
    s_waitcnt lgkmcnt(10)
    v_mfma_f32_16x16x32_bf16 v[112:115], v[216:219], v[160:163], v[112:115]
    ds_read2_b32 v[212:213], v14 offset0:192 offset1:193
    ds_read2_b32 v[214:215], v14 offset0:194 offset1:195
    v_mfma_f32_16x16x32_bf16 v[116:119], v[216:219], v[176:179], v[116:119]
    s_waitcnt lgkmcnt(10)
    v_mfma_f32_16x16x32_bf16 v[112:115], v[220:223], v[156:159], v[112:115]
    ds_read2_b32 v[216:217], v14 offset0:160 offset1:161
    ds_read2_b32 v[218:219], v14 offset0:162 offset1:163
    v_mfma_f32_16x16x32_bf16 v[116:119], v[220:223], v[172:175], v[116:119]
    v_mfma_f32_16x16x32_bf16 v[120:123], v[220:223], v[188:191], 0
    s_waitcnt lgkmcnt(10)
    v_mfma_f32_16x16x32_bf16 v[112:115], v[224:227], v[152:155], v[112:115]
    ds_read2_b32 v[220:221], v14 offset0:128 offset1:129
    ds_read2_b32 v[222:223], v14 offset0:130 offset1:131
    v_mfma_f32_16x16x32_bf16 v[116:119], v[224:227], v[168:171], v[116:119]
    v_mfma_f32_16x16x32_bf16 v[120:123], v[224:227], v[184:187], v[120:123]
    s_waitcnt lgkmcnt(10)
    v_mfma_f32_16x16x32_bf16 v[112:115], v[228:231], v[148:151], v[112:115]
    ds_read2_b32 v[224:225], v14 offset0:96 offset1:97
    ds_read2_b32 v[226:227], v14 offset0:98 offset1:99
    v_mfma_f32_16x16x32_bf16 v[116:119], v[228:231], v[164:167], v[116:119]
    v_mfma_f32_16x16x32_bf16 v[120:123], v[228:231], v[180:183], v[120:123]
    s_waitcnt lgkmcnt(10)
    v_mfma_f32_16x16x32_bf16 v[112:115], v[232:235], v[144:147], v[112:115]
    ds_read2_b32 v[228:229], v14 offset0:64 offset1:65
    ds_read2_b32 v[230:231], v14 offset0:66 offset1:67
    v_mfma_f32_16x16x32_bf16 v[116:119], v[232:235], v[160:163], v[116:119]
    v_mfma_f32_16x16x32_bf16 v[120:123], v[232:235], v[176:179], v[120:123]
    s_waitcnt lgkmcnt(10)
    v_mfma_f32_16x16x32_bf16 v[112:115], v[208:211], v[140:143], v[112:115]
    ds_read2_b32 v[232:233], v14 offset0:32 offset1:33
    ds_read2_b32 v[234:235], v14 offset0:34 offset1:35
    v_mfma_f32_16x16x32_bf16 v[116:119], v[208:211], v[156:159], v[116:119]
    v_mfma_f32_16x16x32_bf16 v[120:123], v[208:211], v[172:175], v[120:123]
    v_mfma_f32_16x16x32_bf16 v[124:127], v[208:211], v[188:191], 0
    s_waitcnt lgkmcnt(10)
    v_mfma_f32_16x16x32_bf16 v[112:115], v[212:215], v[136:139], v[112:115]
    ds_read2_b32 v[208:209], v14 offset0:0 offset1:1
    ds_read2_b32 v[210:211], v14 offset0:2 offset1:3
    v_mfma_f32_16x16x32_bf16 v[116:119], v[212:215], v[152:155], v[116:119]
    v_mfma_f32_16x16x32_bf16 v[120:123], v[212:215], v[168:171], v[120:123]
    v_mfma_f32_16x16x32_bf16 v[124:127], v[212:215], v[184:187], v[124:127]
    s_waitcnt lgkmcnt(10)
    v_mfma_f32_16x16x32_bf16 v[112:115], v[216:219], v[132:135], v[112:115]
    ds_read2_b32 v[212:213], v7 offset0:224 offset1:225
    ds_read2_b32 v[214:215], v7 offset0:226 offset1:227
    v_mfma_f32_16x16x32_bf16 v[116:119], v[216:219], v[148:151], v[116:119]
    v_mfma_f32_16x16x32_bf16 v[120:123], v[216:219], v[164:167], v[120:123]
    v_mfma_f32_16x16x32_bf16 v[124:127], v[216:219], v[180:183], v[124:127]
    s_waitcnt lgkmcnt(10)
    v_mfma_f32_16x16x32_bf16 v[112:115], v[220:223], v[128:131], v[112:115]
    ds_read2_b32 v[216:217], v7 offset0:192 offset1:193
    ds_read2_b32 v[218:219], v7 offset0:194 offset1:195
    v_mfma_f32_16x16x32_bf16 v[116:119], v[220:223], v[144:147], v[116:119]
    v_mfma_f32_16x16x32_bf16 v[120:123], v[220:223], v[160:163], v[120:123]
    v_mfma_f32_16x16x32_bf16 v[124:127], v[220:223], v[176:179], v[124:127]
    s_waitcnt lgkmcnt(10)
    v_mfma_f32_16x16x32_bf16 v[116:119], v[224:227], v[140:143], v[116:119]
    ds_read2_b32 v[220:221], v7 offset0:160 offset1:161
    ds_read2_b32 v[222:223], v7 offset0:162 offset1:163
    s_waitcnt vmcnt(1)
    s_barrier
    s_add_u32 s38, s26, 16121856
    buffer_atomic_add v21, v17, s[4:7], s38 offen sc1
    s_waitcnt vmcnt(1)
    v_cmp_gt_u32 vcc, 16, v20
    s_nop 0
    s_and_b64 vcc, vcc, s[54:55]
    s_cbranch_scc1 mk_ps40
mk_po41:
    s_barrier
    s_add_u32 s31, s41, 15876096
    buffer_load_dwordx4 v[236:239], v2, s[4:7], s31 offen offset:0 sc1
    buffer_load_dwordx4 v[240:243], v2, s[4:7], s31 offen offset:1024 sc1
    buffer_load_dwordx4 v[248:251], v2, s[4:7], s31 offen offset:2048 sc1
    buffer_load_dwordx4 v[252:255], v2, s[4:7], s31 offen offset:3072 sc1
    s_mov_b32 s31, 3145728
    buffer_load_dwordx4 v[244:247], v4, s[4:7], s31 offen sc1
    v_mfma_f32_16x16x32_bf16 v[120:123], v[224:227], v[156:159], v[120:123]
    v_mfma_f32_16x16x32_bf16 v[124:127], v[224:227], v[172:175], v[124:127]
    s_waitcnt lgkmcnt(10)
    v_mfma_f32_16x16x32_bf16 v[116:119], v[228:231], v[136:139], v[116:119]
    ds_read2_b32 v[224:225], v7 offset0:128 offset1:129
    ds_read2_b32 v[226:227], v7 offset0:130 offset1:131
    v_mfma_f32_16x16x32_bf16 v[120:123], v[228:231], v[152:155], v[120:123]
    v_mfma_f32_16x16x32_bf16 v[124:127], v[228:231], v[168:171], v[124:127]
    s_waitcnt lgkmcnt(10)
    v_mfma_f32_16x16x32_bf16 v[116:119], v[232:235], v[132:135], v[116:119]
    ds_read2_b32 v[228:229], v7 offset0:96 offset1:97
    ds_read2_b32 v[230:231], v7 offset0:98 offset1:99
    v_mfma_f32_16x16x32_bf16 v[120:123], v[232:235], v[148:151], v[120:123]
    v_mfma_f32_16x16x32_bf16 v[124:127], v[232:235], v[164:167], v[124:127]
    s_waitcnt lgkmcnt(10)
    v_mfma_f32_16x16x32_bf16 v[116:119], v[208:211], v[128:131], v[116:119]
    ds_read2_b32 v[232:233], v7 offset0:64 offset1:65
    ds_read2_b32 v[234:235], v7 offset0:66 offset1:67
    v_mfma_f32_16x16x32_bf16 v[120:123], v[208:211], v[144:147], v[120:123]
    v_mfma_f32_16x16x32_bf16 v[124:127], v[208:211], v[160:163], v[124:127]
    s_waitcnt lgkmcnt(10)
    v_mfma_f32_16x16x32_bf16 v[120:123], v[212:215], v[140:143], v[120:123]
    ds_read2_b32 v[208:209], v7 offset0:32 offset1:33
    ds_read2_b32 v[210:211], v7 offset0:34 offset1:35
    v_mfma_f32_16x16x32_bf16 v[124:127], v[212:215], v[156:159], v[124:127]
    s_waitcnt lgkmcnt(10)
    v_mfma_f32_16x16x32_bf16 v[120:123], v[216:219], v[136:139], v[120:123]
    ds_read2_b32 v[212:213], v7 offset0:0 offset1:1
    ds_read2_b32 v[214:215], v7 offset0:2 offset1:3
    v_mfma_f32_16x16x32_bf16 v[124:127], v[216:219], v[152:155], v[124:127]
    s_waitcnt lgkmcnt(10)
    v_mfma_f32_16x16x32_bf16 v[120:123], v[220:223], v[132:135], v[120:123]
    v_mfma_f32_16x16x32_bf16 v[124:127], v[220:223], v[148:151], v[124:127]
    s_waitcnt lgkmcnt(8)
    v_mfma_f32_16x16x32_bf16 v[120:123], v[224:227], v[128:131], v[120:123]
    v_mfma_f32_16x16x32_bf16 v[124:127], v[224:227], v[144:147], v[124:127]
    s_waitcnt lgkmcnt(6)
    v_mfma_f32_16x16x32_bf16 v[124:127], v[228:231], v[140:143], v[124:127]
    s_waitcnt lgkmcnt(4)
    v_mfma_f32_16x16x32_bf16 v[124:127], v[232:235], v[136:139], v[124:127]
    s_waitcnt lgkmcnt(2)
    v_mfma_f32_16x16x32_bf16 v[124:127], v[208:211], v[132:135], v[124:127]
    s_waitcnt lgkmcnt(0)
    v_mfma_f32_16x16x32_bf16 v[124:127], v[212:215], v[128:131], v[124:127]
    s_waitcnt vmcnt(1)
    v_cvt_f32_f64 v84, v[236:237]
    v_cvt_f32_f64 v85, v[240:241]
    v_cvt_f32_f64 v86, v[248:249]
    v_cvt_f32_f64 v87, v[252:253]
    v_cvt_f32_f64 v88, v[238:239]
    v_cvt_f32_f64 v89, v[242:243]
    v_cvt_f32_f64 v90, v[250:251]
    v_cvt_f32_f64 v91, v[254:255]
    v_pk_mul_f32 v[84:85], v[84:85], s[16:17]
    v_pk_mul_f32 v[86:87], v[86:87], s[16:17]
    v_pk_mul_f32 v[88:89], v[88:89], s[16:17]
    v_pk_mul_f32 v[90:91], v[90:91], s[16:17]
    v_pk_fma_f32 v[88:89], v[84:85], v[84:85], v[88:89] neg_lo:[1,0,0] neg_hi:[1,0,0]
    v_pk_fma_f32 v[90:91], v[86:87], v[86:87], v[90:91] neg_lo:[1,0,0] neg_hi:[1,0,0]
    v_max_f32 v88, 0, v88
    v_max_f32 v89, 0, v89
    v_max_f32 v90, 0, v90
    v_max_f32 v91, 0, v91
    v_pk_add_f32 v[88:89], v[88:89], s[18:19]
    v_pk_add_f32 v[90:91], v[90:91], s[18:19]
    v_rsq_f32 v88, v88
    v_rsq_f32 v89, v89
    v_rsq_f32 v90, v90
    v_rsq_f32 v91, v91
    ds_write2st64_b32 v24, v88, v89 offset0:4 offset1:5
    ds_write2st64_b32 v24, v90, v91 offset0:6 offset1:7
    v_pk_mul_f32 v[84:85], v[84:85], v[88:89] neg_lo:[1,0] neg_hi:[1,0]
    v_pk_mul_f32 v[86:87], v[86:87], v[90:91] neg_lo:[1,0] neg_hi:[1,0]
    ds_write2st64_b32 v24, v84, v85 offset0:0 offset1:1
    ds_write2st64_b32 v24, v86, v87 offset0:2 offset1:3
    ds_read_b128 v[252:255], v25 offset:1024
    ds_read_b128 v[88:91], v25 offset:1040
    ds_read_b128 v[248:251], v25
    ds_read_b128 v[84:87], v25 offset:16
    s_waitcnt vmcnt(0)
    s_mul_i32 s35, s20, 98304
    s_add_u32 s35, s35, s41
    s_add_u32 s35, s35, 7340032
    s_add_u32 s35, s35, s44
    v_lshlrev_b32 v92, 16, v244
    v_and_b32 v93, 0xffff0000, v244
    v_lshlrev_b32 v94, 16, v245
    v_and_b32 v95, 0xffff0000, v245
    v_lshlrev_b32 v96, 16, v246
    v_and_b32 v97, 0xffff0000, v246
    v_lshlrev_b32 v98, 16, v247
    v_and_b32 v99, 0xffff0000, v247
    s_waitcnt lgkmcnt(0)
    v_pk_fma_f32 v[100:101], v[92:93], v[252:253], v[248:249]
    v_pk_fma_f32 v[102:103], v[94:95], v[254:255], v[250:251]
    v_pk_fma_f32 v[104:105], v[96:97], v[88:89], v[84:85]
    v_pk_fma_f32 v[106:107], v[98:99], v[90:91], v[86:87]
    v_cvt_pk_bf16_f32 v108, v100, v101
    v_cvt_pk_bf16_f32 v109, v102, v103
    v_cvt_pk_bf16_f32 v110, v104, v105
    v_cvt_pk_bf16_f32 v111, v106, v107
    ds_write_b128 v6, v[108:111] offset:19200
    ds_read2_b32 v[216:217], v16 offset0:224 offset1:225
    ds_read2_b32 v[218:219], v16 offset0:226 offset1:227
    ds_read2_b32 v[220:221], v16 offset0:192 offset1:193
    ds_read2_b32 v[222:223], v16 offset0:194 offset1:195
    ds_read2_b32 v[224:225], v16 offset0:160 offset1:161
    ds_read2_b32 v[226:227], v16 offset0:162 offset1:163
    ds_read2_b32 v[228:229], v16 offset0:128 offset1:129
    ds_read2_b32 v[230:231], v16 offset0:130 offset1:131
    ds_read2_b32 v[232:233], v16 offset0:96 offset1:97
    ds_read2_b32 v[234:235], v16 offset0:98 offset1:99
    ds_read2_b32 v[208:209], v16 offset0:64 offset1:65
    ds_read2_b32 v[210:211], v16 offset0:66 offset1:67
    s_waitcnt lgkmcnt(12)
    s_barrier
    ds_read_b128 v[188:191], v8 offset:3968
    ds_read_b128 v[172:175], v8 offset:3456
    ds_read_b128 v[156:159], v8 offset:2944
    ds_read_b128 v[140:143], v8 offset:2432
    ds_read_b128 v[184:187], v8 offset:3840
    ds_read_b128 v[168:171], v8 offset:3328
    ds_read_b128 v[152:155], v8 offset:2816
    ds_read_b128 v[136:139], v8 offset:2304
    ds_read_b128 v[180:183], v8 offset:3712
    ds_read_b128 v[164:167], v8 offset:3200
    ds_read_b128 v[148:151], v8 offset:2688
    ds_read_b128 v[132:135], v8 offset:2176
    ds_read_b128 v[176:179], v8 offset:3584
    ds_read_b128 v[160:163], v8 offset:3072
    ds_read_b128 v[144:147], v8 offset:2560
    ds_read_b128 v[128:131], v8 offset:2048
    v_fma_f32 v100, v12, v100, v92
    v_fma_f32 v101, v12, v101, v93
    v_fma_f32 v102, v12, v102, v94
    v_fma_f32 v103, v12, v103, v95
    v_fma_f32 v104, v12, v104, v96
    v_fma_f32 v105, v12, v105, v97
    v_fma_f32 v106, v12, v106, v98
    v_fma_f32 v107, v12, v107, v99
    s_add_u32 s37, s27, 16121856
    v_mov_b32 v20, 0
    buffer_atomic_add v20, v19, s[4:7], s37 offen sc0 sc1
    s_waitcnt lgkmcnt(14)
    v_mfma_f32_16x16x32_bf16 v[124:127], v[216:219], v[188:191], v[124:127]
    ds_read2_b32 v[212:213], v16 offset0:32 offset1:33
    ds_read2_b32 v[214:215], v16 offset0:34 offset1:35
    v_mfma_f32_16x16x32_bf16 v[120:123], v[216:219], v[172:175], v[120:123]
    s_waitcnt lgkmcnt(14)
    v_mfma_f32_16x16x32_bf16 v[116:119], v[216:219], v[156:159], v[116:119]
    v_mfma_f32_16x16x32_bf16 v[112:115], v[216:219], v[140:143], v[112:115]
    s_waitcnt lgkmcnt(12)
    v_mfma_f32_16x16x32_bf16 v[124:127], v[220:223], v[184:187], v[124:127]
    ds_read2_b32 v[216:217], v16 offset0:0 offset1:1
    ds_read2_b32 v[218:219], v16 offset0:2 offset1:3
    v_mfma_f32_16x16x32_bf16 v[120:123], v[220:223], v[168:171], v[120:123]
    s_waitcnt lgkmcnt(12)
    v_mfma_f32_16x16x32_bf16 v[116:119], v[220:223], v[152:155], v[116:119]
    v_mfma_f32_16x16x32_bf16 v[112:115], v[220:223], v[136:139], v[112:115]
    s_waitcnt lgkmcnt(10)
    v_mfma_f32_16x16x32_bf16 v[124:127], v[224:227], v[180:183], v[124:127]
    ds_read2_b32 v[220:221], v15 offset0:224 offset1:225
    ds_read2_b32 v[222:223], v15 offset0:226 offset1:227
    v_mfma_f32_16x16x32_bf16 v[120:123], v[224:227], v[164:167], v[120:123]
    s_waitcnt lgkmcnt(10)
    v_mfma_f32_16x16x32_bf16 v[116:119], v[224:227], v[148:151], v[116:119]
    v_mfma_f32_16x16x32_bf16 v[112:115], v[224:227], v[132:135], v[112:115]
    s_waitcnt lgkmcnt(8)
    v_mfma_f32_16x16x32_bf16 v[124:127], v[228:231], v[176:179], v[124:127]
    ds_read2_b32 v[224:225], v15 offset0:192 offset1:193
    ds_read2_b32 v[226:227], v15 offset0:194 offset1:195
    v_mfma_f32_16x16x32_bf16 v[120:123], v[228:231], v[160:163], v[120:123]
    s_waitcnt lgkmcnt(8)
    v_mfma_f32_16x16x32_bf16 v[116:119], v[228:231], v[144:147], v[116:119]
    v_mfma_f32_16x16x32_bf16 v[112:115], v[228:231], v[128:131], v[112:115]
    v_mfma_f32_16x16x32_bf16 v[124:127], v[232:235], v[172:175], v[124:127]
    ds_read2_b32 v[228:229], v15 offset0:160 offset1:161
    ds_read2_b32 v[230:231], v15 offset0:162 offset1:163
    v_mfma_f32_16x16x32_bf16 v[120:123], v[232:235], v[156:159], v[120:123]
    v_mfma_f32_16x16x32_bf16 v[116:119], v[232:235], v[140:143], v[116:119]
    v_mfma_f32_16x16x32_bf16 v[124:127], v[208:211], v[168:171], v[124:127]
    ds_read2_b32 v[232:233], v15 offset0:128 offset1:129
    ds_read2_b32 v[234:235], v15 offset0:130 offset1:131
    v_mfma_f32_16x16x32_bf16 v[120:123], v[208:211], v[152:155], v[120:123]
    ds_write_b128 v9, v[112:115] offset:0
    v_mfma_f32_16x16x32_bf16 v[116:119], v[208:211], v[136:139], v[116:119]
    s_waitcnt lgkmcnt(11)
    v_mfma_f32_16x16x32_bf16 v[124:127], v[212:215], v[164:167], v[124:127]
    ds_read2_b32 v[208:209], v15 offset0:96 offset1:97
    ds_read2_b32 v[210:211], v15 offset0:98 offset1:99
    v_mfma_f32_16x16x32_bf16 v[120:123], v[212:215], v[148:151], v[120:123]
    v_mfma_f32_16x16x32_bf16 v[116:119], v[212:215], v[132:135], v[116:119]
    s_waitcnt lgkmcnt(11)
    v_mfma_f32_16x16x32_bf16 v[124:127], v[216:219], v[160:163], v[124:127]
    ds_read2_b32 v[212:213], v15 offset0:64 offset1:65
    ds_read2_b32 v[214:215], v15 offset0:66 offset1:67
    v_mfma_f32_16x16x32_bf16 v[120:123], v[216:219], v[144:147], v[120:123]
    v_mfma_f32_16x16x32_bf16 v[116:119], v[216:219], v[128:131], v[116:119]
    s_waitcnt lgkmcnt(11)
    v_mfma_f32_16x16x32_bf16 v[124:127], v[220:223], v[156:159], v[124:127]
    ds_read2_b32 v[216:217], v15 offset0:32 offset1:33
    ds_read2_b32 v[218:219], v15 offset0:34 offset1:35
    v_mfma_f32_16x16x32_bf16 v[120:123], v[220:223], v[140:143], v[120:123]
    s_waitcnt lgkmcnt(11)
    v_mfma_f32_16x16x32_bf16 v[124:127], v[224:227], v[152:155], v[124:127]
    ds_read2_b32 v[220:221], v15 offset0:0 offset1:1
    ds_read2_b32 v[222:223], v15 offset0:2 offset1:3
    v_mfma_f32_16x16x32_bf16 v[120:123], v[224:227], v[136:139], v[120:123]
    ds_write_b128 v9, v[116:119] offset:1152
    s_waitcnt lgkmcnt(12)
    v_mfma_f32_16x16x32_bf16 v[124:127], v[228:231], v[148:151], v[124:127]
    v_mfma_f32_16x16x32_bf16 v[120:123], v[228:231], v[132:135], v[120:123]
    s_waitcnt lgkmcnt(10)
    v_mfma_f32_16x16x32_bf16 v[124:127], v[232:235], v[144:147], v[124:127]
    v_mfma_f32_16x16x32_bf16 v[120:123], v[232:235], v[128:131], v[120:123]
    s_waitcnt lgkmcnt(7)
    v_mfma_f32_16x16x32_bf16 v[124:127], v[208:211], v[140:143], v[124:127]
    s_waitcnt lgkmcnt(5)
    v_mfma_f32_16x16x32_bf16 v[124:127], v[212:215], v[136:139], v[124:127]
    s_waitcnt lgkmcnt(3)
    v_mfma_f32_16x16x32_bf16 v[124:127], v[216:219], v[132:135], v[124:127]
    s_waitcnt lgkmcnt(1)
    v_mfma_f32_16x16x32_bf16 v[124:127], v[220:223], v[128:131], v[124:127]
    ds_write_b128 v9, v[120:123] offset:2304
    s_nop 6
    ds_write_b128 v9, v[124:127] offset:3456
    s_waitcnt vmcnt(0)
    v_cmp_gt_u32 vcc, 16, v20
    s_nop 0
    s_and_b64 vcc, vcc, s[54:55]
    s_cbranch_scc1 mk_ps43
mk_po44:
    s_barrier
    s_add_u32 m0, s41, 32768
    s_nop 0
    buffer_load_dwordx4 v2, s[4:7], s35 offen offset:0 sc1 lds
    s_waitcnt lgkmcnt(0)
    s_barrier
    ds_read_b128 v[192:195], v10 offset:0
    ds_read_b128 v[196:199], v10 offset:256
    ds_read_b128 v[200:203], v10 offset:4608
    ds_read_b128 v[204:207], v10 offset:4864
    s_mov_b32 s31, 8388608
    s_waitcnt lgkmcnt(0)
    buffer_load_dwordx4 v2, s[4:7], s35 offen offset:1024 sc1 lds
    v_pk_add_f32 v[192:193], v[192:193], v[100:101]
    v_pk_add_f32 v[194:195], v[194:195], v[102:103]
    v_pk_add_f32 v[196:197], v[196:197], v[104:105]
    v_pk_add_f32 v[198:199], v[198:199], v[106:107]
    v_pk_add_f32 v[192:193], v[192:193], v[200:201]
    v_pk_add_f32 v[194:195], v[194:195], v[202:203]
    v_pk_add_f32 v[196:197], v[196:197], v[204:205]
    v_pk_add_f32 v[198:199], v[198:199], v[206:207]
    v_cvt_pk_bf16_f32 v108, v192, v193
    v_cvt_pk_bf16_f32 v109, v194, v195
    v_cvt_pk_bf16_f32 v110, v196, v197
    v_cvt_pk_bf16_f32 v111, v198, v199
    buffer_load_dwordx4 v2, s[4:7], s35 offen offset:2048 sc1 lds
    buffer_store_dwordx4 v[108:111], v4, s[4:7], s31 offen sc1
    buffer_load_dwordx4 v2, s[4:7], s35 offen offset:3072 sc1 lds
    s_add_u32 s35, s35, 16384
    s_add_u32 m0, s41, 49152
    s_nop 0
    buffer_load_dwordx4 v2, s[4:7], s35 offen offset:0 sc1 lds
    buffer_load_dwordx4 v2, s[4:7], s35 offen offset:1024 sc1 lds
    buffer_load_dwordx4 v2, s[4:7], s35 offen offset:2048 sc1 lds
    buffer_load_dwordx4 v2, s[4:7], s35 offen offset:3072 sc1 lds
    s_add_u32 s35, s35, 16384
    s_add_u32 m0, s41, 65536
    s_nop 0
    buffer_load_dwordx4 v2, s[4:7], s35 offen offset:0 sc1 lds
    buffer_load_dwordx4 v2, s[4:7], s35 offen offset:1024 sc1 lds
    buffer_load_dwordx4 v2, s[4:7], s35 offen offset:2048 sc1 lds
    s_waitcnt vmcnt(8)
    s_barrier
    s_add_u32 s38, s26, 16154624
    buffer_atomic_add v21, v17, s[4:7], s38 offen sc1
    s_cmp_eq_u32 s30, 0
    s_cbranch_scc1 mk_idle1
    buffer_load_dwordx4 v2, s[4:7], s35 offen offset:3072 sc1 lds
    s_add_u32 s35, s35, 16384
    s_add_u32 m0, s41, 81920
    s_nop 0
    buffer_load_dwordx4 v2, s[4:7], s35 offen offset:0 sc1 lds
    buffer_load_dwordx4 v2, s[4:7], s35 offen offset:1024 sc1 lds
    buffer_load_dwordx4 v2, s[4:7], s35 offen offset:2048 sc1 lds
    buffer_load_dwordx4 v2, s[4:7], s35 offen offset:3072 sc1 lds
    s_add_u32 s35, s35, 16384
    v_add_u32 v24, s41, v28
    v_mov_b32 v164, 0
    v_mov_b32 v165, 0
    v_mov_b32 v166, 0
    v_mov_b32 v167, 0
    s_waitcnt vmcnt(13)
    ds_read_b64_tr_b16 v[116:117], v24 offset:0
    ds_read_b64_tr_b16 v[118:119], v24 offset:256
    ds_read_b64_tr_b16 v[120:121], v24 offset:1024
    ds_read_b64_tr_b16 v[122:123], v24 offset:1280
    ds_read_b64_tr_b16 v[124:125], v24 offset:2048
    ds_read_b64_tr_b16 v[126:127], v24 offset:2304
    ds_read_b64_tr_b16 v[128:129], v24 offset:3072
    ds_read_b64_tr_b16 v[130:131], v24 offset:3328
    s_barrier
    ds_read_b64_tr_b16 v[132:133], v28 offset:0
    ds_read_b64_tr_b16 v[134:135], v28 offset:256
    ds_read_b64_tr_b16 v[136:137], v28 offset:1024
    ds_read_b64_tr_b16 v[138:139], v28 offset:1280
    ds_read_b64_tr_b16 v[140:141], v28 offset:2048
    ds_read_b64_tr_b16 v[142:143], v28 offset:2304
    ds_read_b64_tr_b16 v[144:145], v28 offset:3072
    ds_read_b64_tr_b16 v[146:147], v28 offset:3328
    ds_read_b64_tr_b16 v[148:149], v28 offset:4096
    ds_read_b64_tr_b16 v[150:151], v28 offset:4352
    ds_read_b64_tr_b16 v[152:153], v28 offset:5120
    ds_read_b64_tr_b16 v[154:155], v28 offset:5376
    ds_read_b64_tr_b16 v[156:157], v28 offset:6144
    ds_read_b64_tr_b16 v[158:159], v28 offset:6400
    s_waitcnt lgkmcnt(14)
    v_dot2c_f32_bf16 v164, s24, v116
    v_dot2c_f32_bf16 v166, v116, v116
    v_dot2c_f32_bf16 v165, s24, v117
    v_dot2c_f32_bf16 v167, v117, v117
    v_dot2c_f32_bf16 v164, s24, v118
    v_dot2c_f32_bf16 v166, v118, v118
    v_dot2c_f32_bf16 v165, s24, v119
    v_dot2c_f32_bf16 v167, v119, v119
    v_dot2c_f32_bf16 v164, s24, v120
    v_dot2c_f32_bf16 v166, v120, v120
    v_dot2c_f32_bf16 v165, s24, v121
    v_dot2c_f32_bf16 v167, v121, v121
    v_dot2c_f32_bf16 v164, s24, v122
    v_dot2c_f32_bf16 v166, v122, v122
    v_dot2c_f32_bf16 v165, s24, v123
    v_dot2c_f32_bf16 v167, v123, v123
    v_dot2c_f32_bf16 v164, s24, v124
    v_dot2c_f32_bf16 v166, v124, v124
    v_dot2c_f32_bf16 v165, s24, v125
    v_dot2c_f32_bf16 v167, v125, v125
    v_dot2c_f32_bf16 v164, s24, v126
    v_dot2c_f32_bf16 v166, v126, v126
    v_dot2c_f32_bf16 v165, s24, v127
    v_dot2c_f32_bf16 v167, v127, v127
    v_dot2c_f32_bf16 v164, s24, v128
    v_dot2c_f32_bf16 v166, v128, v128
    v_dot2c_f32_bf16 v165, s24, v129
    v_dot2c_f32_bf16 v167, v129, v129
    v_dot2c_f32_bf16 v164, s24, v130
    v_dot2c_f32_bf16 v166, v130, v130
    v_dot2c_f32_bf16 v165, s24, v131
    v_dot2c_f32_bf16 v167, v131, v131
    s_waitcnt lgkmcnt(12)
    v_mfma_f32_32x32x16_bf16 v[84:99], a[0:3], v[132:135], 0
    ds_read_b64_tr_b16 v[160:161], v28 offset:7168
    ds_read_b64_tr_b16 v[162:163], v28 offset:7424
    s_cmp_eq_u32 s20, 10
    s_cselect_b32 s35, 2146435072, s35
    s_add_u32 m0, s41, 98304
    s_nop 0
    buffer_load_dwordx4 v2, s[4:7], s35 offen offset:0 sc1 lds
    s_waitcnt lgkmcnt(12)
    v_mfma_f32_32x32x16_bf16 v[84:99], a[4:7], v[136:139], v[84:99]
    ds_read_b64_tr_b16 v[132:133], v28 offset:8192
    ds_read_b64_tr_b16 v[134:135], v28 offset:8448
    s_waitcnt lgkmcnt(12)
    v_mfma_f32_32x32x16_bf16 v[84:99], a[8:11], v[140:143], v[84:99]
    ds_read_b64_tr_b16 v[136:137], v28 offset:9216
    ds_read_b64_tr_b16 v[138:139], v28 offset:9472
    buffer_load_dwordx4 v2, s[4:7], s35 offen offset:1024 sc1 lds
    s_waitcnt lgkmcnt(8)
    v_mfma_f32_32x32x16_bf16 v[84:99], a[12:15], v[144:147], v[84:99]
    ds_read_b64_tr_b16 v[140:141], v28 offset:10240
    ds_read_b64_tr_b16 v[142:143], v28 offset:10496
    v_mfma_f32_32x32x16_bf16 v[84:99], a[16:19], v[148:151], v[84:99]
    ds_read_b64_tr_b16 v[144:145], v28 offset:11264
    ds_read_b64_tr_b16 v[146:147], v28 offset:11520
    buffer_load_dwordx4 v2, s[4:7], s35 offen offset:2048 sc1 lds
    v_mfma_f32_32x32x16_bf16 v[84:99], a[20:23], v[152:155], v[84:99]
    ds_read_b64_tr_b16 v[148:149], v28 offset:12288
    ds_read_b64_tr_b16 v[150:151], v28 offset:12544
    s_waitcnt lgkmcnt(8)
    v_mfma_f32_32x32x16_bf16 v[84:99], a[24:27], v[156:159], v[84:99]
    ds_read_b64_tr_b16 v[152:153], v28 offset:13312
    ds_read_b64_tr_b16 v[154:155], v28 offset:13568
    buffer_load_dwordx4 v2, s[4:7], s35 offen offset:3072 sc1 lds
    s_add_u32 s35, s35, 16384
    v_mfma_f32_32x32x16_bf16 v[84:99], a[28:31], v[160:163], v[84:99]
    ds_read_b64_tr_b16 v[156:157], v28 offset:14336
    ds_read_b64_tr_b16 v[158:159], v28 offset:14592
    v_mfma_f32_32x32x16_bf16 v[84:99], a[32:35], v[132:135], v[84:99]
    ds_read_b64_tr_b16 v[160:161], v28 offset:15360
    ds_read_b64_tr_b16 v[162:163], v28 offset:15616
    s_add_u32 m0, s41, 114688
    s_nop 0
    buffer_load_dwordx4 v2, s[4:7], s35 offen offset:0 sc1 lds
    s_waitcnt vmcnt(14)
    s_barrier
    s_waitcnt lgkmcnt(8)
    v_mfma_f32_32x32x16_bf16 v[84:99], a[36:39], v[136:139], v[84:99]
    ds_read_b64_tr_b16 v[132:133], v28 offset:16384
    ds_read_b64_tr_b16 v[134:135], v28 offset:16640
    v_mfma_f32_32x32x16_bf16 v[84:99], a[40:43], v[140:143], v[84:99]
    ds_read_b64_tr_b16 v[136:137], v28 offset:17408
    ds_read_b64_tr_b16 v[138:139], v28 offset:17664
    buffer_load_dwordx4 v2, s[4:7], s35 offen offset:1024 sc1 lds
    ds_read_b64_tr_b16 v[116:117], v24 offset:16384
    ds_read_b64_tr_b16 v[118:119], v24 offset:16640
    ds_read_b64_tr_b16 v[120:121], v24 offset:17408
    ds_read_b64_tr_b16 v[122:123], v24 offset:17664
    ds_read_b64_tr_b16 v[124:125], v24 offset:18432
    ds_read_b64_tr_b16 v[126:127], v24 offset:18688
    ds_read_b64_tr_b16 v[128:129], v24 offset:19456
    ds_read_b64_tr_b16 v[130:131], v24 offset:19712
    v_mfma_f32_32x32x16_bf16 v[84:99], a[44:47], v[144:147], v[84:99]
    ds_read_b64_tr_b16 v[140:141], v28 offset:18432
    ds_read_b64_tr_b16 v[142:143], v28 offset:18688
    s_waitcnt lgkmcnt(15)
    v_mfma_f32_32x32x16_bf16 v[84:99], a[48:51], v[148:151], v[84:99]
    ds_read_b64_tr_b16 v[144:145], v28 offset:19456
    ds_read_b64_tr_b16 v[146:147], v28 offset:19712
    buffer_load_dwordx4 v2, s[4:7], s35 offen offset:2048 sc1 lds
    v_mfma_f32_32x32x16_bf16 v[84:99], a[52:55], v[152:155], v[84:99]
    ds_read_b64_tr_b16 v[148:149], v28 offset:20480
    ds_read_b64_tr_b16 v[150:151], v28 offset:20736
    v_mfma_f32_32x32x16_bf16 v[84:99], a[56:59], v[156:159], v[84:99]
    ds_read_b64_tr_b16 v[152:153], v28 offset:21504
    ds_read_b64_tr_b16 v[154:155], v28 offset:21760
    buffer_load_dwordx4 v2, s[4:7], s35 offen offset:3072 sc1 lds
    s_add_u32 s35, s35, 16384
    s_waitcnt lgkmcnt(8)
    v_dot2c_f32_bf16 v164, s24, v116
    v_dot2c_f32_bf16 v166, v116, v116
    v_dot2c_f32_bf16 v165, s24, v117
    v_dot2c_f32_bf16 v167, v117, v117
    v_dot2c_f32_bf16 v164, s24, v118
    v_dot2c_f32_bf16 v166, v118, v118
    v_dot2c_f32_bf16 v165, s24, v119
    v_dot2c_f32_bf16 v167, v119, v119
    v_dot2c_f32_bf16 v164, s24, v120
    v_dot2c_f32_bf16 v166, v120, v120
    v_dot2c_f32_bf16 v165, s24, v121
    v_dot2c_f32_bf16 v167, v121, v121
    v_dot2c_f32_bf16 v164, s24, v122
    v_dot2c_f32_bf16 v166, v122, v122
    v_dot2c_f32_bf16 v165, s24, v123
    v_dot2c_f32_bf16 v167, v123, v123
    v_dot2c_f32_bf16 v164, s24, v124
    v_dot2c_f32_bf16 v166, v124, v124
    v_dot2c_f32_bf16 v165, s24, v125
    v_dot2c_f32_bf16 v167, v125, v125
    v_dot2c_f32_bf16 v164, s24, v126
    v_dot2c_f32_bf16 v166, v126, v126
    v_dot2c_f32_bf16 v165, s24, v127
    v_dot2c_f32_bf16 v167, v127, v127
    v_dot2c_f32_bf16 v164, s24, v128
    v_dot2c_f32_bf16 v166, v128, v128
    v_dot2c_f32_bf16 v165, s24, v129
    v_dot2c_f32_bf16 v167, v129, v129
    v_dot2c_f32_bf16 v164, s24, v130
    v_dot2c_f32_bf16 v166, v130, v130
    v_dot2c_f32_bf16 v165, s24, v131
    v_dot2c_f32_bf16 v167, v131, v131
    v_mfma_f32_32x32x16_bf16 v[84:99], a[60:63], v[160:163], v[84:99]
    ds_read_b64_tr_b16 v[156:157], v28 offset:22528
    ds_read_b64_tr_b16 v[158:159], v28 offset:22784
    v_add_f32 v164, v164, v165
    v_add_f32 v166, v166, v167
    v_lshlrev_b32 v26, 2, v0
    v_lshlrev_b32 v27, 2, v1
    v_mfma_f32_32x32x16_bf16 v[84:99], a[64:67], v[132:135], v[84:99]
    ds_read_b64_tr_b16 v[160:161], v28 offset:23552
    ds_read_b64_tr_b16 v[162:163], v28 offset:23808
    v_permlane32_swap_b32 v164, v166
    v_add_f32 v164, v164, v166
    ds_write_b32 v26, v164 offset:17152
    v_mfma_f32_32x32x16_bf16 v[84:99], a[68:71], v[136:139], v[84:99]
    ds_read_b64_tr_b16 v[132:133], v28 offset:24576
    ds_read_b64_tr_b16 v[134:135], v28 offset:24832
    s_waitcnt lgkmcnt(9)
    v_mfma_f32_32x32x16_bf16 v[84:99], a[72:75], v[140:143], v[84:99]
    ds_read_b64_tr_b16 v[136:137], v28 offset:25600
    ds_read_b64_tr_b16 v[138:139], v28 offset:25856
    v_mfma_f32_32x32x16_bf16 v[84:99], a[76:79], v[144:147], v[84:99]
    ds_read_b64_tr_b16 v[140:141], v28 offset:26624
    ds_read_b64_tr_b16 v[142:143], v28 offset:26880
    v_mfma_f32_32x32x16_bf16 v[84:99], a[80:83], v[148:151], v[84:99]
    ds_read_b64_tr_b16 v[144:145], v28 offset:27648
    ds_read_b64_tr_b16 v[146:147], v28 offset:27904
    s_waitcnt lgkmcnt(9)
    v_mfma_f32_32x32x16_bf16 v[84:99], a[84:87], v[152:155], v[84:99]
    ds_read_b64_tr_b16 v[148:149], v28 offset:28672
    ds_read_b64_tr_b16 v[150:151], v28 offset:28928
    v_mfma_f32_32x32x16_bf16 v[84:99], a[88:91], v[156:159], v[84:99]
    ds_read_b64_tr_b16 v[152:153], v28 offset:29696
    ds_read_b64_tr_b16 v[154:155], v28 offset:29952
    v_mfma_f32_32x32x16_bf16 v[84:99], a[92:95], v[160:163], v[84:99]
    ds_read_b64_tr_b16 v[156:157], v28 offset:30720
    ds_read_b64_tr_b16 v[158:159], v28 offset:30976
    s_waitcnt lgkmcnt(8)
    v_mfma_f32_32x32x16_bf16 v[84:99], a[96:99], v[132:135], v[84:99]
    ds_read_b64_tr_b16 v[160:161], v28 offset:31744
    ds_read_b64_tr_b16 v[162:163], v28 offset:32000
    s_waitcnt vmcnt(8)
    s_barrier
    v_mfma_f32_32x32x16_bf16 v[84:99], a[100:103], v[136:139], v[84:99]
    ds_read_b64_tr_b16 v[132:133], v28 offset:32768
    ds_read_b64_tr_b16 v[134:135], v28 offset:33024
    ds_read_b32 v168, v27 offset:17152
    ds_read_b32 v169, v27 offset:17408
    ds_read_b32 v170, v27 offset:17664
    ds_read_b32 v171, v27 offset:17920
    v_mfma_f32_32x32x16_bf16 v[84:99], a[104:107], v[140:143], v[84:99]
    ds_read_b64_tr_b16 v[136:137], v28 offset:33792
    ds_read_b64_tr_b16 v[138:139], v28 offset:34048
    s_waitcnt lgkmcnt(12)
    v_mfma_f32_32x32x16_bf16 v[84:99], a[108:111], v[144:147], v[84:99]
    ds_read_b64_tr_b16 v[140:141], v28 offset:34816
    ds_read_b64_tr_b16 v[142:143], v28 offset:35072
    v_mfma_f32_32x32x16_bf16 v[84:99], a[112:115], v[148:151], v[84:99]
    ds_read_b64_tr_b16 v[144:145], v28 offset:35840
    ds_read_b64_tr_b16 v[146:147], v28 offset:36096
    v_mfma_f32_32x32x16_bf16 v[84:99], a[116:119], v[152:155], v[84:99]
    ds_read_b64_tr_b16 v[148:149], v28 offset:36864
    ds_read_b64_tr_b16 v[150:151], v28 offset:37120
    s_waitcnt lgkmcnt(8)
    v_add_f32 v168, v168, v169
    v_add_f32 v170, v170, v171
    v_mfma_f32_32x32x16_bf16 v[84:99], a[120:123], v[156:159], v[84:99]
    ds_read_b64_tr_b16 v[152:153], v28 offset:37888
    ds_read_b64_tr_b16 v[154:155], v28 offset:38144
    v_add_f32 v168, v168, v170
    v_mul_f32 v164, s16, v168
    v_mul_f32 v165, s16, v168
    v_mov_b32 v168, 0
    v_mfma_f32_32x32x16_bf16 v[84:99], a[124:127], v[160:163], v[84:99]
    ds_read_b64_tr_b16 v[156:157], v28 offset:38912
    ds_read_b64_tr_b16 v[158:159], v28 offset:39168
    v_mov_b32 v169, 0
    v_mov_b32 v170, 0
    v_permlane32_swap_b32 v164, v165
    v_mfma_f32_32x32x16_bf16 v[100:115], a[0:3], v[132:135], 0
    ds_read_b64_tr_b16 v[160:161], v28 offset:39936
    ds_read_b64_tr_b16 v[162:163], v28 offset:40192
    v_fma_f32 v165, -v164, v164, v165
    v_cvt_pk_bf16_f32 v171, v164, v164
    v_max_f32 v165, 0, v165
    s_waitcnt lgkmcnt(8)
    v_mfma_f32_32x32x16_bf16 v[100:115], a[4:7], v[136:139], v[100:115]
    ds_read_b64_tr_b16 v[132:133], v28 offset:40960
    ds_read_b64_tr_b16 v[134:135], v28 offset:41216
    v_add_f32 v174, s18, v165
    v_rsq_f32 v164, v174
    v_mfma_f32_32x32x16_bf16 v[84:99], a[128:131], v[168:171], v[84:99]
    v_mfma_f32_32x32x16_bf16 v[100:115], a[8:11], v[140:143], v[100:115]
    ds_read_b64_tr_b16 v[136:137], v28 offset:41984
    ds_read_b64_tr_b16 v[138:139], v28 offset:42240
    v_mul_f32 v173, 0xc0135761, v164
    v_mul_f32 v172, v164, v164
    v_mul_f32 v165, 0xbdd2d3e8, v164
    v_mul_f32 v172, v172, v165
    v_mfma_f32_32x32x16_bf16 v[100:115], a[12:15], v[144:147], v[100:115]
    ds_read_b64_tr_b16 v[140:141], v28 offset:43008
    ds_read_b64_tr_b16 v[142:143], v28 offset:43264
    s_waitcnt lgkmcnt(8)
    v_mfma_f32_32x32x16_bf16 v[100:115], a[16:19], v[148:151], v[100:115]
    ds_read_b64_tr_b16 v[144:145], v28 offset:44032
    ds_read_b64_tr_b16 v[146:147], v28 offset:44288
    s_add_u32 s37, s27, 16154624
    v_mov_b32 v20, 0
    buffer_atomic_add v20, v19, s[4:7], s37 offen sc0 sc1
    v_mfma_f32_32x32x16_bf16 v[100:115], a[20:23], v[152:155], v[100:115]
    ds_read_b64_tr_b16 v[148:149], v28 offset:45056
    ds_read_b64_tr_b16 v[150:151], v28 offset:45312
    v_mfma_f32_32x32x16_bf16 v[100:115], a[24:27], v[156:159], v[100:115]
    ds_read_b64_tr_b16 v[152:153], v28 offset:46080
    ds_read_b64_tr_b16 v[154:155], v28 offset:46336
    v_mul_f32 v164, v84, v84
    v_fma_f32 v164, v164, v172, v173
    v_mul_f32 v165, v85, v85
    s_waitcnt lgkmcnt(8)
    v_mfma_f32_32x32x16_bf16 v[100:115], a[28:31], v[160:163], v[100:115]
    ds_read_b64_tr_b16 v[156:157], v28 offset:47104
    ds_read_b64_tr_b16 v[158:159], v28 offset:47360
    v_mul_f32 v164, v164, v84
    v_fma_f32 v165, v165, v172, v173
    v_mul_f32 v166, v86, v86
    v_mfma_f32_32x32x16_bf16 v[100:115], a[32:35], v[132:135], v[100:115]
    ds_read_b64_tr_b16 v[160:161], v28 offset:48128
    ds_read_b64_tr_b16 v[162:163], v28 offset:48384
    v_exp_f32 v164, v164
    v_mul_f32 v165, v165, v85
    v_fma_f32 v166, v166, v172, v173
    v_mfma_f32_32x32x16_bf16 v[100:115], a[36:39], v[136:139], v[100:115]
    ds_read_b64_tr_b16 v[132:133], v28 offset:49152
    ds_read_b64_tr_b16 v[134:135], v28 offset:49408
    v_mul_f32 v167, v87, v87
    v_mul_f32 v84, v84, v92
    s_waitcnt lgkmcnt(8)
    v_mfma_f32_32x32x16_bf16 v[100:115], a[40:43], v[140:143], v[100:115]
    ds_read_b64_tr_b16 v[136:137], v28 offset:50176
    ds_read_b64_tr_b16 v[138:139], v28 offset:50432
    v_exp_f32 v165, v165
    v_mul_f32 v166, v166, v86
    v_fma_f32 v167, v167, v172, v173
    v_mfma_f32_32x32x16_bf16 v[100:115], a[44:47], v[144:147], v[100:115]
    ds_read_b64_tr_b16 v[140:141], v28 offset:51200
    ds_read_b64_tr_b16 v[142:143], v28 offset:51456
    v_mul_f32 v168, v88, v88
    v_fma_f32 v164, v164, v174, v174
    v_mul_f32 v85, v85, v93
    v_mfma_f32_32x32x16_bf16 v[100:115], a[48:51], v[148:151], v[100:115]
    ds_read_b64_tr_b16 v[144:145], v28 offset:52224
    ds_read_b64_tr_b16 v[146:147], v28 offset:52480
    v_exp_f32 v166, v166
    v_mul_f32 v167, v167, v87
    s_waitcnt lgkmcnt(8)
    v_mfma_f32_32x32x16_bf16 v[100:115], a[52:55], v[152:155], v[100:115]
    ds_read_b64_tr_b16 v[148:149], v28 offset:53248
    ds_read_b64_tr_b16 v[150:151], v28 offset:53504
    v_fma_f32 v168, v168, v172, v173
    v_mul_f32 v169, v89, v89
    v_rcp_f32 v164, v164
    v_mfma_f32_32x32x16_bf16 v[100:115], a[56:59], v[156:159], v[100:115]
    ds_read_b64_tr_b16 v[152:153], v28 offset:54272
    ds_read_b64_tr_b16 v[154:155], v28 offset:54528
    v_fma_f32 v165, v165, v174, v174
    v_mul_f32 v86, v86, v94
    v_exp_f32 v167, v167
    v_mfma_f32_32x32x16_bf16 v[100:115], a[60:63], v[160:163], v[100:115]
    ds_read_b64_tr_b16 v[156:157], v28 offset:55296
    ds_read_b64_tr_b16 v[158:159], v28 offset:55552
    v_mul_f32 v168, v168, v88
    v_fma_f32 v169, v169, v172, v173
    v_mul_f32 v170, v90, v90
    s_waitcnt lgkmcnt(8)
    v_mfma_f32_32x32x16_bf16 v[100:115], a[64:67], v[132:135], v[100:115]
    ds_read_b64_tr_b16 v[160:161], v28 offset:56320
    ds_read_b64_tr_b16 v[162:163], v28 offset:56576
    v_rcp_f32 v165, v165
    v_fma_f32 v166, v166, v174, v174
    v_mul_f32 v87, v87, v95
    v_mfma_f32_32x32x16_bf16 v[100:115], a[68:71], v[136:139], v[100:115]
    ds_read_b64_tr_b16 v[132:133], v28 offset:57344
    ds_read_b64_tr_b16 v[134:135], v28 offset:57600
    v_exp_f32 v168, v168
    v_mul_f32 v169, v169, v89
    v_fma_f32 v170, v170, v172, v173
    v_mfma_f32_32x32x16_bf16 v[100:115], a[72:75], v[140:143], v[100:115]
    ds_read_b64_tr_b16 v[136:137], v28 offset:58368
    ds_read_b64_tr_b16 v[138:139], v28 offset:58624
    v_mul_f32 v171, v91, v91
    v_mul_f32 v84, v84, v164
    s_waitcnt lgkmcnt(8)
    v_mfma_f32_32x32x16_bf16 v[100:115], a[76:79], v[144:147], v[100:115]
    ds_read_b64_tr_b16 v[140:141], v28 offset:59392
    ds_read_b64_tr_b16 v[142:143], v28 offset:59648
    v_rcp_f32 v166, v166
    v_fma_f32 v167, v167, v174, v174
    v_mul_f32 v88, v88, v96
    v_mfma_f32_32x32x16_bf16 v[100:115], a[80:83], v[148:151], v[100:115]
    ds_read_b64_tr_b16 v[144:145], v28 offset:60416
    ds_read_b64_tr_b16 v[146:147], v28 offset:60672
    v_exp_f32 v169, v169
    v_mul_f32 v170, v170, v90
    v_fma_f32 v171, v171, v172, v173
    v_mfma_f32_32x32x16_bf16 v[100:115], a[84:87], v[152:155], v[100:115]
    ds_read_b64_tr_b16 v[148:149], v28 offset:61440
    ds_read_b64_tr_b16 v[150:151], v28 offset:61696
    v_mul_f32 v85, v85, v165
    v_rcp_f32 v167, v167
    s_waitcnt lgkmcnt(8)
    v_mfma_f32_32x32x16_bf16 v[100:115], a[88:91], v[156:159], v[100:115]
    ds_read_b64_tr_b16 v[152:153], v28 offset:62464
    ds_read_b64_tr_b16 v[154:155], v28 offset:62720
    s_waitcnt vmcnt(0)
    v_cmp_gt_u32 vcc, 16, v20
    s_nop 0
    s_and_b64 vcc, vcc, s[54:55]
    s_cbranch_scc1 mk_ps46
mk_po47:
    s_barrier
    s_mul_i32 s35, s20, 98304
    s_add_u32 s35, s35, s41
    s_add_u32 s35, s35, 8388608
    s_add_u32 s35, s35, s44
    v_mfma_f32_32x32x16_bf16 v[100:115], a[92:95], v[160:163], v[100:115]
    ds_read_b64_tr_b16 v[156:157], v28 offset:63488
    ds_read_b64_tr_b16 v[158:159], v28 offset:63744
    s_mul_i32 s39, s20, 1536
    s_add_u32 s39, s39, 15926272
    buffer_load_dwordx4 v[176:179], v30, s[4:7], s39 offen offset:512 sc1
    v_mfma_f32_32x32x16_bf16 v[100:115], a[96:99], v[132:135], v[100:115]
    ds_read_b64_tr_b16 v[160:161], v28 offset:64512
    ds_read_b64_tr_b16 v[162:163], v28 offset:64768
    s_add_u32 m0, s41, 131072
    s_nop 0
    buffer_load_dwordx4 v2, s[4:7], s35 offen offset:0 sc1 lds
    s_barrier
    s_waitcnt lgkmcnt(8)
    v_mfma_f32_32x32x16_bf16 v[100:115], a[100:103], v[136:139], v[100:115]
    ds_read_b64_tr_b16 v[132:133], v29 offset:0
    ds_read_b64_tr_b16 v[134:135], v29 offset:256
    v_fma_f32 v168, v168, v174, v174
    v_mul_f32 v89, v89, v97
    v_exp_f32 v170, v170
    v_mfma_f32_32x32x16_bf16 v[100:115], a[104:107], v[140:143], v[100:115]
    ds_read_b64_tr_b16 v[136:137], v29 offset:1024
    ds_read_b64_tr_b16 v[138:139], v29 offset:1280
    buffer_load_dwordx4 v2, s[4:7], s35 offen offset:1024 sc1 lds
    v_mul_f32 v171, v171, v91
    v_mul_f32 v86, v86, v166
    v_mfma_f32_32x32x16_bf16 v[100:115], a[108:111], v[144:147], v[100:115]
    ds_read_b64_tr_b16 v[140:141], v29 offset:2048
    ds_read_b64_tr_b16 v[142:143], v29 offset:2304
    v_rcp_f32 v168, v168
    v_fma_f32 v169, v169, v174, v174
    s_waitcnt lgkmcnt(8)
    v_mfma_f32_32x32x16_bf16 v[100:115], a[112:115], v[148:151], v[100:115]
    ds_read_b64_tr_b16 v[144:145], v29 offset:3072
    ds_read_b64_tr_b16 v[146:147], v29 offset:3328
    buffer_load_dwordx4 v2, s[4:7], s35 offen offset:2048 sc1 lds
    v_mul_f32 v90, v90, v98
    v_mfma_f32_32x32x16_bf16 v[100:115], a[116:119], v[152:155], v[100:115]
    ds_read_b64_tr_b16 v[148:149], v29 offset:4096
    ds_read_b64_tr_b16 v[150:151], v29 offset:4352
    v_exp_f32 v171, v171
    v_mul_f32 v87, v87, v167
    v_mfma_f32_32x32x16_bf16 v[100:115], a[120:123], v[156:159], v[100:115]
    ds_read_b64_tr_b16 v[152:153], v29 offset:5120
    ds_read_b64_tr_b16 v[154:155], v29 offset:5376
    buffer_load_dwordx4 v2, s[4:7], s35 offen offset:3072 sc1 lds
    s_add_u32 s35, s35, 16384
    s_waitcnt lgkmcnt(8)
    v_mfma_f32_32x32x16_bf16 v[100:115], a[124:127], v[160:163], v[100:115]
    ds_read_b64_tr_b16 v[156:157], v29 offset:6144
    ds_read_b64_tr_b16 v[158:159], v29 offset:6400
    v_rcp_f32 v169, v169
    v_fma_f32 v170, v170, v174, v174
    v_mul_f32 v91, v91, v99
    v_mfma_f32_32x32x16_bf16 v[116:131], a[0:3], v[132:135], 0
    ds_read_b64_tr_b16 v[160:161], v29 offset:7168
    ds_read_b64_tr_b16 v[162:163], v29 offset:7424
    s_add_u32 m0, s41, 147456
    s_nop 0
    buffer_load_dwordx4 v2, s[4:7], s35 offen offset:0 sc1 lds
    v_mul_f32 v88, v88, v168
    v_mfma_f32_32x32x16_bf16 v[116:131], a[4:7], v[136:139], v[116:131]
    ds_read_b64_tr_b16 v[132:133], v29 offset:8192
    ds_read_b64_tr_b16 v[134:135], v29 offset:8448
    v_rcp_f32 v170, v170
    v_fma_f32 v171, v171, v174, v174
    s_waitcnt lgkmcnt(8)
    v_mfma_f32_32x32x16_bf16 v[116:131], a[8:11], v[140:143], v[116:131]
    ds_read_b64_tr_b16 v[136:137], v29 offset:9216
    ds_read_b64_tr_b16 v[138:139], v29 offset:9472
    buffer_load_dwordx4 v2, s[4:7], s35 offen offset:1024 sc1 lds
    v_mul_f32 v89, v89, v169
    v_mfma_f32_32x32x16_bf16 v[116:131], a[12:15], v[144:147], v[116:131]
    ds_read_b64_tr_b16 v[140:141], v29 offset:10240
    ds_read_b64_tr_b16 v[142:143], v29 offset:10496
    v_rcp_f32 v171, v171
    v_mul_f32 v90, v90, v170
    v_mul_f32 v91, v91, v171
    v_mfma_f32_32x32x16_bf16 v[116:131], a[16:19], v[148:151], v[116:131]
    ds_read_b64_tr_b16 v[144:145], v29 offset:11264
    ds_read_b64_tr_b16 v[146:147], v29 offset:11520
    buffer_load_dwordx4 v2, s[4:7], s35 offen offset:2048 sc1 lds
    s_waitcnt vmcnt(7)
    v_cmp_eq_u32 vcc, 0, v176
    s_cbranch_vccnz mk_qs49
mk_qo50:
    v_mfma_f32_32x32x16_bf16 v[100:115], a[128:131], v[176:179], v[100:115]
    s_waitcnt lgkmcnt(8)
    v_mfma_f32_32x32x16_bf16 v[116:131], a[20:23], v[152:155], v[116:131]
    ds_read_b64_tr_b16 v[148:149], v29 offset:12288
    ds_read_b64_tr_b16 v[150:151], v29 offset:12544
    v_cvt_pk_bf16_f32 v92, v84, v85
    v_cvt_pk_bf16_f32 v93, v86, v87
    v_cvt_pk_bf16_f32 v94, v88, v89
    v_cvt_pk_bf16_f32 v95, v90, v91
    v_mfma_f32_32x32x16_bf16 v[116:131], a[24:27], v[156:159], v[116:131]
    ds_read_b64_tr_b16 v[152:153], v29 offset:13312
    ds_read_b64_tr_b16 v[154:155], v29 offset:13568
    buffer_load_dwordx4 v2, s[4:7], s35 offen offset:3072 sc1 lds
    s_add_u32 s35, s35, 16384
    v_mfma_f32_32x32x16_bf16 v[116:131], a[28:31], v[160:163], v[116:131]
    ds_read_b64_tr_b16 v[156:157], v29 offset:14336
    ds_read_b64_tr_b16 v[158:159], v29 offset:14592
    s_mul_i32 s43, s20, 270336
    s_lshl_b32 s32, s21, 10
    s_add_u32 s43, s43, s32
    s_add_u32 s43, s43, 31457280
    buffer_store_dwordx4 v[92:95], v2, s[4:7], s43 offen sc1
    s_add_u32 s43, s43, 90112
    s_waitcnt lgkmcnt(8)
    v_mfma_f32_32x32x16_bf16 v[116:131], a[32:35], v[132:135], v[116:131]
    ds_read_b64_tr_b16 v[160:161], v29 offset:15360
    ds_read_b64_tr_b16 v[162:163], v29 offset:15616
    s_add_u32 m0, s41, 32768
    s_nop 0
    buffer_load_dwordx4 v2, s[4:7], s35 offen offset:0 sc1 lds
    v_mul_f32 v164, v100, v100
    v_mfma_f32_32x32x16_bf16 v[116:131], a[36:39], v[136:139], v[116:131]
    ds_read_b64_tr_b16 v[132:133], v29 offset:16384
    ds_read_b64_tr_b16 v[134:135], v29 offset:16640
    v_fma_f32 v164, v164, v176, v177
    v_mul_f32 v165, v101, v101
    v_mul_f32 v164, v164, v100
    v_fma_f32 v165, v165, v176, v177
    v_mfma_f32_32x32x16_bf16 v[116:131], a[40:43], v[140:143], v[116:131]
    ds_read_b64_tr_b16 v[136:137], v29 offset:17408
    ds_read_b64_tr_b16 v[138:139], v29 offset:17664
    buffer_load_dwordx4 v2, s[4:7], s35 offen offset:1024 sc1 lds
    v_mul_f32 v166, v102, v102
    s_waitcnt lgkmcnt(8)
    v_mfma_f32_32x32x16_bf16 v[116:131], a[44:47], v[144:147], v[116:131]
    ds_read_b64_tr_b16 v[140:141], v29 offset:18432
    ds_read_b64_tr_b16 v[142:143], v29 offset:18688
    v_exp_f32 v164, v164
    v_mul_f32 v165, v165, v101
    v_fma_f32 v166, v166, v176, v177
    v_mfma_f32_32x32x16_bf16 v[116:131], a[48:51], v[148:151], v[116:131]
    ds_read_b64_tr_b16 v[144:145], v29 offset:19456
    ds_read_b64_tr_b16 v[146:147], v29 offset:19712
    buffer_load_dwordx4 v2, s[4:7], s35 offen offset:2048 sc1 lds
    v_mul_f32 v167, v103, v103
    v_mul_f32 v100, v100, v108
    v_mfma_f32_32x32x16_bf16 v[116:131], a[52:55], v[152:155], v[116:131]
    ds_read_b64_tr_b16 v[148:149], v29 offset:20480
    ds_read_b64_tr_b16 v[150:151], v29 offset:20736
    v_exp_f32 v165, v165
    v_mul_f32 v166, v166, v102
    s_waitcnt lgkmcnt(8)
    v_mfma_f32_32x32x16_bf16 v[116:131], a[56:59], v[156:159], v[116:131]
    ds_read_b64_tr_b16 v[152:153], v29 offset:21504
    ds_read_b64_tr_b16 v[154:155], v29 offset:21760
    buffer_load_dwordx4 v2, s[4:7], s35 offen offset:3072 sc1 lds
    s_add_u32 s35, s35, 16384
    v_fma_f32 v167, v167, v176, v177
    v_mfma_f32_32x32x16_bf16 v[116:131], a[60:63], v[160:163], v[116:131]
    ds_read_b64_tr_b16 v[156:157], v29 offset:22528
    ds_read_b64_tr_b16 v[158:159], v29 offset:22784
    buffer_load_dwordx4 v[180:183], v30, s[4:7], s39 offen offset:1024 sc1
    v_mul_f32 v168, v104, v104
    v_fma_f32 v164, v164, v178, v178
    v_mfma_f32_32x32x16_bf16 v[116:131], a[64:67], v[132:135], v[116:131]
    ds_read_b64_tr_b16 v[160:161], v29 offset:23552
    ds_read_b64_tr_b16 v[162:163], v29 offset:23808
    s_add_u32 m0, s41, 49152
    s_nop 0
    buffer_load_dwordx4 v2, s[4:7], s35 offen offset:0 sc1 lds
    s_waitcnt lgkmcnt(8)
    v_mfma_f32_32x32x16_bf16 v[116:131], a[68:71], v[136:139], v[116:131]
    ds_read_b64_tr_b16 v[132:133], v29 offset:24576
    ds_read_b64_tr_b16 v[134:135], v29 offset:24832
    v_mul_f32 v101, v101, v109
    v_exp_f32 v166, v166
    v_mul_f32 v167, v167, v103
    v_mfma_f32_32x32x16_bf16 v[116:131], a[72:75], v[140:143], v[116:131]
    ds_read_b64_tr_b16 v[136:137], v29 offset:25600
    ds_read_b64_tr_b16 v[138:139], v29 offset:25856
    buffer_load_dwordx4 v2, s[4:7], s35 offen offset:1024 sc1 lds
    v_fma_f32 v168, v168, v176, v177
    v_mul_f32 v169, v105, v105
    v_mfma_f32_32x32x16_bf16 v[116:131], a[76:79], v[144:147], v[116:131]
    ds_read_b64_tr_b16 v[140:141], v29 offset:26624
    ds_read_b64_tr_b16 v[142:143], v29 offset:26880
    v_rcp_f32 v164, v164
    v_fma_f32 v165, v165, v178, v178
    s_waitcnt lgkmcnt(8)
    v_mfma_f32_32x32x16_bf16 v[116:131], a[80:83], v[148:151], v[116:131]
    ds_read_b64_tr_b16 v[144:145], v29 offset:27648
    ds_read_b64_tr_b16 v[146:147], v29 offset:27904
    buffer_load_dwordx4 v2, s[4:7], s35 offen offset:2048 sc1 lds
    v_mul_f32 v102, v102, v110
    v_mfma_f32_32x32x16_bf16 v[116:131], a[84:87], v[152:155], v[116:131]
    ds_read_b64_tr_b16 v[148:149], v29 offset:28672
    ds_read_b64_tr_b16 v[150:151], v29 offset:28928
    v_exp_f32 v167, v167
    v_mul_f32 v168, v168, v104
    v_fma_f32 v169, v169, v176, v177
    v_mfma_f32_32x32x16_bf16 v[116:131], a[88:91], v[156:159], v[116:131]
    ds_read_b64_tr_b16 v[152:153], v29 offset:29696
    ds_read_b64_tr_b16 v[154:155], v29 offset:29952
    buffer_load_dwordx4 v2, s[4:7], s35 offen offset:3072 sc1 lds
    s_add_u32 s35, s35, 16384
    s_waitcnt lgkmcnt(8)
    v_mfma_f32_32x32x16_bf16 v[116:131], a[92:95], v[160:163], v[116:131]
    ds_read_b64_tr_b16 v[156:157], v29 offset:30720
    ds_read_b64_tr_b16 v[158:159], v29 offset:30976
    v_mul_f32 v170, v106, v106
    v_rcp_f32 v165, v165
    v_fma_f32 v166, v166, v178, v178
    v_mfma_f32_32x32x16_bf16 v[116:131], a[96:99], v[132:135], v[116:131]
    ds_read_b64_tr_b16 v[160:161], v29 offset:31744
    ds_read_b64_tr_b16 v[162:163], v29 offset:32000
    v_mul_f32 v103, v103, v111
    v_exp_f32 v168, v168
    v_mul_f32 v169, v169, v105
    s_waitcnt vmcnt(10)
    s_barrier
    v_mfma_f32_32x32x16_bf16 v[116:131], a[100:103], v[136:139], v[116:131]
    ds_read_b64_tr_b16 v[132:133], v29 offset:32768
    ds_read_b64_tr_b16 v[134:135], v29 offset:33024
    v_fma_f32 v170, v170, v176, v177
    v_mul_f32 v171, v107, v107
    v_mul_f32 v100, v100, v164
    s_waitcnt lgkmcnt(8)
    v_mfma_f32_32x32x16_bf16 v[116:131], a[104:107], v[140:143], v[116:131]
    ds_read_b64_tr_b16 v[136:137], v29 offset:33792
    ds_read_b64_tr_b16 v[138:139], v29 offset:34048
    s_cmp_eq_u32 s20, 10
    s_cselect_b32 s35, 2146435072, s35
    s_add_u32 m0, s41, 65536
    s_nop 0
    buffer_load_dwordx4 v2, s[4:7], s35 offen offset:0 sc1 lds
    v_mfma_f32_32x32x16_bf16 v[116:131], a[108:111], v[144:147], v[116:131]
    ds_read_b64_tr_b16 v[140:141], v29 offset:34816
    ds_read_b64_tr_b16 v[142:143], v29 offset:35072
    v_rcp_f32 v166, v166
    v_fma_f32 v167, v167, v178, v178
    v_mul_f32 v104, v104, v112
    v_mfma_f32_32x32x16_bf16 v[116:131], a[112:115], v[148:151], v[116:131]
    ds_read_b64_tr_b16 v[144:145], v29 offset:35840
    ds_read_b64_tr_b16 v[146:147], v29 offset:36096
    buffer_load_dwordx4 v2, s[4:7], s35 offen offset:1024 sc1 lds
    s_waitcnt vmcnt(6)
    v_cmp_eq_u32 vcc, 0, v180
    s_cbranch_vccnz mk_qs52
mk_qo53:
    v_mfma_f32_32x32x16_bf16 v[116:131], a[128:131], v[180:183], v[116:131]
    s_waitcnt lgkmcnt(8)
    v_mfma_f32_32x32x16_bf16 v[116:131], a[116:119], v[152:155], v[116:131]
    ds_read_b64_tr_b16 v[148:149], v29 offset:36864
    ds_read_b64_tr_b16 v[150:151], v29 offset:37120
    v_exp_f32 v169, v169
    v_mul_f32 v170, v170, v106
    v_fma_f32 v171, v171, v176, v177
    v_mfma_f32_32x32x16_bf16 v[116:131], a[120:123], v[156:159], v[116:131]
    ds_read_b64_tr_b16 v[152:153], v29 offset:37888
    ds_read_b64_tr_b16 v[154:155], v29 offset:38144
    buffer_load_dwordx4 v2, s[4:7], s35 offen offset:2048 sc1 lds
    v_mul_f32 v101, v101, v165
    v_mfma_f32_32x32x16_bf16 v[116:131], a[124:127], v[160:163], v[116:131]
    ds_read_b64_tr_b16 v[156:157], v29 offset:38912
    ds_read_b64_tr_b16 v[158:159], v29 offset:39168
    v_rcp_f32 v167, v167
    v_fma_f32 v168, v168, v178, v178
    s_waitcnt lgkmcnt(8)
    v_mfma_f32_32x32x16_bf16 v[84:99], a[0:3], v[132:135], 0
    ds_read_b64_tr_b16 v[160:161], v29 offset:39936
    ds_read_b64_tr_b16 v[162:163], v29 offset:40192
    buffer_load_dwordx4 v2, s[4:7], s35 offen offset:3072 sc1 lds
    s_add_u32 s35, s35, 16384
    v_mul_f32 v105, v105, v113
    v_mfma_f32_32x32x16_bf16 v[84:99], a[4:7], v[136:139], v[84:99]
    ds_read_b64_tr_b16 v[132:133], v29 offset:40960
    ds_read_b64_tr_b16 v[134:135], v29 offset:41216
    v_exp_f32 v170, v170
    v_mul_f32 v171, v171, v107
    v_mul_f32 v102, v102, v166
    v_mfma_f32_32x32x16_bf16 v[84:99], a[8:11], v[140:143], v[84:99]
    ds_read_b64_tr_b16 v[136:137], v29 offset:41984
    ds_read_b64_tr_b16 v[138:139], v29 offset:42240
    s_add_u32 m0, s41, 81920
    s_nop 0
    buffer_load_dwordx4 v2, s[4:7], s35 offen offset:0 sc1 lds
    s_waitcnt lgkmcnt(8)
    v_mfma_f32_32x32x16_bf16 v[84:99], a[12:15], v[144:147], v[84:99]
    ds_read_b64_tr_b16 v[140:141], v29 offset:43008
    ds_read_b64_tr_b16 v[142:143], v29 offset:43264
    v_rcp_f32 v168, v168
    v_fma_f32 v169, v169, v178, v178
    v_mul_f32 v106, v106, v114
    v_mfma_f32_32x32x16_bf16 v[84:99], a[16:19], v[148:151], v[84:99]
    ds_read_b64_tr_b16 v[144:145], v29 offset:44032
    ds_read_b64_tr_b16 v[146:147], v29 offset:44288
    buffer_load_dwordx4 v2, s[4:7], s35 offen offset:1024 sc1 lds
    v_exp_f32 v171, v171
    v_mul_f32 v103, v103, v167
    v_mfma_f32_32x32x16_bf16 v[84:99], a[20:23], v[152:155], v[84:99]
    ds_read_b64_tr_b16 v[148:149], v29 offset:45056
    ds_read_b64_tr_b16 v[150:151], v29 offset:45312
    v_rcp_f32 v169, v169
    v_fma_f32 v170, v170, v178, v178
    v_mul_f32 v107, v107, v115
    s_waitcnt lgkmcnt(8)
    v_mfma_f32_32x32x16_bf16 v[84:99], a[24:27], v[156:159], v[84:99]
    ds_read_b64_tr_b16 v[152:153], v29 offset:46080
    ds_read_b64_tr_b16 v[154:155], v29 offset:46336
    buffer_load_dwordx4 v2, s[4:7], s35 offen offset:2048 sc1 lds
    v_mul_f32 v104, v104, v168
    v_rcp_f32 v170, v170
    v_mfma_f32_32x32x16_bf16 v[84:99], a[28:31], v[160:163], v[84:99]
    ds_read_b64_tr_b16 v[156:157], v29 offset:47104
    ds_read_b64_tr_b16 v[158:159], v29 offset:47360
    v_fma_f32 v171, v171, v178, v178
    v_mul_f32 v105, v105, v169
    v_rcp_f32 v171, v171
    v_mul_f32 v106, v106, v170
    v_mfma_f32_32x32x16_bf16 v[84:99], a[32:35], v[132:135], v[84:99]
    ds_read_b64_tr_b16 v[160:161], v29 offset:48128
    ds_read_b64_tr_b16 v[162:163], v29 offset:48384
    buffer_load_dwordx4 v2, s[4:7], s35 offen offset:3072 sc1 lds
    s_add_u32 s35, s35, 16384
    v_mul_f32 v107, v107, v171
    s_waitcnt lgkmcnt(8)
    v_mfma_f32_32x32x16_bf16 v[84:99], a[36:39], v[136:139], v[84:99]
    ds_read_b64_tr_b16 v[132:133], v29 offset:49152
    ds_read_b64_tr_b16 v[134:135], v29 offset:49408
    v_cvt_pk_bf16_f32 v108, v100, v101
    v_cvt_pk_bf16_f32 v109, v102, v103
    v_cvt_pk_bf16_f32 v110, v104, v105
    v_cvt_pk_bf16_f32 v111, v106, v107
    v_mfma_f32_32x32x16_bf16 v[84:99], a[40:43], v[140:143], v[84:99]
    ds_read_b64_tr_b16 v[136:137], v29 offset:50176
    ds_read_b64_tr_b16 v[138:139], v29 offset:50432
    buffer_store_dwordx4 v[108:111], v2, s[4:7], s43 offen sc1
    s_add_u32 s43, s43, 90112
    v_mul_f32 v164, v116, v116
    v_mfma_f32_32x32x16_bf16 v[84:99], a[44:47], v[144:147], v[84:99]
    ds_read_b64_tr_b16 v[140:141], v29 offset:51200
    ds_read_b64_tr_b16 v[142:143], v29 offset:51456
    v_fma_f32 v164, v164, v180, v181
    v_mul_f32 v165, v117, v117
    v_mul_f32 v164, v164, v116
    v_fma_f32 v165, v165, v180, v181
    s_waitcnt lgkmcnt(8)
    v_mfma_f32_32x32x16_bf16 v[84:99], a[48:51], v[148:151], v[84:99]
    ds_read_b64_tr_b16 v[144:145], v29 offset:52224
    ds_read_b64_tr_b16 v[146:147], v29 offset:52480
    v_mul_f32 v166, v118, v118
    v_exp_f32 v164, v164
    v_mul_f32 v165, v165, v117
    v_fma_f32 v166, v166, v180, v181
    v_mfma_f32_32x32x16_bf16 v[84:99], a[52:55], v[152:155], v[84:99]
    ds_read_b64_tr_b16 v[148:149], v29 offset:53248
    ds_read_b64_tr_b16 v[150:151], v29 offset:53504
    v_mul_f32 v167, v119, v119
    v_mul_f32 v116, v116, v124
    v_exp_f32 v165, v165
    v_mul_f32 v166, v166, v118
    v_mfma_f32_32x32x16_bf16 v[84:99], a[56:59], v[156:159], v[84:99]
    ds_read_b64_tr_b16 v[152:153], v29 offset:54272
    ds_read_b64_tr_b16 v[154:155], v29 offset:54528
    v_fma_f32 v167, v167, v180, v181
    v_mul_f32 v168, v120, v120
    v_fma_f32 v164, v164, v182, v182
    v_mul_f32 v117, v117, v125
    s_waitcnt lgkmcnt(8)
    v_mfma_f32_32x32x16_bf16 v[84:99], a[60:63], v[160:163], v[84:99]
    ds_read_b64_tr_b16 v[156:157], v29 offset:55296
    ds_read_b64_tr_b16 v[158:159], v29 offset:55552
    v_exp_f32 v166, v166
    v_mul_f32 v167, v167, v119
    v_fma_f32 v168, v168, v180, v181
    v_mul_f32 v169, v121, v121
    v_mfma_f32_32x32x16_bf16 v[84:99], a[64:67], v[132:135], v[84:99]
    ds_read_b64_tr_b16 v[160:161], v29 offset:56320
    ds_read_b64_tr_b16 v[162:163], v29 offset:56576
    v_rcp_f32 v164, v164
    v_fma_f32 v165, v165, v182, v182
    v_mul_f32 v118, v118, v126
    v_mfma_f32_32x32x16_bf16 v[84:99], a[68:71], v[136:139], v[84:99]
    ds_read_b64_tr_b16 v[132:133], v29 offset:57344
    ds_read_b64_tr_b16 v[134:135], v29 offset:57600
    v_exp_f32 v167, v167
    v_mul_f32 v168, v168, v120
    v_fma_f32 v169, v169, v180, v181
    s_waitcnt lgkmcnt(8)
    v_mfma_f32_32x32x16_bf16 v[84:99], a[72:75], v[140:143], v[84:99]
    ds_read_b64_tr_b16 v[136:137], v29 offset:58368
    ds_read_b64_tr_b16 v[138:139], v29 offset:58624
    v_mul_f32 v170, v122, v122
    v_rcp_f32 v165, v165
    v_fma_f32 v166, v166, v182, v182
    v_mul_f32 v119, v119, v127
    v_mfma_f32_32x32x16_bf16 v[84:99], a[76:79], v[144:147], v[84:99]
    ds_read_b64_tr_b16 v[140:141], v29 offset:59392
    ds_read_b64_tr_b16 v[142:143], v29 offset:59648
    s_mul_i32 s39, s20, 1536
    s_add_u32 s39, s39, 15943168
    buffer_load_dwordx4 v[172:175], v30, s[4:7], s39 offen offset:0 sc1
    v_mfma_f32_32x32x16_bf16 v[84:99], a[80:83], v[148:151], v[84:99]
    ds_read_b64_tr_b16 v[144:145], v29 offset:60416
    ds_read_b64_tr_b16 v[146:147], v29 offset:60672
    v_exp_f32 v168, v168
    v_mul_f32 v169, v169, v121
    v_fma_f32 v170, v170, v180, v181
    s_waitcnt lgkmcnt(8)
    v_mfma_f32_32x32x16_bf16 v[84:99], a[84:87], v[152:155], v[84:99]
    ds_read_b64_tr_b16 v[148:149], v29 offset:61440
    ds_read_b64_tr_b16 v[150:151], v29 offset:61696
    v_mul_f32 v171, v123, v123
    v_mul_f32 v116, v116, v164
    v_rcp_f32 v166, v166
    v_fma_f32 v167, v167, v182, v182
    v_mfma_f32_32x32x16_bf16 v[84:99], a[88:91], v[156:159], v[84:99]
    ds_read_b64_tr_b16 v[152:153], v29 offset:62464
    ds_read_b64_tr_b16 v[154:155], v29 offset:62720
    v_mul_f32 v120, v120, v128
    v_exp_f32 v169, v169
    v_mul_f32 v170, v170, v122
    v_fma_f32 v171, v171, v180, v181
    v_mfma_f32_32x32x16_bf16 v[84:99], a[92:95], v[160:163], v[84:99]
    ds_read_b64_tr_b16 v[156:157], v29 offset:63488
    ds_read_b64_tr_b16 v[158:159], v29 offset:63744
    v_mul_f32 v117, v117, v165
    v_rcp_f32 v167, v167
    v_fma_f32 v168, v168, v182, v182
    s_waitcnt lgkmcnt(8)
    v_mfma_f32_32x32x16_bf16 v[84:99], a[96:99], v[132:135], v[84:99]
    ds_read_b64_tr_b16 v[160:161], v29 offset:64512
    ds_read_b64_tr_b16 v[162:163], v29 offset:64768
    v_mul_f32 v121, v121, v129
    v_exp_f32 v170, v170
    v_mul_f32 v171, v171, v123
    v_mul_f32 v118, v118, v166
    s_waitcnt vmcnt(10)
    s_barrier
    v_mfma_f32_32x32x16_bf16 v[84:99], a[100:103], v[136:139], v[84:99]
    ds_read_b64_tr_b16 v[132:133], v28 offset:0
    ds_read_b64_tr_b16 v[134:135], v28 offset:256
    v_rcp_f32 v168, v168
    v_fma_f32 v169, v169, v182, v182
    v_mul_f32 v122, v122, v130
    v_mfma_f32_32x32x16_bf16 v[84:99], a[104:107], v[140:143], v[84:99]
    ds_read_b64_tr_b16 v[136:137], v28 offset:1024
    ds_read_b64_tr_b16 v[138:139], v28 offset:1280
    v_exp_f32 v171, v171
    v_mul_f32 v119, v119, v167
    s_waitcnt lgkmcnt(8)
    v_mfma_f32_32x32x16_bf16 v[84:99], a[108:111], v[144:147], v[84:99]
    ds_read_b64_tr_b16 v[140:141], v28 offset:2048
    ds_read_b64_tr_b16 v[142:143], v28 offset:2304
    v_rcp_f32 v169, v169
    v_fma_f32 v170, v170, v182, v182
    v_mul_f32 v123, v123, v131
    v_mul_f32 v120, v120, v168
    v_mfma_f32_32x32x16_bf16 v[84:99], a[112:115], v[148:151], v[84:99]
    ds_read_b64_tr_b16 v[144:145], v28 offset:3072
    ds_read_b64_tr_b16 v[146:147], v28 offset:3328
    v_rcp_f32 v170, v170
    v_fma_f32 v171, v171, v182, v182
    v_mul_f32 v121, v121, v169
    v_mfma_f32_32x32x16_bf16 v[84:99], a[116:119], v[152:155], v[84:99]
    ds_read_b64_tr_b16 v[148:149], v28 offset:4096
    ds_read_b64_tr_b16 v[150:151], v28 offset:4352
    v_rcp_f32 v171, v171
    v_mul_f32 v122, v122, v170
    v_mul_f32 v123, v123, v171
    s_waitcnt lgkmcnt(8)
    v_mfma_f32_32x32x16_bf16 v[84:99], a[120:123], v[156:159], v[84:99]
    ds_read_b64_tr_b16 v[152:153], v28 offset:5120
    ds_read_b64_tr_b16 v[154:155], v28 offset:5376
    v_cvt_pk_bf16_f32 v124, v116, v117
    v_cvt_pk_bf16_f32 v125, v118, v119
    v_cvt_pk_bf16_f32 v126, v120, v121
    v_cvt_pk_bf16_f32 v127, v122, v123
    v_mfma_f32_32x32x16_bf16 v[84:99], a[124:127], v[160:163], v[84:99]
    ds_read_b64_tr_b16 v[156:157], v28 offset:6144
    ds_read_b64_tr_b16 v[158:159], v28 offset:6400
    s_cmp_eq_u32 s20, 10
    s_cselect_b32 s43, 2146435072, s43
    buffer_store_dwordx4 v[124:127], v2, s[4:7], s43 offen sc1
    v_mfma_f32_32x32x16_bf16 v[100:115], a[0:3], v[132:135], 0
    ds_read_b64_tr_b16 v[160:161], v28 offset:7168
    ds_read_b64_tr_b16 v[162:163], v28 offset:7424
    s_waitcnt vmcnt(1)
    v_cmp_eq_u32 vcc, 0, v172
    s_cbranch_vccnz mk_qs55
mk_qo56:
    v_mfma_f32_32x32x16_bf16 v[84:99], a[128:131], v[172:175], v[84:99]
    s_waitcnt lgkmcnt(8)
    v_mfma_f32_32x32x16_bf16 v[100:115], a[4:7], v[136:139], v[100:115]
    ds_read_b64_tr_b16 v[132:133], v28 offset:8192
    ds_read_b64_tr_b16 v[134:135], v28 offset:8448
    v_mfma_f32_32x32x16_bf16 v[100:115], a[8:11], v[140:143], v[100:115]
    ds_read_b64_tr_b16 v[136:137], v28 offset:9216
    ds_read_b64_tr_b16 v[138:139], v28 offset:9472
    v_mfma_f32_32x32x16_bf16 v[100:115], a[12:15], v[144:147], v[100:115]
    ds_read_b64_tr_b16 v[140:141], v28 offset:10240
    ds_read_b64_tr_b16 v[142:143], v28 offset:10496
    s_nop 1
    v_mul_f32 v164, v84, v84
    v_fma_f32 v164, v164, v172, v173
    v_mul_f32 v165, v85, v85
    s_waitcnt lgkmcnt(8)
    v_mfma_f32_32x32x16_bf16 v[100:115], a[16:19], v[148:151], v[100:115]
    ds_read_b64_tr_b16 v[144:145], v28 offset:11264
    ds_read_b64_tr_b16 v[146:147], v28 offset:11520
    v_mul_f32 v164, v164, v84
    v_fma_f32 v165, v165, v172, v173
    v_mul_f32 v166, v86, v86
    v_mfma_f32_32x32x16_bf16 v[100:115], a[20:23], v[152:155], v[100:115]
    ds_read_b64_tr_b16 v[148:149], v28 offset:12288
    ds_read_b64_tr_b16 v[150:151], v28 offset:12544
    v_exp_f32 v164, v164
    v_mul_f32 v165, v165, v85
    v_fma_f32 v166, v166, v172, v173
    v_mfma_f32_32x32x16_bf16 v[100:115], a[24:27], v[156:159], v[100:115]
    ds_read_b64_tr_b16 v[152:153], v28 offset:13312
    ds_read_b64_tr_b16 v[154:155], v28 offset:13568
    v_mul_f32 v167, v87, v87
    v_mul_f32 v84, v84, v92
    s_waitcnt lgkmcnt(8)
    v_mfma_f32_32x32x16_bf16 v[100:115], a[28:31], v[160:163], v[100:115]
    ds_read_b64_tr_b16 v[156:157], v28 offset:14336
    ds_read_b64_tr_b16 v[158:159], v28 offset:14592
    v_exp_f32 v165, v165
    v_mul_f32 v166, v166, v86
    v_fma_f32 v167, v167, v172, v173
    v_mfma_f32_32x32x16_bf16 v[100:115], a[32:35], v[132:135], v[100:115]
    ds_read_b64_tr_b16 v[160:161], v28 offset:15360
    ds_read_b64_tr_b16 v[162:163], v28 offset:15616
    v_mul_f32 v168, v88, v88
    v_fma_f32 v164, v164, v174, v174
    v_mul_f32 v85, v85, v93
    v_mfma_f32_32x32x16_bf16 v[100:115], a[36:39], v[136:139], v[100:115]
    ds_read_b64_tr_b16 v[132:133], v28 offset:16384
    ds_read_b64_tr_b16 v[134:135], v28 offset:16640
    v_exp_f32 v166, v166
    v_mul_f32 v167, v167, v87
    s_waitcnt lgkmcnt(8)
    v_mfma_f32_32x32x16_bf16 v[100:115], a[40:43], v[140:143], v[100:115]
    ds_read_b64_tr_b16 v[136:137], v28 offset:17408
    ds_read_b64_tr_b16 v[138:139], v28 offset:17664
    v_fma_f32 v168, v168, v172, v173
    v_mul_f32 v169, v89, v89
    v_rcp_f32 v164, v164
    v_mfma_f32_32x32x16_bf16 v[100:115], a[44:47], v[144:147], v[100:115]
    ds_read_b64_tr_b16 v[140:141], v28 offset:18432
    ds_read_b64_tr_b16 v[142:143], v28 offset:18688
    v_fma_f32 v165, v165, v174, v174
    v_mul_f32 v86, v86, v94
    v_exp_f32 v167, v167
    v_mfma_f32_32x32x16_bf16 v[100:115], a[48:51], v[148:151], v[100:115]
    ds_read_b64_tr_b16 v[144:145], v28 offset:19456
    ds_read_b64_tr_b16 v[146:147], v28 offset:19712
    v_mul_f32 v168, v168, v88
    v_fma_f32 v169, v169, v172, v173
    v_mul_f32 v170, v90, v90
    s_waitcnt lgkmcnt(8)
    v_mfma_f32_32x32x16_bf16 v[100:115], a[52:55], v[152:155], v[100:115]
    ds_read_b64_tr_b16 v[148:149], v28 offset:20480
    ds_read_b64_tr_b16 v[150:151], v28 offset:20736
    v_rcp_f32 v165, v165
    v_fma_f32 v166, v166, v174, v174
    v_mul_f32 v87, v87, v95
    v_mfma_f32_32x32x16_bf16 v[100:115], a[56:59], v[156:159], v[100:115]
    ds_read_b64_tr_b16 v[152:153], v28 offset:21504
    ds_read_b64_tr_b16 v[154:155], v28 offset:21760
    v_exp_f32 v168, v168
    v_mul_f32 v169, v169, v89
    v_fma_f32 v170, v170, v172, v173
    v_mfma_f32_32x32x16_bf16 v[100:115], a[60:63], v[160:163], v[100:115]
    ds_read_b64_tr_b16 v[156:157], v28 offset:22528
    ds_read_b64_tr_b16 v[158:159], v28 offset:22784
    v_mul_f32 v171, v91, v91
    v_mul_f32 v84, v84, v164
    s_waitcnt lgkmcnt(8)
    v_mfma_f32_32x32x16_bf16 v[100:115], a[64:67], v[132:135], v[100:115]
    ds_read_b64_tr_b16 v[160:161], v28 offset:23552
    ds_read_b64_tr_b16 v[162:163], v28 offset:23808
    v_rcp_f32 v166, v166
    v_fma_f32 v167, v167, v174, v174
    v_mul_f32 v88, v88, v96
    v_mfma_f32_32x32x16_bf16 v[100:115], a[68:71], v[136:139], v[100:115]
    ds_read_b64_tr_b16 v[132:133], v28 offset:24576
    ds_read_b64_tr_b16 v[134:135], v28 offset:24832
    s_waitcnt vmcnt(0)
    s_barrier
    s_add_u32 s38, s28, 16297984
    buffer_atomic_add v21, v18, s[4:7], s38 offen sc1
    v_mfma_f32_32x32x16_bf16 v[100:115], a[72:75], v[140:143], v[100:115]
    ds_read_b64_tr_b16 v[136:137], v28 offset:25600
    ds_read_b64_tr_b16 v[138:139], v28 offset:25856
    buffer_load_dwordx4 v[176:179], v30, s[4:7], s39 offen offset:512 sc1
    s_waitcnt lgkmcnt(8)
    v_mfma_f32_32x32x16_bf16 v[100:115], a[76:79], v[144:147], v[100:115]
    ds_read_b64_tr_b16 v[140:141], v28 offset:26624
    ds_read_b64_tr_b16 v[142:143], v28 offset:26880
    v_exp_f32 v169, v169
    v_mul_f32 v170, v170, v90
    v_fma_f32 v171, v171, v172, v173
    v_mfma_f32_32x32x16_bf16 v[100:115], a[80:83], v[148:151], v[100:115]
    ds_read_b64_tr_b16 v[144:145], v28 offset:27648
    ds_read_b64_tr_b16 v[146:147], v28 offset:27904
    v_mul_f32 v85, v85, v165
    v_rcp_f32 v167, v167
    v_fma_f32 v168, v168, v174, v174
    v_mfma_f32_32x32x16_bf16 v[100:115], a[84:87], v[152:155], v[100:115]
    ds_read_b64_tr_b16 v[148:149], v28 offset:28672
    ds_read_b64_tr_b16 v[150:151], v28 offset:28928
    v_mul_f32 v89, v89, v97
    v_exp_f32 v170, v170
    s_waitcnt lgkmcnt(8)
    v_mfma_f32_32x32x16_bf16 v[100:115], a[88:91], v[156:159], v[100:115]
    ds_read_b64_tr_b16 v[152:153], v28 offset:29696
    ds_read_b64_tr_b16 v[154:155], v28 offset:29952
    v_mul_f32 v171, v171, v91
    v_mul_f32 v86, v86, v166
    v_rcp_f32 v168, v168
    v_mfma_f32_32x32x16_bf16 v[100:115], a[92:95], v[160:163], v[100:115]
    ds_read_b64_tr_b16 v[156:157], v28 offset:30720
    ds_read_b64_tr_b16 v[158:159], v28 offset:30976
    v_fma_f32 v169, v169, v174, v174
    v_mul_f32 v90, v90, v98
    v_exp_f32 v171, v171
    v_mfma_f32_32x32x16_bf16 v[100:115], a[96:99], v[132:135], v[100:115]
    ds_read_b64_tr_b16 v[160:161], v28 offset:31744
    ds_read_b64_tr_b16 v[162:163], v28 offset:32000
    v_mul_f32 v87, v87, v167
    v_rcp_f32 v169, v169
    s_barrier
    s_waitcnt lgkmcnt(8)
    v_mfma_f32_32x32x16_bf16 v[100:115], a[100:103], v[136:139], v[100:115]
    ds_read_b64_tr_b16 v[132:133], v28 offset:32768
    ds_read_b64_tr_b16 v[134:135], v28 offset:33024
    v_fma_f32 v170, v170, v174, v174
    v_mul_f32 v91, v91, v99
    v_mul_f32 v88, v88, v168
    v_mfma_f32_32x32x16_bf16 v[100:115], a[104:107], v[140:143], v[100:115]
    ds_read_b64_tr_b16 v[136:137], v28 offset:33792
    ds_read_b64_tr_b16 v[138:139], v28 offset:34048
    v_rcp_f32 v170, v170
    v_fma_f32 v171, v171, v174, v174
    v_mul_f32 v89, v89, v169
    v_mfma_f32_32x32x16_bf16 v[100:115], a[108:111], v[144:147], v[100:115]
    ds_read_b64_tr_b16 v[140:141], v28 offset:34816
    ds_read_b64_tr_b16 v[142:143], v28 offset:35072
    v_rcp_f32 v171, v171
    v_mul_f32 v90, v90, v170
    s_waitcnt lgkmcnt(8)
    v_mfma_f32_32x32x16_bf16 v[100:115], a[112:115], v[148:151], v[100:115]
    ds_read_b64_tr_b16 v[144:145], v28 offset:35840
    ds_read_b64_tr_b16 v[146:147], v28 offset:36096
    v_mul_f32 v91, v91, v171
    v_cvt_pk_bf16_f32 v92, v84, v85
    v_cvt_pk_bf16_f32 v93, v86, v87
    v_cvt_pk_bf16_f32 v94, v88, v89
    v_mfma_f32_32x32x16_bf16 v[100:115], a[116:119], v[152:155], v[100:115]
    ds_read_b64_tr_b16 v[148:149], v28 offset:36864
    ds_read_b64_tr_b16 v[150:151], v28 offset:37120
    v_cvt_pk_bf16_f32 v95, v90, v91
    s_mul_i32 s43, s20, 270336
    s_lshl_b32 s32, s21, 10
    s_add_u32 s43, s43, s32
    s_add_u32 s43, s43, 34340864
    buffer_store_dwordx4 v[92:95], v2, s[4:7], s43 offen sc1
    s_add_u32 s43, s43, 90112
    v_mfma_f32_32x32x16_bf16 v[100:115], a[120:123], v[156:159], v[100:115]
    ds_read_b64_tr_b16 v[152:153], v28 offset:37888
    ds_read_b64_tr_b16 v[154:155], v28 offset:38144
    s_waitcnt lgkmcnt(8)
    v_mfma_f32_32x32x16_bf16 v[100:115], a[124:127], v[160:163], v[100:115]
    ds_read_b64_tr_b16 v[156:157], v28 offset:38912
    ds_read_b64_tr_b16 v[158:159], v28 offset:39168
    s_waitcnt vmcnt(1)
    v_cmp_eq_u32 vcc, 0, v176
    s_cbranch_vccnz mk_qs58
mk_qo59:
    v_mfma_f32_32x32x16_bf16 v[100:115], a[128:131], v[176:179], v[100:115]
    s_add_u32 s37, s29, 16297984
    v_mov_b32 v20, 0
    buffer_atomic_add v20, v13, s[4:7], s37 offen sc0 sc1
    s_mul_i32 s93, s22, 90112
    s_lshl_b32 s33, s3, 10
    s_add_u32 s93, s93, s33
    s_add_u32 s93, s93, 31457280
    s_add_u32 s94, s93, 90112
    s_mul_i32 s40, s23, 0
    s_add_u32 s40, s40, s93
    v_mfma_f32_32x32x16_bf16 v[116:131], a[0:3], v[132:135], 0
    ds_read_b64_tr_b16 v[160:161], v28 offset:39936
    ds_read_b64_tr_b16 v[162:163], v28 offset:40192
    v_mfma_f32_32x32x16_bf16 v[116:131], a[4:7], v[136:139], v[116:131]
    ds_read_b64_tr_b16 v[132:133], v28 offset:40960
    ds_read_b64_tr_b16 v[134:135], v28 offset:41216
    s_waitcnt lgkmcnt(8)
    v_mfma_f32_32x32x16_bf16 v[116:131], a[8:11], v[140:143], v[116:131]
    ds_read_b64_tr_b16 v[136:137], v28 offset:41984
    ds_read_b64_tr_b16 v[138:139], v28 offset:42240
    v_mul_f32 v164, v100, v100
    v_fma_f32 v164, v164, v176, v177
    v_mul_f32 v165, v101, v101
    v_mul_f32 v164, v164, v100
    v_mfma_f32_32x32x16_bf16 v[116:131], a[12:15], v[144:147], v[116:131]
    ds_read_b64_tr_b16 v[140:141], v28 offset:43008
    ds_read_b64_tr_b16 v[142:143], v28 offset:43264
    v_fma_f32 v165, v165, v176, v177
    v_mul_f32 v166, v102, v102
    v_exp_f32 v164, v164
    v_mfma_f32_32x32x16_bf16 v[116:131], a[16:19], v[148:151], v[116:131]
    ds_read_b64_tr_b16 v[144:145], v28 offset:44032
    ds_read_b64_tr_b16 v[146:147], v28 offset:44288
    v_mul_f32 v165, v165, v101
    v_fma_f32 v166, v166, v176, v177
    v_mul_f32 v167, v103, v103
    s_waitcnt lgkmcnt(8)
    v_mfma_f32_32x32x16_bf16 v[116:131], a[20:23], v[152:155], v[116:131]
    ds_read_b64_tr_b16 v[148:149], v28 offset:45056
    ds_read_b64_tr_b16 v[150:151], v28 offset:45312
    v_mul_f32 v100, v100, v108
    v_exp_f32 v165, v165
    v_mul_f32 v166, v166, v102
    v_mfma_f32_32x32x16_bf16 v[116:131], a[24:27], v[156:159], v[116:131]
    ds_read_b64_tr_b16 v[152:153], v28 offset:46080
    ds_read_b64_tr_b16 v[154:155], v28 offset:46336
    v_fma_f32 v167, v167, v176, v177
    v_mul_f32 v168, v104, v104
    v_fma_f32 v164, v164, v178, v178
    v_mul_f32 v101, v101, v109
    v_mfma_f32_32x32x16_bf16 v[116:131], a[28:31], v[160:163], v[116:131]
    ds_read_b64_tr_b16 v[156:157], v28 offset:47104
    ds_read_b64_tr_b16 v[158:159], v28 offset:47360
    v_exp_f32 v166, v166
    v_mul_f32 v167, v167, v103
    s_waitcnt lgkmcnt(8)
    v_mfma_f32_32x32x16_bf16 v[116:131], a[32:35], v[132:135], v[116:131]
    ds_read_b64_tr_b16 v[160:161], v28 offset:48128
    ds_read_b64_tr_b16 v[162:163], v28 offset:48384
    v_fma_f32 v168, v168, v176, v177
    v_mul_f32 v169, v105, v105
    v_rcp_f32 v164, v164
    v_mfma_f32_32x32x16_bf16 v[116:131], a[36:39], v[136:139], v[116:131]
    ds_read_b64_tr_b16 v[132:133], v28 offset:49152
    ds_read_b64_tr_b16 v[134:135], v28 offset:49408
    v_fma_f32 v165, v165, v178, v178
    v_mul_f32 v102, v102, v110
    v_exp_f32 v167, v167
    v_mfma_f32_32x32x16_bf16 v[116:131], a[40:43], v[140:143], v[116:131]
    ds_read_b64_tr_b16 v[136:137], v28 offset:50176
    ds_read_b64_tr_b16 v[138:139], v28 offset:50432
    v_mul_f32 v168, v168, v104
    v_fma_f32 v169, v169, v176, v177
    v_mul_f32 v170, v106, v106
    s_waitcnt lgkmcnt(8)
    v_mfma_f32_32x32x16_bf16 v[116:131], a[44:47], v[144:147], v[116:131]
    ds_read_b64_tr_b16 v[140:141], v28 offset:51200
    ds_read_b64_tr_b16 v[142:143], v28 offset:51456
    buffer_load_dwordx4 v[180:183], v30, s[4:7], s39 offen offset:1024 sc1
    v_rcp_f32 v165, v165
    v_mfma_f32_32x32x16_bf16 v[116:131], a[48:51], v[148:151], v[116:131]
    ds_read_b64_tr_b16 v[144:145], v28 offset:52224
    ds_read_b64_tr_b16 v[146:147], v28 offset:52480
    v_fma_f32 v166, v166, v178, v178
    v_mul_f32 v103, v103, v111
    v_exp_f32 v168, v168
    v_mfma_f32_32x32x16_bf16 v[116:131], a[52:55], v[152:155], v[116:131]
    ds_read_b64_tr_b16 v[148:149], v28 offset:53248
    ds_read_b64_tr_b16 v[150:151], v28 offset:53504
    v_mul_f32 v169, v169, v105
    v_fma_f32 v170, v170, v176, v177
    v_mul_f32 v171, v107, v107
    s_waitcnt lgkmcnt(8)
    v_mfma_f32_32x32x16_bf16 v[116:131], a[56:59], v[156:159], v[116:131]
    ds_read_b64_tr_b16 v[152:153], v28 offset:54272
    ds_read_b64_tr_b16 v[154:155], v28 offset:54528
    v_mul_f32 v100, v100, v164
    v_rcp_f32 v166, v166
    v_fma_f32 v167, v167, v178, v178
    v_mfma_f32_32x32x16_bf16 v[116:131], a[60:63], v[160:163], v[116:131]
    ds_read_b64_tr_b16 v[156:157], v28 offset:55296
    ds_read_b64_tr_b16 v[158:159], v28 offset:55552
    s_waitcnt vmcnt(1)
    v_cmp_gt_u32 vcc, 11, v20
    s_nop 0
    s_and_b64 vcc, vcc, s[52:53]
    s_cbranch_scc1 mk_ps61
mk_po62:
    s_barrier
    v_mfma_f32_32x32x16_bf16 v[116:131], a[64:67], v[132:135], v[116:131]
    ds_read_b64_tr_b16 v[160:161], v28 offset:56320
    ds_read_b64_tr_b16 v[162:163], v28 offset:56576
    buffer_load_dwordx4 v[252:255], v2, s[4:7], s40 offen sc1
    s_add_u32 s40, s40, 4096
    s_waitcnt lgkmcnt(8)
    v_mfma_f32_32x32x16_bf16 v[116:131], a[68:71], v[136:139], v[116:131]
    ds_read_b64_tr_b16 v[132:133], v28 offset:57344
    ds_read_b64_tr_b16 v[134:135], v28 offset:57600
    v_mul_f32 v104, v104, v112
    v_exp_f32 v169, v169
    v_mul_f32 v170, v170, v106
    v_mfma_f32_32x32x16_bf16 v[116:131], a[72:75], v[140:143], v[116:131]
    ds_read_b64_tr_b16 v[136:137], v28 offset:58368
    ds_read_b64_tr_b16 v[138:139], v28 offset:58624
    buffer_load_dwordx4 v[248:251], v2, s[4:7], s40 offen sc1
    s_add_u32 s40, s40, 4096
    v_fma_f32 v171, v171, v176, v177
    v_mfma_f32_32x32x16_bf16 v[116:131], a[76:79], v[144:147], v[116:131]
    ds_read_b64_tr_b16 v[140:141], v28 offset:59392
    ds_read_b64_tr_b16 v[142:143], v28 offset:59648
    v_mul_f32 v101, v101, v165
    v_rcp_f32 v167, v167
    s_waitcnt lgkmcnt(8)
    v_mfma_f32_32x32x16_bf16 v[116:131], a[80:83], v[148:151], v[116:131]
    ds_read_b64_tr_b16 v[144:145], v28 offset:60416
    ds_read_b64_tr_b16 v[146:147], v28 offset:60672
    buffer_load_dwordx4 v[244:247], v2, s[4:7], s40 offen sc1
    s_add_u32 s40, s40, 4096
    v_fma_f32 v168, v168, v178, v178
    v_mfma_f32_32x32x16_bf16 v[116:131], a[84:87], v[152:155], v[116:131]
    ds_read_b64_tr_b16 v[148:149], v28 offset:61440
    ds_read_b64_tr_b16 v[150:151], v28 offset:61696
    v_mul_f32 v105, v105, v113
    v_exp_f32 v170, v170
    v_mul_f32 v171, v171, v107
    v_mfma_f32_32x32x16_bf16 v[116:131], a[88:91], v[156:159], v[116:131]
    ds_read_b64_tr_b16 v[152:153], v28 offset:62464
    ds_read_b64_tr_b16 v[154:155], v28 offset:62720
    buffer_load_dwordx4 v[240:243], v2, s[4:7], s40 offen sc1
    s_add_u32 s40, s40, 4096
    s_waitcnt lgkmcnt(8)
    v_mfma_f32_32x32x16_bf16 v[116:131], a[92:95], v[160:163], v[116:131]
    ds_read_b64_tr_b16 v[156:157], v28 offset:63488
    ds_read_b64_tr_b16 v[158:159], v28 offset:63744
    v_mul_f32 v102, v102, v166
    v_rcp_f32 v168, v168
    v_fma_f32 v169, v169, v178, v178
    v_mfma_f32_32x32x16_bf16 v[116:131], a[96:99], v[132:135], v[116:131]
    ds_read_b64_tr_b16 v[160:161], v28 offset:64512
    ds_read_b64_tr_b16 v[162:163], v28 offset:64768
    buffer_load_dwordx4 v[236:239], v2, s[4:7], s40 offen sc1
    s_add_u32 s40, s40, 4096
    s_waitcnt vmcnt(5)
    v_cmp_eq_u32 vcc, 0, v180
    s_cbranch_vccnz mk_qs64
mk_qo65:
    v_mfma_f32_32x32x16_bf16 v[116:131], a[128:131], v[180:183], v[116:131]
    v_mfma_f32_32x32x16_bf16 v[116:131], a[100:103], v[136:139], v[116:131]
    v_mul_f32 v106, v106, v114
    v_exp_f32 v171, v171
    v_mul_f32 v103, v103, v167
    s_waitcnt lgkmcnt(6)
    v_mfma_f32_32x32x16_bf16 v[116:131], a[104:107], v[140:143], v[116:131]
    buffer_load_dwordx4 v[232:235], v2, s[4:7], s40 offen sc1
    s_add_u32 s40, s40, 4096
    v_rcp_f32 v169, v169
    v_fma_f32 v170, v170, v178, v178
    v_mfma_f32_32x32x16_bf16 v[116:131], a[108:111], v[144:147], v[116:131]
    v_mul_f32 v107, v107, v115
    v_mul_f32 v104, v104, v168
    v_rcp_f32 v170, v170
    v_fma_f32 v171, v171, v178, v178
    v_mul_f32 v105, v105, v169
    v_mfma_f32_32x32x16_bf16 v[116:131], a[112:115], v[148:151], v[116:131]
    buffer_load_dwordx4 v[228:231], v2, s[4:7], s40 offen sc1
    s_add_u32 s40, s40, 4096
    v_rcp_f32 v171, v171
    s_waitcnt lgkmcnt(0)
    v_mfma_f32_32x32x16_bf16 v[116:131], a[116:119], v[152:155], v[116:131]
    v_mul_f32 v106, v106, v170
    v_mul_f32 v107, v107, v171
    v_cvt_pk_bf16_f32 v108, v100, v101
    v_cvt_pk_bf16_f32 v109, v102, v103
    v_cvt_pk_bf16_f32 v110, v104, v105
    v_cvt_pk_bf16_f32 v111, v106, v107
    v_mfma_f32_32x32x16_bf16 v[116:131], a[120:123], v[156:159], v[116:131]
    buffer_load_dwordx4 v[224:227], v2, s[4:7], s40 offen sc1
    s_add_u32 s40, s40, 4096
    buffer_store_dwordx4 v[108:111], v2, s[4:7], s43 offen sc1
    s_add_u32 s43, s43, 90112
    v_mfma_f32_32x32x16_bf16 v[116:131], a[124:127], v[160:163], v[116:131]
    s_nop 11
    v_pk_mul_f32 v[164:165], v[116:117], v[116:117]
    v_pk_mul_f32 v[166:167], v[118:119], v[118:119]
    v_pk_mul_f32 v[168:169], v[120:121], v[120:121]
    v_pk_mul_f32 v[170:171], v[122:123], v[122:123]
    v_pk_fma_f32 v[164:165], v[164:165], v[180:181], v[180:181] op_sel:[0,0,1] op_sel_hi:[1,0,1]
    v_pk_fma_f32 v[166:167], v[166:167], v[180:181], v[180:181] op_sel:[0,0,1] op_sel_hi:[1,0,1]
    v_pk_fma_f32 v[168:169], v[168:169], v[180:181], v[180:181] op_sel:[0,0,1] op_sel_hi:[1,0,1]
    v_pk_fma_f32 v[170:171], v[170:171], v[180:181], v[180:181] op_sel:[0,0,1] op_sel_hi:[1,0,1]
    v_pk_mul_f32 v[164:165], v[164:165], v[116:117]
    v_pk_mul_f32 v[166:167], v[166:167], v[118:119]
    v_pk_mul_f32 v[168:169], v[168:169], v[120:121]
    v_pk_mul_f32 v[170:171], v[170:171], v[122:123]
    buffer_load_dwordx4 v[220:223], v2, s[4:7], s40 offen sc1
    s_add_u32 s40, s40, 4096
    v_exp_f32 v164, v164
    v_exp_f32 v165, v165
    v_exp_f32 v166, v166
    v_exp_f32 v167, v167
    v_exp_f32 v168, v168
    v_exp_f32 v169, v169
    v_exp_f32 v170, v170
    v_exp_f32 v171, v171
    v_pk_mul_f32 v[116:117], v[116:117], v[124:125]
    v_pk_mul_f32 v[118:119], v[118:119], v[126:127]
    v_pk_mul_f32 v[120:121], v[120:121], v[128:129]
    v_pk_mul_f32 v[122:123], v[122:123], v[130:131]
    buffer_load_dwordx4 v[216:219], v2, s[4:7], s40 offen sc1
    s_add_u32 s40, s40, 4096
    v_pk_fma_f32 v[164:165], v[164:165], v[182:183], v[182:183] op_sel:[0,0,0] op_sel_hi:[1,0,0]
    v_pk_fma_f32 v[166:167], v[166:167], v[182:183], v[182:183] op_sel:[0,0,0] op_sel_hi:[1,0,0]
    v_pk_fma_f32 v[168:169], v[168:169], v[182:183], v[182:183] op_sel:[0,0,0] op_sel_hi:[1,0,0]
    v_pk_fma_f32 v[170:171], v[170:171], v[182:183], v[182:183] op_sel:[0,0,0] op_sel_hi:[1,0,0]
    v_rcp_f32 v164, v164
    v_rcp_f32 v165, v165
    v_rcp_f32 v166, v166
    v_rcp_f32 v167, v167
    v_rcp_f32 v168, v168
    v_rcp_f32 v169, v169
    v_rcp_f32 v170, v170
    v_rcp_f32 v171, v171
    buffer_load_dwordx4 v[212:215], v2, s[4:7], s40 offen sc1
    s_add_u32 s40, s40, 4096
    v_pk_mul_f32 v[116:117], v[116:117], v[164:165]
    v_pk_mul_f32 v[118:119], v[118:119], v[166:167]
    v_pk_mul_f32 v[120:121], v[120:121], v[168:169]
    v_pk_mul_f32 v[122:123], v[122:123], v[170:171]
    v_cvt_pk_bf16_f32 v124, v116, v117
    v_cvt_pk_bf16_f32 v125, v118, v119
    v_cvt_pk_bf16_f32 v126, v120, v121
    v_cvt_pk_bf16_f32 v127, v122, v123
    s_cmp_eq_u32 s20, 10
    s_cselect_b32 s43, 2146435072, s43
    buffer_store_dwordx4 v[124:127], v2, s[4:7], s43 offen sc1
    buffer_load_dwordx4 v[208:211], v2, s[4:7], s40 offen sc1
    s_add_u32 s40, s40, 4096
    buffer_load_dwordx4 v[204:207], v2, s[4:7], s40 offen sc1
    s_add_u32 s40, s40, 4096
    buffer_load_dwordx4 v[200:203], v2, s[4:7], s40 offen sc1
    s_add_u32 s40, s40, 4096
mk_B1:
    s_lshl_b32 s42, s22, 15
    s_lshl_b32 s31, s23, 12
    s_add_u32 s42, s42, s31
    s_add_u32 s42, s42, 7340032
    s_lshl_b32 s32, s3, 10
    s_add_u32 s32, s32, 133120
    s_mov_b32 m0, s32
    s_waitcnt vmcnt(15)
    v_mfma_f32_32x32x16_bf16 v[84:99], a[132:135], v[252:255], 0
    v_lshrrev_b32 v117, 2, v0
    v_and_b32 v118, 3, v0
    v_and_b32 v116, 31, v1
    v_mul_u32_u24 v116, 272, v116
    buffer_load_dwordx4 v[196:199], v2, s[4:7], s40 offen sc1
    s_add_u32 s40, s40, 4096
    s_waitcnt vmcnt(15)
    v_mfma_f32_32x32x16_bf16 v[84:99], a[140:143], v[248:251], v[84:99]
    v_lshrrev_b32 v119, 5, v1
    v_lshl_add_u32 v116, v119, 4, v116
    s_mul_i32 s31, s3, 8704
    s_add_u32 s31, s31, 98304
    s_waitcnt vmcnt(14)
    v_mfma_f32_32x32x16_bf16 v[84:99], a[148:151], v[244:247], v[84:99]
    v_add_u32 v14, s31, v116
    v_lshrrev_b32 v117, 3, v0
    v_and_b32 v118, 7, v0
    v_mul_u32_u24 v116, 272, v117
    buffer_load_dwordx4 v[192:195], v2, s[4:7], s40 offen sc1
    s_add_u32 s40, s40, 4096
    s_waitcnt vmcnt(14)
    v_mfma_f32_32x32x16_bf16 v[84:99], a[156:159], v[240:243], v[84:99]
    v_lshl_add_u32 v15, v118, 5, v116
    v_add_u32 v15, 98304, v15
    v_lshlrev_b32 v24, 10, v117
    v_lshl_add_u32 v24, v118, 4, v24
    s_waitcnt vmcnt(13)
    v_mfma_f32_32x32x16_bf16 v[84:99], a[164:167], v[236:239], v[84:99]
    v_mul_u32_u24 v116, 144, v117
    v_lshl_add_u32 v25, v118, 4, v116
    v_add_u32 v25, 137216, v25
    v_lshlrev_b32 v116, 3, v119
    buffer_load_dwordx4 v[188:191], v2, s[4:7], s40 offen sc1
    s_add_u32 s40, s40, 4096
    s_waitcnt vmcnt(13)
    v_mfma_f32_32x32x16_bf16 v[84:99], a[172:175], v[232:235], v[84:99]
    v_bfe_u32 v117, v1, 2, 2
    v_add_u32 v116, v116, v117
    v_lshlrev_b32 v116, 6, v116
    v_bfe_u32 v117, v1, 4, 1
    v_mfma_f32_32x32x16_bf16 v[100:115], a[136:139], v[252:255], 0
    v_lshl_add_u32 v116, v117, 5, v116
    v_and_b32 v117, 3, v1
    v_lshl_add_u32 v116, v117, 3, v116
    v_add_u32 v26, s32, v116
    buffer_load_dwordx4 v[184:187], v2, s[4:7], s40 offen sc1
    s_add_u32 s40, s40, 4096
    s_waitcnt vmcnt(13)
    v_mfma_f32_32x32x16_bf16 v[84:99], a[180:183], v[228:231], v[84:99]
    v_and_b32 v116, 31, v1
    v_mul_u32_u24 v116, 144, v116
    v_lshl_add_u32 v116, v119, 4, v116
    s_lshl_b32 s31, s3, 5
    v_mfma_f32_32x32x16_bf16 v[100:115], a[144:147], v[248:251], v[100:115]
    s_add_u32 s31, s31, 137216
    v_add_u32 v27, s31, v116
    s_lshl_b32 s43, s22, 15
    s_lshl_b32 s33, s23, 7
    buffer_load_dwordx4 v[136:139], v2, s[4:7], s40 offen sc1
    s_add_u32 s40, s40, 4096
    s_waitcnt vmcnt(13)
    v_mfma_f32_32x32x16_bf16 v[84:99], a[188:191], v[224:227], v[84:99]
    s_add_u32 s43, s43, s33
    v_mfma_f32_32x32x16_bf16 v[100:115], a[152:155], v[244:247], v[100:115]
    buffer_load_dwordx4 v[140:143], v2, s[4:7], s40 offen sc1
    s_add_u32 s40, s40, 4096
    s_waitcnt vmcnt(12)
    v_mfma_f32_32x32x16_bf16 v[84:99], a[196:199], v[220:223], v[84:99]
    v_mfma_f32_32x32x16_bf16 v[100:115], a[160:163], v[240:243], v[100:115]
    buffer_load_dwordx4 v[144:147], v2, s[4:7], s40 offen sc1
    s_add_u32 s40, s40, 4096
    s_waitcnt vmcnt(12)
    v_mfma_f32_32x32x16_bf16 v[84:99], a[204:207], v[216:219], v[84:99]
    v_mfma_f32_32x32x16_bf16 v[100:115], a[168:171], v[236:239], v[100:115]
    buffer_load_dwordx4 v[148:151], v2, s[4:7], s40 offen sc1
    s_waitcnt vmcnt(12)
    v_mfma_f32_32x32x16_bf16 v[84:99], a[212:215], v[212:215], v[84:99]
    v_mfma_f32_32x32x16_bf16 v[100:115], a[176:179], v[232:235], v[100:115]
    buffer_load_dwordx4 v3, s[4:7], s42 offen sc1 lds
    s_waitcnt vmcnt(11)
    v_mfma_f32_32x32x16_bf16 v[84:99], a[220:223], v[208:211], v[84:99]
    v_mfma_f32_32x32x16_bf16 v[100:115], a[184:187], v[228:231], v[100:115]
    s_waitcnt vmcnt(10)
    v_mfma_f32_32x32x16_bf16 v[84:99], a[228:231], v[204:207], v[84:99]
    v_mfma_f32_32x32x16_bf16 v[100:115], a[192:195], v[224:227], v[100:115]
    s_waitcnt vmcnt(9)
    v_mfma_f32_32x32x16_bf16 v[84:99], a[236:239], v[200:203], v[84:99]
    v_mfma_f32_32x32x16_bf16 v[100:115], a[200:203], v[220:223], v[100:115]
    s_barrier
    s_add_u32 s38, s28, 16320512
    buffer_atomic_add v21, v18, s[4:7], s38 offen sc1
    s_waitcnt vmcnt(9)
    v_mfma_f32_32x32x16_bf16 v[84:99], a[244:247], v[196:199], v[84:99]
    v_mfma_f32_32x32x16_bf16 v[100:115], a[208:211], v[216:219], v[100:115]
    s_waitcnt vmcnt(8)
    v_mfma_f32_32x32x16_bf16 v[84:99], a[252:255], v[192:195], v[84:99]
    v_mfma_f32_32x32x16_bf16 v[100:115], a[216:219], v[212:215], v[100:115]
    s_waitcnt vmcnt(7)
    v_mfma_f32_32x32x16_bf16 v[84:99], v[36:39], v[188:191], v[84:99]
    v_mfma_f32_32x32x16_bf16 v[100:115], a[224:227], v[208:211], v[100:115]
    s_waitcnt vmcnt(6)
    v_mfma_f32_32x32x16_bf16 v[84:99], v[44:47], v[184:187], v[84:99]
    v_mfma_f32_32x32x16_bf16 v[100:115], a[232:235], v[204:207], v[100:115]
    s_waitcnt vmcnt(5)
    v_mfma_f32_32x32x16_bf16 v[84:99], v[52:55], v[136:139], v[84:99]
    v_mfma_f32_32x32x16_bf16 v[100:115], a[240:243], v[200:203], v[100:115]
    s_waitcnt vmcnt(1)
    ds_read_b64_tr_b16 v[116:117], v26 offset:0
    ds_read_b64_tr_b16 v[118:119], v26 offset:256
    v_mfma_f32_32x32x16_bf16 v[84:99], v[60:63], v[140:143], v[84:99]
    v_mfma_f32_32x32x16_bf16 v[100:115], a[248:251], v[196:199], v[100:115]
    v_mfma_f32_32x32x16_bf16 v[84:99], v[68:71], v[144:147], v[84:99]
    v_mfma_f32_32x32x16_bf16 v[100:115], v[32:35], v[192:195], v[100:115]
    s_waitcnt lgkmcnt(0)
    ds_write_b128 v27, v[116:119]
    v_mfma_f32_32x32x16_bf16 v[84:99], v[76:79], v[148:151], v[84:99]
    v_mfma_f32_32x32x16_bf16 v[100:115], v[40:43], v[188:191], v[100:115]
    v_mfma_f32_32x32x16_bf16 v[100:115], v[48:51], v[184:187], v[100:115]
    v_mfma_f32_32x32x16_bf16 v[100:115], v[56:59], v[136:139], v[100:115]
    s_nop 8
    ds_write_b128 v14, v[84:87] offset:0
    v_mfma_f32_32x32x16_bf16 v[100:115], v[64:67], v[140:143], v[100:115]
    ds_write_b128 v14, v[88:91] offset:32
    v_mfma_f32_32x32x16_bf16 v[100:115], v[72:75], v[144:147], v[100:115]
    ds_write_b128 v14, v[92:95] offset:64
    v_mfma_f32_32x32x16_bf16 v[100:115], v[80:83], v[148:151], v[100:115]
    ds_write_b128 v14, v[96:99] offset:96
    s_nop 10
    ds_write_b128 v14, v[100:103] offset:128
    ds_write_b128 v14, v[104:107] offset:160
    ds_write_b128 v14, v[108:111] offset:192
    ds_write_b128 v14, v[112:115] offset:224
    s_mul_i32 s93, s22, 90112
    s_lshl_b32 s33, s3, 10
    s_add_u32 s93, s93, s33
    s_add_u32 s93, s93, 34340864
    s_add_u32 s94, s93, 90112
    s_mul_i32 s40, s23, 0
    s_add_u32 s40, s40, s93
    s_add_u32 s37, s29, 16320512
    v_mov_b32 v20, 0
    buffer_atomic_add v20, v13, s[4:7], s37 offen sc0 sc1
    s_waitcnt lgkmcnt(0)
    s_barrier
    ds_read_b128 v[84:87], v15 offset:0
    ds_read_b128 v[88:91], v15 offset:16
    ds_read_b128 v[92:95], v15 offset:8704
    ds_read_b128 v[96:99], v15 offset:8720
    ds_read_b128 v[100:103], v15 offset:17408
    ds_read_b128 v[104:107], v15 offset:17424
    ds_read_b128 v[108:111], v15 offset:26112
    ds_read_b128 v[112:115], v15 offset:26128
    ds_read_b128 v[132:135], v25
    s_waitcnt lgkmcnt(5)
    v_pk_add_f32 v[84:85], v[84:85], v[92:93]
    v_pk_add_f32 v[86:87], v[86:87], v[94:95]
    v_pk_add_f32 v[88:89], v[88:89], v[96:97]
    v_pk_add_f32 v[90:91], v[90:91], v[98:99]
    s_waitcnt lgkmcnt(0)
    v_pk_add_f32 v[100:101], v[100:101], v[108:109]
    v_pk_add_f32 v[102:103], v[102:103], v[110:111]
    v_pk_add_f32 v[104:105], v[104:105], v[112:113]
    v_pk_add_f32 v[106:107], v[106:107], v[114:115]
    v_lshlrev_b32 v124, 16, v132
    v_and_b32 v125, 0xffff0000, v132
    v_lshlrev_b32 v126, 16, v133
    v_and_b32 v127, 0xffff0000, v133
    v_lshlrev_b32 v128, 16, v134
    v_and_b32 v129, 0xffff0000, v134
    v_lshlrev_b32 v130, 16, v135
    v_and_b32 v131, 0xffff0000, v135
    v_pk_add_f32 v[84:85], v[84:85], v[100:101]
    v_pk_add_f32 v[86:87], v[86:87], v[102:103]
    v_pk_add_f32 v[88:89], v[88:89], v[104:105]
    v_pk_add_f32 v[90:91], v[90:91], v[106:107]
    v_pk_add_f32 v[84:85], v[84:85], v[124:125]
    v_pk_add_f32 v[86:87], v[86:87], v[126:127]
    v_pk_add_f32 v[88:89], v[88:89], v[128:129]
    v_pk_add_f32 v[90:91], v[90:91], v[130:131]
    v_cvt_pk_bf16_f32 v120, v84, v85
    v_cvt_pk_bf16_f32 v121, v86, v87
    v_cvt_pk_bf16_f32 v122, v88, v89
    v_cvt_pk_bf16_f32 v123, v90, v91
    buffer_store_dwordx4 v[120:123], v24, s[8:11], s43 offen
    s_waitcnt vmcnt(1)
    v_cmp_gt_u32 vcc, 11, v20
    s_nop 0
    s_and_b64 vcc, vcc, s[52:53]
    s_cbranch_scc1 mk_ps67
mk_po68:
    s_barrier
    s_barrier
    s_add_u32 s42, s42, 1048576
    s_add_u32 s43, s43, 1048576
    buffer_load_dwordx4 v[252:255], v2, s[4:7], s40 offen sc1
    s_add_u32 s40, s40, 4096
    buffer_load_dwordx4 v[248:251], v2, s[4:7], s40 offen sc1
    s_add_u32 s40, s40, 4096
    buffer_load_dwordx4 v[244:247], v2, s[4:7], s40 offen sc1
    s_add_u32 s40, s40, 4096
    buffer_load_dwordx4 v[240:243], v2, s[4:7], s40 offen sc1
    s_add_u32 s40, s40, 4096
    buffer_load_dwordx4 v[236:239], v2, s[4:7], s40 offen sc1
    s_add_u32 s40, s40, 4096
    buffer_load_dwordx4 v[232:235], v2, s[4:7], s40 offen sc1
    s_add_u32 s40, s40, 4096
    buffer_load_dwordx4 v[228:231], v2, s[4:7], s40 offen sc1
    s_add_u32 s40, s40, 4096
    buffer_load_dwordx4 v[224:227], v2, s[4:7], s40 offen sc1
    s_add_u32 s40, s40, 4096
    buffer_load_dwordx4 v[220:223], v2, s[4:7], s40 offen sc1
    s_add_u32 s40, s40, 4096
    buffer_load_dwordx4 v[216:219], v2, s[4:7], s40 offen sc1
    s_add_u32 s40, s40, 4096
    buffer_load_dwordx4 v[212:215], v2, s[4:7], s40 offen sc1
    s_add_u32 s40, s40, 4096
    buffer_load_dwordx4 v[208:211], v2, s[4:7], s40 offen sc1
    s_add_u32 s40, s40, 4096
    buffer_load_dwordx4 v[204:207], v2, s[4:7], s40 offen sc1
    s_add_u32 s40, s40, 4096
    buffer_load_dwordx4 v[200:203], v2, s[4:7], s40 offen sc1
    s_add_u32 s40, s40, 4096
    s_waitcnt vmcnt(13)
    v_mfma_f32_32x32x16_bf16 v[84:99], a[132:135], v[252:255], 0
    buffer_load_dwordx4 v[196:199], v2, s[4:7], s40 offen sc1
    s_add_u32 s40, s40, 4096
    s_waitcnt vmcnt(13)
    v_mfma_f32_32x32x16_bf16 v[84:99], a[140:143], v[248:251], v[84:99]
    s_waitcnt vmcnt(12)
    v_mfma_f32_32x32x16_bf16 v[84:99], a[148:151], v[244:247], v[84:99]
    buffer_load_dwordx4 v[192:195], v2, s[4:7], s40 offen sc1
    s_add_u32 s40, s40, 4096
    s_waitcnt vmcnt(12)
    v_mfma_f32_32x32x16_bf16 v[84:99], a[156:159], v[240:243], v[84:99]
    s_waitcnt vmcnt(11)
    v_mfma_f32_32x32x16_bf16 v[84:99], a[164:167], v[236:239], v[84:99]
    buffer_load_dwordx4 v[188:191], v2, s[4:7], s40 offen sc1
    s_add_u32 s40, s40, 4096
    s_waitcnt vmcnt(11)
    v_mfma_f32_32x32x16_bf16 v[84:99], a[172:175], v[232:235], v[84:99]
    v_mfma_f32_32x32x16_bf16 v[100:115], a[136:139], v[252:255], 0
    buffer_load_dwordx4 v[184:187], v2, s[4:7], s40 offen sc1
    s_add_u32 s40, s40, 4096
    s_waitcnt vmcnt(11)
    v_mfma_f32_32x32x16_bf16 v[84:99], a[180:183], v[228:231], v[84:99]
    v_mfma_f32_32x32x16_bf16 v[100:115], a[144:147], v[248:251], v[100:115]
    buffer_load_dwordx4 v[136:139], v2, s[4:7], s40 offen sc1
    s_add_u32 s40, s40, 4096
    s_waitcnt vmcnt(11)
    v_mfma_f32_32x32x16_bf16 v[84:99], a[188:191], v[224:227], v[84:99]
    v_mfma_f32_32x32x16_bf16 v[100:115], a[152:155], v[244:247], v[100:115]
    buffer_load_dwordx4 v[140:143], v2, s[4:7], s40 offen sc1
    s_add_u32 s40, s40, 4096
    s_waitcnt vmcnt(11)
    v_mfma_f32_32x32x16_bf16 v[84:99], a[196:199], v[220:223], v[84:99]
    v_mfma_f32_32x32x16_bf16 v[100:115], a[160:163], v[240:243], v[100:115]
    buffer_load_dwordx4 v[144:147], v2, s[4:7], s40 offen sc1
    s_add_u32 s40, s40, 4096
    s_waitcnt vmcnt(11)
    v_mfma_f32_32x32x16_bf16 v[84:99], a[204:207], v[216:219], v[84:99]
    v_mfma_f32_32x32x16_bf16 v[100:115], a[168:171], v[236:239], v[100:115]
    buffer_load_dwordx4 v[148:151], v2, s[4:7], s40 offen sc1
    s_waitcnt vmcnt(11)
    v_mfma_f32_32x32x16_bf16 v[84:99], a[212:215], v[212:215], v[84:99]
    v_mfma_f32_32x32x16_bf16 v[100:115], a[176:179], v[232:235], v[100:115]
    buffer_load_dwordx4 v3, s[4:7], s42 offen sc1 lds
    s_waitcnt vmcnt(11)
    v_mfma_f32_32x32x16_bf16 v[84:99], a[220:223], v[208:211], v[84:99]
    v_mfma_f32_32x32x16_bf16 v[100:115], a[184:187], v[228:231], v[100:115]
    s_waitcnt vmcnt(10)
    v_mfma_f32_32x32x16_bf16 v[84:99], a[228:231], v[204:207], v[84:99]
    v_mfma_f32_32x32x16_bf16 v[100:115], a[192:195], v[224:227], v[100:115]
    s_waitcnt vmcnt(9)
    v_mfma_f32_32x32x16_bf16 v[84:99], a[236:239], v[200:203], v[84:99]
    v_mfma_f32_32x32x16_bf16 v[100:115], a[200:203], v[220:223], v[100:115]
    s_waitcnt vmcnt(8)
    v_mfma_f32_32x32x16_bf16 v[84:99], a[244:247], v[196:199], v[84:99]
    v_mfma_f32_32x32x16_bf16 v[100:115], a[208:211], v[216:219], v[100:115]
    s_waitcnt vmcnt(7)
    v_mfma_f32_32x32x16_bf16 v[84:99], a[252:255], v[192:195], v[84:99]
    v_mfma_f32_32x32x16_bf16 v[100:115], a[216:219], v[212:215], v[100:115]
    s_waitcnt vmcnt(6)
    v_mfma_f32_32x32x16_bf16 v[84:99], v[36:39], v[188:191], v[84:99]
    v_mfma_f32_32x32x16_bf16 v[100:115], a[224:227], v[208:211], v[100:115]
    s_waitcnt vmcnt(5)
    v_mfma_f32_32x32x16_bf16 v[84:99], v[44:47], v[184:187], v[84:99]
    v_mfma_f32_32x32x16_bf16 v[100:115], a[232:235], v[204:207], v[100:115]
    s_waitcnt vmcnt(4)
    v_mfma_f32_32x32x16_bf16 v[84:99], v[52:55], v[136:139], v[84:99]
    v_mfma_f32_32x32x16_bf16 v[100:115], a[240:243], v[200:203], v[100:115]
    s_waitcnt vmcnt(0)
    ds_read_b64_tr_b16 v[116:117], v26 offset:0
    ds_read_b64_tr_b16 v[118:119], v26 offset:256
    v_mfma_f32_32x32x16_bf16 v[84:99], v[60:63], v[140:143], v[84:99]
    v_mfma_f32_32x32x16_bf16 v[100:115], a[248:251], v[196:199], v[100:115]
    v_mfma_f32_32x32x16_bf16 v[84:99], v[68:71], v[144:147], v[84:99]
    v_mfma_f32_32x32x16_bf16 v[100:115], v[32:35], v[192:195], v[100:115]
    s_waitcnt lgkmcnt(0)
    ds_write_b128 v27, v[116:119]
    v_mfma_f32_32x32x16_bf16 v[84:99], v[76:79], v[148:151], v[84:99]
    v_mfma_f32_32x32x16_bf16 v[100:115], v[40:43], v[188:191], v[100:115]
    v_mfma_f32_32x32x16_bf16 v[100:115], v[48:51], v[184:187], v[100:115]
    v_mfma_f32_32x32x16_bf16 v[100:115], v[56:59], v[136:139], v[100:115]
    s_nop 8
    ds_write_b128 v14, v[84:87] offset:0
    v_mfma_f32_32x32x16_bf16 v[100:115], v[64:67], v[140:143], v[100:115]
    ds_write_b128 v14, v[88:91] offset:32
    v_mfma_f32_32x32x16_bf16 v[100:115], v[72:75], v[144:147], v[100:115]
    ds_write_b128 v14, v[92:95] offset:64
    v_mfma_f32_32x32x16_bf16 v[100:115], v[80:83], v[148:151], v[100:115]
    ds_write_b128 v14, v[96:99] offset:96
    s_nop 10
    ds_write_b128 v14, v[100:103] offset:128
    ds_write_b128 v14, v[104:107] offset:160
    ds_write_b128 v14, v[108:111] offset:192
    ds_write_b128 v14, v[112:115] offset:224
    s_waitcnt lgkmcnt(0)
    s_barrier
    ds_read_b128 v[84:87], v15 offset:0
    ds_read_b128 v[88:91], v15 offset:16
    ds_read_b128 v[92:95], v15 offset:8704
    ds_read_b128 v[96:99], v15 offset:8720
    ds_read_b128 v[100:103], v15 offset:17408
    ds_read_b128 v[104:107], v15 offset:17424
    ds_read_b128 v[108:111], v15 offset:26112
    ds_read_b128 v[112:115], v15 offset:26128
    ds_read_b128 v[132:135], v25
    s_waitcnt lgkmcnt(5)
    v_pk_add_f32 v[84:85], v[84:85], v[92:93]
    v_pk_add_f32 v[86:87], v[86:87], v[94:95]
    v_pk_add_f32 v[88:89], v[88:89], v[96:97]
    v_pk_add_f32 v[90:91], v[90:91], v[98:99]
    s_waitcnt lgkmcnt(0)
    v_pk_add_f32 v[100:101], v[100:101], v[108:109]
    v_pk_add_f32 v[102:103], v[102:103], v[110:111]
    v_pk_add_f32 v[104:105], v[104:105], v[112:113]
    v_pk_add_f32 v[106:107], v[106:107], v[114:115]
    v_lshlrev_b32 v124, 16, v132
    v_and_b32 v125, 0xffff0000, v132
    v_lshlrev_b32 v126, 16, v133
    v_and_b32 v127, 0xffff0000, v133
    v_lshlrev_b32 v128, 16, v134
    v_and_b32 v129, 0xffff0000, v134
    v_lshlrev_b32 v130, 16, v135
    v_and_b32 v131, 0xffff0000, v135
    v_pk_add_f32 v[84:85], v[84:85], v[100:101]
    v_pk_add_f32 v[86:87], v[86:87], v[102:103]
    v_pk_add_f32 v[88:89], v[88:89], v[104:105]
    v_pk_add_f32 v[90:91], v[90:91], v[106:107]
    v_pk_add_f32 v[84:85], v[84:85], v[124:125]
    v_pk_add_f32 v[86:87], v[86:87], v[126:127]
    v_pk_add_f32 v[88:89], v[88:89], v[128:129]
    v_pk_add_f32 v[90:91], v[90:91], v[130:131]
    v_cvt_pk_bf16_f32 v120, v84, v85
    v_cvt_pk_bf16_f32 v121, v86, v87
    v_cvt_pk_bf16_f32 v122, v88, v89
    v_cvt_pk_bf16_f32 v123, v90, v91
    buffer_store_dwordx4 v[120:123], v24, s[8:11], s43 offen
mk_end:
    s_endpgm
mk_idle0:
    v_add_u32 v24, s41, v28
    v_add_u32 v25, s41, v29
    v_lshlrev_b32 v26, 2, v0
    v_lshlrev_b32 v27, 2, v1
    s_mul_i32 s42, s20, 1536
    s_add_u32 s42, s42, 15859712
    s_add_u32 s42, s42, s44
    buffer_load_dwordx4 v2, s[4:7], s35 offen offset:3072 sc1 lds
    s_add_u32 s35, s35, 16384
    s_add_u32 m0, s41, 81920
    s_nop 0
    buffer_load_dwordx4 v2, s[4:7], s35 offen offset:0 sc1 lds
    buffer_load_dwordx4 v2, s[4:7], s35 offen offset:1024 sc1 lds
    buffer_load_dwordx4 v2, s[4:7], s35 offen offset:2048 sc1 lds
    buffer_load_dwordx4 v2, s[4:7], s35 offen offset:3072 sc1 lds
    s_add_u32 s35, s35, 16384
    s_waitcnt vmcnt(13)
    ds_read_b64_tr_b16 v[84:85], v24 offset:0
    ds_read_b64_tr_b16 v[86:87], v24 offset:256
    ds_read_b64_tr_b16 v[88:89], v24 offset:1024
    ds_read_b64_tr_b16 v[90:91], v24 offset:1280
    ds_read_b64_tr_b16 v[92:93], v24 offset:2048
    ds_read_b64_tr_b16 v[94:95], v24 offset:2304
    ds_read_b64_tr_b16 v[96:97], v24 offset:3072
    ds_read_b64_tr_b16 v[98:99], v24 offset:3328
    s_waitcnt vmcnt(9)
    ds_read_b64_tr_b16 v[100:101], v24 offset:16384
    ds_read_b64_tr_b16 v[102:103], v24 offset:16640
    ds_read_b64_tr_b16 v[104:105], v24 offset:17408
    ds_read_b64_tr_b16 v[106:107], v24 offset:17664
    ds_read_b64_tr_b16 v[108:109], v24 offset:18432
    ds_read_b64_tr_b16 v[110:111], v24 offset:18688
    ds_read_b64_tr_b16 v[112:113], v24 offset:19456
    ds_read_b64_tr_b16 v[114:115], v24 offset:19712
    v_mov_b32 v164, 0
    v_mov_b32 v165, 0
    v_mov_b32 v166, 0
    v_mov_b32 v167, 0
    s_waitcnt lgkmcnt(14)
    v_dot2c_f32_bf16 v164, s24, v84
    v_dot2c_f32_bf16 v166, v84, v84
    v_dot2c_f32_bf16 v165, s24, v85
    v_dot2c_f32_bf16 v167, v85, v85
    v_dot2c_f32_bf16 v164, s24, v86
    v_dot2c_f32_bf16 v166, v86, v86
    v_dot2c_f32_bf16 v165, s24, v87
    v_dot2c_f32_bf16 v167, v87, v87
    s_waitcnt lgkmcnt(12)
    v_dot2c_f32_bf16 v164, s24, v88
    v_dot2c_f32_bf16 v166, v88, v88
    v_dot2c_f32_bf16 v165, s24, v89
    v_dot2c_f32_bf16 v167, v89, v89
    v_dot2c_f32_bf16 v164, s24, v90
    v_dot2c_f32_bf16 v166, v90, v90
    v_dot2c_f32_bf16 v165, s24, v91
    v_dot2c_f32_bf16 v167, v91, v91
    s_waitcnt lgkmcnt(10)
    v_dot2c_f32_bf16 v164, s24, v92
    v_dot2c_f32_bf16 v166, v92, v92
    v_dot2c_f32_bf16 v165, s24, v93
    v_dot2c_f32_bf16 v167, v93, v93
    v_dot2c_f32_bf16 v164, s24, v94
    v_dot2c_f32_bf16 v166, v94, v94
    v_dot2c_f32_bf16 v165, s24, v95
    v_dot2c_f32_bf16 v167, v95, v95
    s_waitcnt lgkmcnt(8)
    v_dot2c_f32_bf16 v164, s24, v96
    v_dot2c_f32_bf16 v166, v96, v96
    v_dot2c_f32_bf16 v165, s24, v97
    v_dot2c_f32_bf16 v167, v97, v97
    v_dot2c_f32_bf16 v164, s24, v98
    v_dot2c_f32_bf16 v166, v98, v98
    v_dot2c_f32_bf16 v165, s24, v99
    v_dot2c_f32_bf16 v167, v99, v99
    s_waitcnt lgkmcnt(6)
    v_dot2c_f32_bf16 v164, s24, v100
    v_dot2c_f32_bf16 v166, v100, v100
    v_dot2c_f32_bf16 v165, s24, v101
    v_dot2c_f32_bf16 v167, v101, v101
    v_dot2c_f32_bf16 v164, s24, v102
    v_dot2c_f32_bf16 v166, v102, v102
    v_dot2c_f32_bf16 v165, s24, v103
    v_dot2c_f32_bf16 v167, v103, v103
    s_waitcnt lgkmcnt(4)
    v_dot2c_f32_bf16 v164, s24, v104
    v_dot2c_f32_bf16 v166, v104, v104
    v_dot2c_f32_bf16 v165, s24, v105
    v_dot2c_f32_bf16 v167, v105, v105
    v_dot2c_f32_bf16 v164, s24, v106
    v_dot2c_f32_bf16 v166, v106, v106
    v_dot2c_f32_bf16 v165, s24, v107
    v_dot2c_f32_bf16 v167, v107, v107
    s_waitcnt lgkmcnt(2)
    v_dot2c_f32_bf16 v164, s24, v108
    v_dot2c_f32_bf16 v166, v108, v108
    v_dot2c_f32_bf16 v165, s24, v109
    v_dot2c_f32_bf16 v167, v109, v109
    v_dot2c_f32_bf16 v164, s24, v110
    v_dot2c_f32_bf16 v166, v110, v110
    v_dot2c_f32_bf16 v165, s24, v111
    v_dot2c_f32_bf16 v167, v111, v111
    s_waitcnt lgkmcnt(0)
    v_dot2c_f32_bf16 v164, s24, v112
    v_dot2c_f32_bf16 v166, v112, v112
    v_dot2c_f32_bf16 v165, s24, v113
    v_dot2c_f32_bf16 v167, v113, v113
    v_dot2c_f32_bf16 v164, s24, v114
    v_dot2c_f32_bf16 v166, v114, v114
    v_dot2c_f32_bf16 v165, s24, v115
    v_dot2c_f32_bf16 v167, v115, v115
    s_nop 1
    v_add_f32 v164, v164, v165
    v_add_f32 v166, v166, v167
    s_nop 1
    v_permlane32_swap_b32 v164, v166
    v_add_f32 v164, v164, v166
    ds_write_b32 v26, v164 offset:17152
    s_add_u32 s37, s27, 16023552
    v_mov_b32 v20, 0
    buffer_atomic_add v20, v19, s[4:7], s37 offen sc0 sc1
    s_waitcnt lgkmcnt(0)
    s_barrier
    s_mov_b32 s39, 2146435072
    s_cmp_lg_u32 s3, 3
    s_cbranch_scc1 mk_fs70
    ds_read_b32 v168, v27 offset:17152
    ds_read_b32 v169, v27 offset:17408
    ds_read_b32 v170, v27 offset:17664
    ds_read_b32 v171, v27 offset:17920
    s_add_u32 s39, s42, 0
    s_waitcnt lgkmcnt(0)
    v_add_f32 v168, v168, v169
    v_add_f32 v170, v170, v171
    v_add_f32 v168, v168, v170
    v_mul_f32 v164, s16, v168
    v_mov_b32 v165, v164
    s_nop 1
    v_permlane32_swap_b32 v164, v165
    v_fma_f32 v165, -v164, v164, v165
    v_cvt_pk_bf16_f32 v175, v164, v164
    v_max_f32 v165, 0, v165
    v_add_f32 v174, s18, v165
    v_rsq_f32 v164, v174
    v_and_b32 v174, 0xffffff7f, v174
    v_mul_f32 v173, 0xc0135761, v164
    v_mul_f32 v172, v164, v164
    v_mul_f32 v165, 0xbdd2d3e8, v164
    v_and_b32 v173, 0xffffff7f, v173
    v_mul_f32 v172, v172, v165
    v_and_b32 v172, 0xffffff7f, v172
    v_or_b32 v172, 1, v172
mk_fs70:
    s_mov_b32 exec_hi, 0
    buffer_store_dwordx4 v[172:175], v2, s[4:7], s39 offen offset:512 sc1
    s_mov_b32 exec_hi, -1
    s_waitcnt vmcnt(6)
    ds_read_b64_tr_b16 v[132:133], v24 offset:32768
    ds_read_b64_tr_b16 v[134:135], v24 offset:33024
    ds_read_b64_tr_b16 v[136:137], v24 offset:33792
    ds_read_b64_tr_b16 v[138:139], v24 offset:34048
    ds_read_b64_tr_b16 v[140:141], v24 offset:34816
    ds_read_b64_tr_b16 v[142:143], v24 offset:35072
    ds_read_b64_tr_b16 v[144:145], v24 offset:35840
    ds_read_b64_tr_b16 v[146:147], v24 offset:36096
    s_waitcnt vmcnt(2)
    ds_read_b64_tr_b16 v[148:149], v24 offset:49152
    ds_read_b64_tr_b16 v[150:151], v24 offset:49408
    ds_read_b64_tr_b16 v[152:153], v24 offset:50176
    ds_read_b64_tr_b16 v[154:155], v24 offset:50432
    ds_read_b64_tr_b16 v[156:157], v24 offset:51200
    ds_read_b64_tr_b16 v[158:159], v24 offset:51456
    ds_read_b64_tr_b16 v[160:161], v24 offset:52224
    ds_read_b64_tr_b16 v[162:163], v24 offset:52480
    v_mov_b32 v164, 0
    v_mov_b32 v165, 0
    v_mov_b32 v166, 0
    v_mov_b32 v167, 0
    s_waitcnt lgkmcnt(14)
    v_dot2c_f32_bf16 v164, s24, v132
    v_dot2c_f32_bf16 v166, v132, v132
    v_dot2c_f32_bf16 v165, s24, v133
    v_dot2c_f32_bf16 v167, v133, v133
    v_dot2c_f32_bf16 v164, s24, v134
    v_dot2c_f32_bf16 v166, v134, v134
    v_dot2c_f32_bf16 v165, s24, v135
    v_dot2c_f32_bf16 v167, v135, v135
    s_waitcnt lgkmcnt(12)
    v_dot2c_f32_bf16 v164, s24, v136
    v_dot2c_f32_bf16 v166, v136, v136
    v_dot2c_f32_bf16 v165, s24, v137
    v_dot2c_f32_bf16 v167, v137, v137
    v_dot2c_f32_bf16 v164, s24, v138
    v_dot2c_f32_bf16 v166, v138, v138
    v_dot2c_f32_bf16 v165, s24, v139
    v_dot2c_f32_bf16 v167, v139, v139
    s_waitcnt lgkmcnt(10)
    v_dot2c_f32_bf16 v164, s24, v140
    v_dot2c_f32_bf16 v166, v140, v140
    v_dot2c_f32_bf16 v165, s24, v141
    v_dot2c_f32_bf16 v167, v141, v141
    v_dot2c_f32_bf16 v164, s24, v142
    v_dot2c_f32_bf16 v166, v142, v142
    v_dot2c_f32_bf16 v165, s24, v143
    v_dot2c_f32_bf16 v167, v143, v143
    s_waitcnt lgkmcnt(8)
    v_dot2c_f32_bf16 v164, s24, v144
    v_dot2c_f32_bf16 v166, v144, v144
    v_dot2c_f32_bf16 v165, s24, v145
    v_dot2c_f32_bf16 v167, v145, v145
    v_dot2c_f32_bf16 v164, s24, v146
    v_dot2c_f32_bf16 v166, v146, v146
    v_dot2c_f32_bf16 v165, s24, v147
    v_dot2c_f32_bf16 v167, v147, v147
    s_waitcnt lgkmcnt(6)
    v_dot2c_f32_bf16 v164, s24, v148
    v_dot2c_f32_bf16 v166, v148, v148
    v_dot2c_f32_bf16 v165, s24, v149
    v_dot2c_f32_bf16 v167, v149, v149
    v_dot2c_f32_bf16 v164, s24, v150
    v_dot2c_f32_bf16 v166, v150, v150
    v_dot2c_f32_bf16 v165, s24, v151
    v_dot2c_f32_bf16 v167, v151, v151
    s_waitcnt lgkmcnt(4)
    v_dot2c_f32_bf16 v164, s24, v152
    v_dot2c_f32_bf16 v166, v152, v152
    v_dot2c_f32_bf16 v165, s24, v153
    v_dot2c_f32_bf16 v167, v153, v153
    v_dot2c_f32_bf16 v164, s24, v154
    v_dot2c_f32_bf16 v166, v154, v154
    v_dot2c_f32_bf16 v165, s24, v155
    v_dot2c_f32_bf16 v167, v155, v155
    s_waitcnt lgkmcnt(2)
    v_dot2c_f32_bf16 v164, s24, v156
    v_dot2c_f32_bf16 v166, v156, v156
    v_dot2c_f32_bf16 v165, s24, v157
    v_dot2c_f32_bf16 v167, v157, v157
    v_dot2c_f32_bf16 v164, s24, v158
    v_dot2c_f32_bf16 v166, v158, v158
    v_dot2c_f32_bf16 v165, s24, v159
    v_dot2c_f32_bf16 v167, v159, v159
    s_waitcnt lgkmcnt(0)
    v_dot2c_f32_bf16 v164, s24, v160
    v_dot2c_f32_bf16 v166, v160, v160
    v_dot2c_f32_bf16 v165, s24, v161
    v_dot2c_f32_bf16 v167, v161, v161
    v_dot2c_f32_bf16 v164, s24, v162
    v_dot2c_f32_bf16 v166, v162, v162
    v_dot2c_f32_bf16 v165, s24, v163
    v_dot2c_f32_bf16 v167, v163, v163
    s_nop 1
    v_add_f32 v164, v164, v165
    v_add_f32 v166, v166, v167
    s_nop 1
    v_permlane32_swap_b32 v164, v166
    v_add_f32 v164, v164, v166
    ds_write_b32 v26, v164 offset:18176
    s_waitcnt lgkmcnt(0)
    s_barrier
    s_mov_b32 s39, 2146435072
    s_cmp_lg_u32 s3, 2
    s_cbranch_scc1 mk_fs71
    ds_read_b32 v168, v27 offset:18176
    ds_read_b32 v169, v27 offset:18432
    ds_read_b32 v170, v27 offset:18688
    ds_read_b32 v171, v27 offset:18944
    s_add_u32 s39, s42, 0
    s_waitcnt lgkmcnt(0)
    v_add_f32 v168, v168, v169
    v_add_f32 v170, v170, v171
    v_add_f32 v168, v168, v170
    v_mul_f32 v164, s16, v168
    v_mov_b32 v165, v164
    s_nop 1
    v_permlane32_swap_b32 v164, v165
    v_fma_f32 v165, -v164, v164, v165
    v_cvt_pk_bf16_f32 v175, v164, v164
    v_max_f32 v165, 0, v165
    v_add_f32 v174, s18, v165
    v_rsq_f32 v164, v174
    v_and_b32 v174, 0xffffff7f, v174
    v_mul_f32 v173, 0xc0135761, v164
    v_mul_f32 v172, v164, v164
    v_mul_f32 v165, 0xbdd2d3e8, v164
    v_and_b32 v173, 0xffffff7f, v173
    v_mul_f32 v172, v172, v165
    v_and_b32 v172, 0xffffff7f, v172
    v_or_b32 v172, 1, v172
mk_fs71:
    s_mov_b32 exec_hi, 0
    buffer_store_dwordx4 v[172:175], v2, s[4:7], s39 offen offset:1024 sc1
    s_mov_b32 exec_hi, -1
    s_waitcnt vmcnt(2)
    v_cmp_gt_u32 vcc, 16, v20
    s_nop 0
    s_and_b64 vcc, vcc, s[54:55]
    s_cbranch_scc1 mk_ps72
mk_po73:
    s_barrier
    s_mul_i32 s35, s20, 98304
    s_add_u32 s35, s35, s41
    s_add_u32 s35, s35, 5242880
    s_add_u32 s35, s35, s44
    s_sub_u32 s35, s35, 32768
    s_add_u32 m0, s41, 131072
    s_nop 0
    buffer_load_dwordx4 v2, s[4:7], s35 offen offset:0 sc1 lds
    buffer_load_dwordx4 v2, s[4:7], s35 offen offset:1024 sc1 lds
    buffer_load_dwordx4 v2, s[4:7], s35 offen offset:2048 sc1 lds
    buffer_load_dwordx4 v2, s[4:7], s35 offen offset:3072 sc1 lds
    s_add_u32 s35, s35, 16384
    s_add_u32 m0, s41, 147456
    s_nop 0
    buffer_load_dwordx4 v2, s[4:7], s35 offen offset:0 sc1 lds
    buffer_load_dwordx4 v2, s[4:7], s35 offen offset:1024 sc1 lds
    buffer_load_dwordx4 v2, s[4:7], s35 offen offset:2048 sc1 lds
    buffer_load_dwordx4 v2, s[4:7], s35 offen offset:3072 sc1 lds
    s_add_u32 s35, s35, 16384
    s_add_u32 m0, s41, 32768
    s_nop 0
    buffer_load_dwordx4 v2, s[4:7], s35 offen offset:0 sc1 lds
    buffer_load_dwordx4 v2, s[4:7], s35 offen offset:1024 sc1 lds
    buffer_load_dwordx4 v2, s[4:7], s35 offen offset:2048 sc1 lds
    buffer_load_dwordx4 v2, s[4:7], s35 offen offset:3072 sc1 lds
    s_add_u32 s35, s35, 16384
    s_add_u32 m0, s41, 49152
    s_nop 0
    buffer_load_dwordx4 v2, s[4:7], s35 offen offset:0 sc1 lds
    buffer_load_dwordx4 v2, s[4:7], s35 offen offset:1024 sc1 lds
    buffer_load_dwordx4 v2, s[4:7], s35 offen offset:2048 sc1 lds
    buffer_load_dwordx4 v2, s[4:7], s35 offen offset:3072 sc1 lds
    s_add_u32 s35, s35, 16384
    s_waitcnt vmcnt(12)
    ds_read_b64_tr_b16 v[84:85], v25 offset:32768
    ds_read_b64_tr_b16 v[86:87], v25 offset:33024
    ds_read_b64_tr_b16 v[88:89], v25 offset:33792
    ds_read_b64_tr_b16 v[90:91], v25 offset:34048
    ds_read_b64_tr_b16 v[92:93], v25 offset:34816
    ds_read_b64_tr_b16 v[94:95], v25 offset:35072
    ds_read_b64_tr_b16 v[96:97], v25 offset:35840
    ds_read_b64_tr_b16 v[98:99], v25 offset:36096
    s_waitcnt vmcnt(8)
    ds_read_b64_tr_b16 v[100:101], v25 offset:49152
    ds_read_b64_tr_b16 v[102:103], v25 offset:49408
    ds_read_b64_tr_b16 v[104:105], v25 offset:50176
    ds_read_b64_tr_b16 v[106:107], v25 offset:50432
    ds_read_b64_tr_b16 v[108:109], v25 offset:51200
    ds_read_b64_tr_b16 v[110:111], v25 offset:51456
    ds_read_b64_tr_b16 v[112:113], v25 offset:52224
    ds_read_b64_tr_b16 v[114:115], v25 offset:52480
    v_mov_b32 v164, 0
    v_mov_b32 v165, 0
    v_mov_b32 v166, 0
    v_mov_b32 v167, 0
    s_waitcnt lgkmcnt(14)
    v_dot2c_f32_bf16 v164, s24, v84
    v_dot2c_f32_bf16 v166, v84, v84
    v_dot2c_f32_bf16 v165, s24, v85
    v_dot2c_f32_bf16 v167, v85, v85
    v_dot2c_f32_bf16 v164, s24, v86
    v_dot2c_f32_bf16 v166, v86, v86
    v_dot2c_f32_bf16 v165, s24, v87
    v_dot2c_f32_bf16 v167, v87, v87
    s_cmp_eq_u32 s20, 10
    s_cselect_b32 s35, 2146435072, s35
    s_add_u32 m0, s41, 65536
    s_nop 0
    buffer_load_dwordx4 v2, s[4:7], s35 offen offset:0 sc1 lds
    s_waitcnt lgkmcnt(12)
    v_dot2c_f32_bf16 v164, s24, v88
    v_dot2c_f32_bf16 v166, v88, v88
    v_dot2c_f32_bf16 v165, s24, v89
    v_dot2c_f32_bf16 v167, v89, v89
    v_dot2c_f32_bf16 v164, s24, v90
    v_dot2c_f32_bf16 v166, v90, v90
    v_dot2c_f32_bf16 v165, s24, v91
    v_dot2c_f32_bf16 v167, v91, v91
    buffer_load_dwordx4 v2, s[4:7], s35 offen offset:1024 sc1 lds
    s_waitcnt lgkmcnt(10)
    v_dot2c_f32_bf16 v164, s24, v92
    v_dot2c_f32_bf16 v166, v92, v92
    v_dot2c_f32_bf16 v165, s24, v93
    v_dot2c_f32_bf16 v167, v93, v93
    v_dot2c_f32_bf16 v164, s24, v94
    v_dot2c_f32_bf16 v166, v94, v94
    v_dot2c_f32_bf16 v165, s24, v95
    v_dot2c_f32_bf16 v167, v95, v95
    buffer_load_dwordx4 v2, s[4:7], s35 offen offset:2048 sc1 lds
    s_waitcnt lgkmcnt(8)
    v_dot2c_f32_bf16 v164, s24, v96
    v_dot2c_f32_bf16 v166, v96, v96
    v_dot2c_f32_bf16 v165, s24, v97
    v_dot2c_f32_bf16 v167, v97, v97
    v_dot2c_f32_bf16 v164, s24, v98
    v_dot2c_f32_bf16 v166, v98, v98
    v_dot2c_f32_bf16 v165, s24, v99
    v_dot2c_f32_bf16 v167, v99, v99
    buffer_load_dwordx4 v2, s[4:7], s35 offen offset:3072 sc1 lds
    s_add_u32 s35, s35, 16384
    s_waitcnt lgkmcnt(6)
    v_dot2c_f32_bf16 v164, s24, v100
    v_dot2c_f32_bf16 v166, v100, v100
    v_dot2c_f32_bf16 v165, s24, v101
    v_dot2c_f32_bf16 v167, v101, v101
    v_dot2c_f32_bf16 v164, s24, v102
    v_dot2c_f32_bf16 v166, v102, v102
    v_dot2c_f32_bf16 v165, s24, v103
    v_dot2c_f32_bf16 v167, v103, v103
    s_add_u32 m0, s41, 81920
    s_nop 0
    buffer_load_dwordx4 v2, s[4:7], s35 offen offset:0 sc1 lds
    s_waitcnt lgkmcnt(4)
    v_dot2c_f32_bf16 v164, s24, v104
    v_dot2c_f32_bf16 v166, v104, v104
    v_dot2c_f32_bf16 v165, s24, v105
    v_dot2c_f32_bf16 v167, v105, v105
    v_dot2c_f32_bf16 v164, s24, v106
    v_dot2c_f32_bf16 v166, v106, v106
    v_dot2c_f32_bf16 v165, s24, v107
    v_dot2c_f32_bf16 v167, v107, v107
    buffer_load_dwordx4 v2, s[4:7], s35 offen offset:1024 sc1 lds
    s_waitcnt lgkmcnt(2)
    v_dot2c_f32_bf16 v164, s24, v108
    v_dot2c_f32_bf16 v166, v108, v108
    v_dot2c_f32_bf16 v165, s24, v109
    v_dot2c_f32_bf16 v167, v109, v109
    v_dot2c_f32_bf16 v164, s24, v110
    v_dot2c_f32_bf16 v166, v110, v110
    v_dot2c_f32_bf16 v165, s24, v111
    v_dot2c_f32_bf16 v167, v111, v111
    buffer_load_dwordx4 v2, s[4:7], s35 offen offset:2048 sc1 lds
    s_waitcnt lgkmcnt(0)
    v_dot2c_f32_bf16 v164, s24, v112
    v_dot2c_f32_bf16 v166, v112, v112
    v_dot2c_f32_bf16 v165, s24, v113
    v_dot2c_f32_bf16 v167, v113, v113
    v_dot2c_f32_bf16 v164, s24, v114
    v_dot2c_f32_bf16 v166, v114, v114
    v_dot2c_f32_bf16 v165, s24, v115
    v_dot2c_f32_bf16 v167, v115, v115
    buffer_load_dwordx4 v2, s[4:7], s35 offen offset:3072 sc1 lds
    s_add_u32 s35, s35, 16384
    v_add_f32 v164, v164, v165
    v_add_f32 v166, v166, v167
    s_nop 1
    v_permlane32_swap_b32 v164, v166
    v_add_f32 v164, v164, v166
    ds_write_b32 v26, v164 offset:20224
    s_waitcnt lgkmcnt(0)
    s_barrier
    s_mov_b32 s39, 2146435072
    s_cmp_lg_u32 s3, 0
    s_cbranch_scc1 mk_fs75
    ds_read_b32 v168, v27 offset:20224
    ds_read_b32 v169, v27 offset:20480
    ds_read_b32 v170, v27 offset:20736
    ds_read_b32 v171, v27 offset:20992
    s_add_u32 s39, s42, 16896
    s_waitcnt lgkmcnt(0)
    v_add_f32 v168, v168, v169
    v_add_f32 v170, v170, v171
    v_add_f32 v168, v168, v170
    v_mul_f32 v164, s16, v168
    v_mov_b32 v165, v164
    s_nop 1
    v_permlane32_swap_b32 v164, v165
    v_fma_f32 v165, -v164, v164, v165
    v_cvt_pk_bf16_f32 v175, v164, v164
    v_max_f32 v165, 0, v165
    v_add_f32 v174, s18, v165
    v_rsq_f32 v164, v174
    v_and_b32 v174, 0xffffff7f, v174
    v_mul_f32 v173, 0xc0135761, v164
    v_mul_f32 v172, v164, v164
    v_mul_f32 v165, 0xbdd2d3e8, v164
    v_and_b32 v173, 0xffffff7f, v173
    v_mul_f32 v172, v172, v165
    v_and_b32 v172, 0xffffff7f, v172
    v_or_b32 v172, 1, v172
mk_fs75:
    s_mov_b32 exec_hi, 0
    buffer_store_dwordx4 v[172:175], v2, s[4:7], s39 offen offset:0 sc1
    s_mov_b32 exec_hi, -1
    s_waitcnt vmcnt(13)
    ds_read_b64_tr_b16 v[132:133], v24 offset:0
    ds_read_b64_tr_b16 v[134:135], v24 offset:256
    ds_read_b64_tr_b16 v[136:137], v24 offset:1024
    ds_read_b64_tr_b16 v[138:139], v24 offset:1280
    ds_read_b64_tr_b16 v[140:141], v24 offset:2048
    ds_read_b64_tr_b16 v[142:143], v24 offset:2304
    ds_read_b64_tr_b16 v[144:145], v24 offset:3072
    ds_read_b64_tr_b16 v[146:147], v24 offset:3328
    s_waitcnt vmcnt(9)
    ds_read_b64_tr_b16 v[148:149], v24 offset:16384
    ds_read_b64_tr_b16 v[150:151], v24 offset:16640
    ds_read_b64_tr_b16 v[152:153], v24 offset:17408
    ds_read_b64_tr_b16 v[154:155], v24 offset:17664
    ds_read_b64_tr_b16 v[156:157], v24 offset:18432
    ds_read_b64_tr_b16 v[158:159], v24 offset:18688
    ds_read_b64_tr_b16 v[160:161], v24 offset:19456
    ds_read_b64_tr_b16 v[162:163], v24 offset:19712
    v_mov_b32 v164, 0
    v_mov_b32 v165, 0
    v_mov_b32 v166, 0
    v_mov_b32 v167, 0
    s_waitcnt lgkmcnt(14)
    v_dot2c_f32_bf16 v164, s24, v132
    v_dot2c_f32_bf16 v166, v132, v132
    v_dot2c_f32_bf16 v165, s24, v133
    v_dot2c_f32_bf16 v167, v133, v133
    v_dot2c_f32_bf16 v164, s24, v134
    v_dot2c_f32_bf16 v166, v134, v134
    v_dot2c_f32_bf16 v165, s24, v135
    v_dot2c_f32_bf16 v167, v135, v135
    s_waitcnt lgkmcnt(12)
    v_dot2c_f32_bf16 v164, s24, v136
    v_dot2c_f32_bf16 v166, v136, v136
    v_dot2c_f32_bf16 v165, s24, v137
    v_dot2c_f32_bf16 v167, v137, v137
    v_dot2c_f32_bf16 v164, s24, v138
    v_dot2c_f32_bf16 v166, v138, v138
    v_dot2c_f32_bf16 v165, s24, v139
    v_dot2c_f32_bf16 v167, v139, v139
    s_waitcnt lgkmcnt(10)
    v_dot2c_f32_bf16 v164, s24, v140
    v_dot2c_f32_bf16 v166, v140, v140
    v_dot2c_f32_bf16 v165, s24, v141
    v_dot2c_f32_bf16 v167, v141, v141
    v_dot2c_f32_bf16 v164, s24, v142
    v_dot2c_f32_bf16 v166, v142, v142
    v_dot2c_f32_bf16 v165, s24, v143
    v_dot2c_f32_bf16 v167, v143, v143
    s_waitcnt lgkmcnt(8)
    v_dot2c_f32_bf16 v164, s24, v144
    v_dot2c_f32_bf16 v166, v144, v144
    v_dot2c_f32_bf16 v165, s24, v145
    v_dot2c_f32_bf16 v167, v145, v145
    v_dot2c_f32_bf16 v164, s24, v146
    v_dot2c_f32_bf16 v166, v146, v146
    v_dot2c_f32_bf16 v165, s24, v147
    v_dot2c_f32_bf16 v167, v147, v147
    s_waitcnt lgkmcnt(6)
    v_dot2c_f32_bf16 v164, s24, v148
    v_dot2c_f32_bf16 v166, v148, v148
    v_dot2c_f32_bf16 v165, s24, v149
    v_dot2c_f32_bf16 v167, v149, v149
    v_dot2c_f32_bf16 v164, s24, v150
    v_dot2c_f32_bf16 v166, v150, v150
    v_dot2c_f32_bf16 v165, s24, v151
    v_dot2c_f32_bf16 v167, v151, v151
    s_waitcnt lgkmcnt(4)
    v_dot2c_f32_bf16 v164, s24, v152
    v_dot2c_f32_bf16 v166, v152, v152
    v_dot2c_f32_bf16 v165, s24, v153
    v_dot2c_f32_bf16 v167, v153, v153
    v_dot2c_f32_bf16 v164, s24, v154
    v_dot2c_f32_bf16 v166, v154, v154
    v_dot2c_f32_bf16 v165, s24, v155
    v_dot2c_f32_bf16 v167, v155, v155
    s_waitcnt lgkmcnt(2)
    v_dot2c_f32_bf16 v164, s24, v156
    v_dot2c_f32_bf16 v166, v156, v156
    v_dot2c_f32_bf16 v165, s24, v157
    v_dot2c_f32_bf16 v167, v157, v157
    v_dot2c_f32_bf16 v164, s24, v158
    v_dot2c_f32_bf16 v166, v158, v158
    v_dot2c_f32_bf16 v165, s24, v159
    v_dot2c_f32_bf16 v167, v159, v159
    s_waitcnt lgkmcnt(0)
    v_dot2c_f32_bf16 v164, s24, v160
    v_dot2c_f32_bf16 v166, v160, v160
    v_dot2c_f32_bf16 v165, s24, v161
    v_dot2c_f32_bf16 v167, v161, v161
    v_dot2c_f32_bf16 v164, s24, v162
    v_dot2c_f32_bf16 v166, v162, v162
    v_dot2c_f32_bf16 v165, s24, v163
    v_dot2c_f32_bf16 v167, v163, v163
    s_nop 1
    v_add_f32 v164, v164, v165
    v_add_f32 v166, v166, v167
    s_nop 1
    v_permlane32_swap_b32 v164, v166
    v_add_f32 v164, v164, v166
    ds_write_b32 v26, v164 offset:17152
    s_waitcnt vmcnt(5)
    ds_read_b64_tr_b16 v[84:85], v24 offset:32768
    ds_read_b64_tr_b16 v[86:87], v24 offset:33024
    ds_read_b64_tr_b16 v[88:89], v24 offset:33792
    ds_read_b64_tr_b16 v[90:91], v24 offset:34048
    ds_read_b64_tr_b16 v[92:93], v24 offset:34816
    ds_read_b64_tr_b16 v[94:95], v24 offset:35072
    ds_read_b64_tr_b16 v[96:97], v24 offset:35840
    ds_read_b64_tr_b16 v[98:99], v24 offset:36096
    s_waitcnt vmcnt(1)
    ds_read_b64_tr_b16 v[100:101], v24 offset:49152
    ds_read_b64_tr_b16 v[102:103], v24 offset:49408
    ds_read_b64_tr_b16 v[104:105], v24 offset:50176
    ds_read_b64_tr_b16 v[106:107], v24 offset:50432
    ds_read_b64_tr_b16 v[108:109], v24 offset:51200
    ds_read_b64_tr_b16 v[110:111], v24 offset:51456
    ds_read_b64_tr_b16 v[112:113], v24 offset:52224
    ds_read_b64_tr_b16 v[114:115], v24 offset:52480
    s_waitcnt lgkmcnt(15)
    s_barrier
    s_mov_b32 s39, 2146435072
    s_cmp_lg_u32 s3, 3
    s_cbranch_scc1 mk_fs76
    ds_read_b32 v168, v27 offset:17152
    ds_read_b32 v169, v27 offset:17408
    ds_read_b32 v170, v27 offset:17664
    ds_read_b32 v171, v27 offset:17920
    s_add_u32 s39, s42, 16896
    s_waitcnt lgkmcnt(0)
    v_add_f32 v168, v168, v169
    v_add_f32 v170, v170, v171
    v_add_f32 v168, v168, v170
    v_mul_f32 v164, s16, v168
    v_mov_b32 v165, v164
    s_nop 1
    v_permlane32_swap_b32 v164, v165
    v_fma_f32 v165, -v164, v164, v165
    v_cvt_pk_bf16_f32 v175, v164, v164
    v_max_f32 v165, 0, v165
    v_add_f32 v174, s18, v165
    v_rsq_f32 v164, v174
    v_and_b32 v174, 0xffffff7f, v174
    v_mul_f32 v173, 0xc0135761, v164
    v_mul_f32 v172, v164, v164
    v_mul_f32 v165, 0xbdd2d3e8, v164
    v_and_b32 v173, 0xffffff7f, v173
    v_mul_f32 v172, v172, v165
    v_and_b32 v172, 0xffffff7f, v172
    v_or_b32 v172, 1, v172
mk_fs76:
    s_mov_b32 exec_hi, 0
    buffer_store_dwordx4 v[172:175], v2, s[4:7], s39 offen offset:512 sc1
    s_mov_b32 exec_hi, -1
    v_mov_b32 v164, 0
    v_mov_b32 v165, 0
    v_mov_b32 v166, 0
    v_mov_b32 v167, 0
    s_waitcnt lgkmcnt(14)
    v_dot2c_f32_bf16 v164, s24, v84
    v_dot2c_f32_bf16 v166, v84, v84
    v_dot2c_f32_bf16 v165, s24, v85
    v_dot2c_f32_bf16 v167, v85, v85
    v_dot2c_f32_bf16 v164, s24, v86
    v_dot2c_f32_bf16 v166, v86, v86
    v_dot2c_f32_bf16 v165, s24, v87
    v_dot2c_f32_bf16 v167, v87, v87
    s_waitcnt lgkmcnt(12)
    v_dot2c_f32_bf16 v164, s24, v88
    v_dot2c_f32_bf16 v166, v88, v88
    v_dot2c_f32_bf16 v165, s24, v89
    v_dot2c_f32_bf16 v167, v89, v89
    v_dot2c_f32_bf16 v164, s24, v90
    v_dot2c_f32_bf16 v166, v90, v90
    v_dot2c_f32_bf16 v165, s24, v91
    v_dot2c_f32_bf16 v167, v91, v91
    s_waitcnt lgkmcnt(10)
    v_dot2c_f32_bf16 v164, s24, v92
    v_dot2c_f32_bf16 v166, v92, v92
    v_dot2c_f32_bf16 v165, s24, v93
    v_dot2c_f32_bf16 v167, v93, v93
    v_dot2c_f32_bf16 v164, s24, v94
    v_dot2c_f32_bf16 v166, v94, v94
    v_dot2c_f32_bf16 v165, s24, v95
    v_dot2c_f32_bf16 v167, v95, v95
    s_waitcnt lgkmcnt(8)
    v_dot2c_f32_bf16 v164, s24, v96
    v_dot2c_f32_bf16 v166, v96, v96
    v_dot2c_f32_bf16 v165, s24, v97
    v_dot2c_f32_bf16 v167, v97, v97
    v_dot2c_f32_bf16 v164, s24, v98
    v_dot2c_f32_bf16 v166, v98, v98
    v_dot2c_f32_bf16 v165, s24, v99
    v_dot2c_f32_bf16 v167, v99, v99
    s_waitcnt lgkmcnt(6)
    v_dot2c_f32_bf16 v164, s24, v100
    v_dot2c_f32_bf16 v166, v100, v100
    v_dot2c_f32_bf16 v165, s24, v101
    v_dot2c_f32_bf16 v167, v101, v101
    v_dot2c_f32_bf16 v164, s24, v102
    v_dot2c_f32_bf16 v166, v102, v102
    v_dot2c_f32_bf16 v165, s24, v103
    v_dot2c_f32_bf16 v167, v103, v103
    s_waitcnt lgkmcnt(4)
    v_dot2c_f32_bf16 v164, s24, v104
    v_dot2c_f32_bf16 v166, v104, v104
    v_dot2c_f32_bf16 v165, s24, v105
    v_dot2c_f32_bf16 v167, v105, v105
    v_dot2c_f32_bf16 v164, s24, v106
    v_dot2c_f32_bf16 v166, v106, v106
    v_dot2c_f32_bf16 v165, s24, v107
    v_dot2c_f32_bf16 v167, v107, v107
    s_waitcnt lgkmcnt(2)
    v_dot2c_f32_bf16 v164, s24, v108
    v_dot2c_f32_bf16 v166, v108, v108
    v_dot2c_f32_bf16 v165, s24, v109
    v_dot2c_f32_bf16 v167, v109, v109
    v_dot2c_f32_bf16 v164, s24, v110
    v_dot2c_f32_bf16 v166, v110, v110
    v_dot2c_f32_bf16 v165, s24, v111
    v_dot2c_f32_bf16 v167, v111, v111
    s_waitcnt lgkmcnt(0)
    v_dot2c_f32_bf16 v164, s24, v112
    v_dot2c_f32_bf16 v166, v112, v112
    v_dot2c_f32_bf16 v165, s24, v113
    v_dot2c_f32_bf16 v167, v113, v113
    v_dot2c_f32_bf16 v164, s24, v114
    v_dot2c_f32_bf16 v166, v114, v114
    v_dot2c_f32_bf16 v165, s24, v115
    v_dot2c_f32_bf16 v167, v115, v115
    s_nop 1
    v_add_f32 v164, v164, v165
    v_add_f32 v166, v166, v167
    s_nop 1
    v_permlane32_swap_b32 v164, v166
    v_add_f32 v164, v164, v166
    ds_write_b32 v26, v164 offset:18176
    s_waitcnt lgkmcnt(0)
    s_barrier
    s_mov_b32 s39, 2146435072
    s_cmp_lg_u32 s3, 2
    s_cbranch_scc1 mk_fs77
    ds_read_b32 v168, v27 offset:18176
    ds_read_b32 v169, v27 offset:18432
    ds_read_b32 v170, v27 offset:18688
    ds_read_b32 v171, v27 offset:18944
    s_add_u32 s39, s42, 16896
    s_waitcnt lgkmcnt(0)
    v_add_f32 v168, v168, v169
    v_add_f32 v170, v170, v171
    v_add_f32 v168, v168, v170
    v_mul_f32 v164, s16, v168
    v_mov_b32 v165, v164
    s_nop 1
    v_permlane32_swap_b32 v164, v165
    v_fma_f32 v165, -v164, v164, v165
    v_cvt_pk_bf16_f32 v175, v164, v164
    v_max_f32 v165, 0, v165
    v_add_f32 v174, s18, v165
    v_rsq_f32 v164, v174
    v_and_b32 v174, 0xffffff7f, v174
    v_mul_f32 v173, 0xc0135761, v164
    v_mul_f32 v172, v164, v164
    v_mul_f32 v165, 0xbdd2d3e8, v164
    v_and_b32 v173, 0xffffff7f, v173
    v_mul_f32 v172, v172, v165
    v_and_b32 v172, 0xffffff7f, v172
    v_or_b32 v172, 1, v172
mk_fs77:
    s_mov_b32 exec_hi, 0
    buffer_store_dwordx4 v[172:175], v2, s[4:7], s39 offen offset:1024 sc1
    s_mov_b32 exec_hi, -1
    s_mul_i32 s91, s23, 180224
    s_lshl_b32 s31, s3, 10
    s_add_u32 s91, s91, s31
    s_add_u32 s91, s91, 20971520
    s_add_u32 s92, s91, 90112
    s_mul_i32 s36, s23, 0
    s_add_u32 s36, s36, s91
    buffer_load_dwordx4 a[132:135], v2, s[4:7], s36 offen sc1
    buffer_load_dwordx4 a[136:139], v23, s[4:7], s36 offen sc1
    s_add_u32 s36, s36, 4096
    buffer_load_dwordx4 a[140:143], v2, s[4:7], s36 offen sc1
    buffer_load_dwordx4 a[144:147], v23, s[4:7], s36 offen sc1
    s_add_u32 s36, s36, 4096
    buffer_load_dwordx4 a[148:151], v2, s[4:7], s36 offen sc1
    buffer_load_dwordx4 a[152:155], v23, s[4:7], s36 offen sc1
    s_add_u32 s36, s36, 4096
    buffer_load_dwordx4 a[156:159], v2, s[4:7], s36 offen sc1
    buffer_load_dwordx4 a[160:163], v23, s[4:7], s36 offen sc1
    s_add_u32 s36, s36, 4096
    buffer_load_dwordx4 a[164:167], v2, s[4:7], s36 offen sc1
    buffer_load_dwordx4 a[168:171], v23, s[4:7], s36 offen sc1
    s_add_u32 s36, s36, 4096
    buffer_load_dwordx4 a[172:175], v2, s[4:7], s36 offen sc1
    buffer_load_dwordx4 a[176:179], v23, s[4:7], s36 offen sc1
    s_add_u32 s36, s36, 4096
    buffer_load_dwordx4 a[180:183], v2, s[4:7], s36 offen sc1
    buffer_load_dwordx4 a[184:187], v23, s[4:7], s36 offen sc1
    s_add_u32 s36, s36, 4096
    buffer_load_dwordx4 a[188:191], v2, s[4:7], s36 offen sc1
    buffer_load_dwordx4 a[192:195], v23, s[4:7], s36 offen sc1
    s_add_u32 s36, s36, 4096
    buffer_load_dwordx4 a[196:199], v2, s[4:7], s36 offen sc1
    buffer_load_dwordx4 a[200:203], v23, s[4:7], s36 offen sc1
    s_add_u32 s36, s36, 4096
    buffer_load_dwordx4 a[204:207], v2, s[4:7], s36 offen sc1
    buffer_load_dwordx4 a[208:211], v23, s[4:7], s36 offen sc1
    s_add_u32 s36, s36, 4096
    buffer_load_dwordx4 a[212:215], v2, s[4:7], s36 offen sc1
    buffer_load_dwordx4 a[216:219], v23, s[4:7], s36 offen sc1
    s_add_u32 s36, s36, 4096
    buffer_load_dwordx4 a[220:223], v2, s[4:7], s36 offen sc1
    buffer_load_dwordx4 a[224:227], v23, s[4:7], s36 offen sc1
    s_add_u32 s36, s36, 4096
    buffer_load_dwordx4 a[228:231], v2, s[4:7], s36 offen sc1
    buffer_load_dwordx4 a[232:235], v23, s[4:7], s36 offen sc1
    s_add_u32 s36, s36, 4096
    buffer_load_dwordx4 a[236:239], v2, s[4:7], s36 offen sc1
    buffer_load_dwordx4 a[240:243], v23, s[4:7], s36 offen sc1
    s_add_u32 s36, s36, 4096
    buffer_load_dwordx4 a[244:247], v2, s[4:7], s36 offen sc1
    buffer_load_dwordx4 a[248:251], v23, s[4:7], s36 offen sc1
    s_add_u32 s36, s36, 4096
    buffer_load_dwordx4 a[252:255], v2, s[4:7], s36 offen sc1
    buffer_load_dwordx4 v[32:35], v23, s[4:7], s36 offen sc1
    s_add_u32 s36, s36, 4096
    buffer_load_dwordx4 v[36:39], v2, s[4:7], s36 offen sc1
    buffer_load_dwordx4 v[40:43], v23, s[4:7], s36 offen sc1
    s_add_u32 s36, s36, 4096
    buffer_load_dwordx4 v[44:47], v2, s[4:7], s36 offen sc1
    buffer_load_dwordx4 v[48:51], v23, s[4:7], s36 offen sc1
    s_add_u32 s36, s36, 4096
    buffer_load_dwordx4 v[52:55], v2, s[4:7], s36 offen sc1
    buffer_load_dwordx4 v[56:59], v23, s[4:7], s36 offen sc1
    s_add_u32 s36, s36, 4096
    buffer_load_dwordx4 v[60:63], v2, s[4:7], s36 offen sc1
    buffer_load_dwordx4 v[64:67], v23, s[4:7], s36 offen sc1
    s_add_u32 s36, s36, 4096
    buffer_load_dwordx4 v[68:71], v2, s[4:7], s36 offen sc1
    buffer_load_dwordx4 v[72:75], v23, s[4:7], s36 offen sc1
    s_add_u32 s36, s36, 4096
    buffer_load_dwordx4 v[76:79], v2, s[4:7], s36 offen sc1
    buffer_load_dwordx4 v[80:83], v23, s[4:7], s36 offen sc1
    s_mul_i32 s93, s22, 90112
    s_lshl_b32 s33, s3, 10
    s_add_u32 s93, s93, s33
    s_add_u32 s93, s93, 25165824
    s_add_u32 s94, s93, 90112
    s_mul_i32 s40, s23, 0
    s_add_u32 s40, s40, s93
    s_add_u32 s37, s29, 16252928
    v_mov_b32 v20, 0
    buffer_atomic_add v20, v13, s[4:7], s37 offen sc0 sc1
    s_waitcnt vmcnt(0)
    v_cmp_gt_u32 vcc, 11, v20
    s_nop 0
    s_and_b64 vcc, vcc, s[52:53]
    s_cbranch_scc1 mk_ps78
mk_po79:
    s_barrier
    buffer_load_dwordx4 v[252:255], v2, s[4:7], s40 offen sc1
    s_add_u32 s40, s40, 4096
    buffer_load_dwordx4 v[248:251], v2, s[4:7], s40 offen sc1
    s_add_u32 s40, s40, 4096
    buffer_load_dwordx4 v[244:247], v2, s[4:7], s40 offen sc1
    s_add_u32 s40, s40, 4096
    buffer_load_dwordx4 v[240:243], v2, s[4:7], s40 offen sc1
    s_add_u32 s40, s40, 4096
    buffer_load_dwordx4 v[236:239], v2, s[4:7], s40 offen sc1
    s_add_u32 s40, s40, 4096
    buffer_load_dwordx4 v[232:235], v2, s[4:7], s40 offen sc1
    s_add_u32 s40, s40, 4096
    buffer_load_dwordx4 v[228:231], v2, s[4:7], s40 offen sc1
    s_add_u32 s40, s40, 4096
    buffer_load_dwordx4 v[224:227], v2, s[4:7], s40 offen sc1
    s_add_u32 s40, s40, 4096
    buffer_load_dwordx4 v[220:223], v2, s[4:7], s40 offen sc1
    s_add_u32 s40, s40, 4096
    buffer_load_dwordx4 v[216:219], v2, s[4:7], s40 offen sc1
    s_add_u32 s40, s40, 4096
    buffer_load_dwordx4 v[212:215], v2, s[4:7], s40 offen sc1
    s_add_u32 s40, s40, 4096
    buffer_load_dwordx4 v[208:211], v2, s[4:7], s40 offen sc1
    s_add_u32 s40, s40, 4096
    buffer_load_dwordx4 v[204:207], v2, s[4:7], s40 offen sc1
    s_add_u32 s40, s40, 4096
    buffer_load_dwordx4 v[200:203], v2, s[4:7], s40 offen sc1
    s_add_u32 s40, s40, 4096
    s_waitcnt vmcnt(0)
    s_branch mk_B0
mk_idle1:
    v_add_u32 v24, s41, v28
    v_add_u32 v25, s41, v29
    v_lshlrev_b32 v26, 2, v0
    v_lshlrev_b32 v27, 2, v1
    s_mul_i32 s42, s20, 1536
    s_add_u32 s42, s42, 15893504
    s_add_u32 s42, s42, s44
    buffer_load_dwordx4 v2, s[4:7], s35 offen offset:3072 sc1 lds
    s_add_u32 s35, s35, 16384
    s_add_u32 m0, s41, 81920
    s_nop 0
    buffer_load_dwordx4 v2, s[4:7], s35 offen offset:0 sc1 lds
    buffer_load_dwordx4 v2, s[4:7], s35 offen offset:1024 sc1 lds
    buffer_load_dwordx4 v2, s[4:7], s35 offen offset:2048 sc1 lds
    buffer_load_dwordx4 v2, s[4:7], s35 offen offset:3072 sc1 lds
    s_add_u32 s35, s35, 16384
    s_waitcnt vmcnt(13)
    ds_read_b64_tr_b16 v[84:85], v24 offset:0
    ds_read_b64_tr_b16 v[86:87], v24 offset:256
    ds_read_b64_tr_b16 v[88:89], v24 offset:1024
    ds_read_b64_tr_b16 v[90:91], v24 offset:1280
    ds_read_b64_tr_b16 v[92:93], v24 offset:2048
    ds_read_b64_tr_b16 v[94:95], v24 offset:2304
    ds_read_b64_tr_b16 v[96:97], v24 offset:3072
    ds_read_b64_tr_b16 v[98:99], v24 offset:3328
    s_waitcnt vmcnt(9)
    ds_read_b64_tr_b16 v[100:101], v24 offset:16384
    ds_read_b64_tr_b16 v[102:103], v24 offset:16640
    ds_read_b64_tr_b16 v[104:105], v24 offset:17408
    ds_read_b64_tr_b16 v[106:107], v24 offset:17664
    ds_read_b64_tr_b16 v[108:109], v24 offset:18432
    ds_read_b64_tr_b16 v[110:111], v24 offset:18688
    ds_read_b64_tr_b16 v[112:113], v24 offset:19456
    ds_read_b64_tr_b16 v[114:115], v24 offset:19712
    v_mov_b32 v164, 0
    v_mov_b32 v165, 0
    v_mov_b32 v166, 0
    v_mov_b32 v167, 0
    s_waitcnt lgkmcnt(14)
    v_dot2c_f32_bf16 v164, s24, v84
    v_dot2c_f32_bf16 v166, v84, v84
    v_dot2c_f32_bf16 v165, s24, v85
    v_dot2c_f32_bf16 v167, v85, v85
    v_dot2c_f32_bf16 v164, s24, v86
    v_dot2c_f32_bf16 v166, v86, v86
    v_dot2c_f32_bf16 v165, s24, v87
    v_dot2c_f32_bf16 v167, v87, v87
    s_waitcnt lgkmcnt(12)
    v_dot2c_f32_bf16 v164, s24, v88
    v_dot2c_f32_bf16 v166, v88, v88
    v_dot2c_f32_bf16 v165, s24, v89
    v_dot2c_f32_bf16 v167, v89, v89
    v_dot2c_f32_bf16 v164, s24, v90
    v_dot2c_f32_bf16 v166, v90, v90
    v_dot2c_f32_bf16 v165, s24, v91
    v_dot2c_f32_bf16 v167, v91, v91
    s_waitcnt lgkmcnt(10)
    v_dot2c_f32_bf16 v164, s24, v92
    v_dot2c_f32_bf16 v166, v92, v92
    v_dot2c_f32_bf16 v165, s24, v93
    v_dot2c_f32_bf16 v167, v93, v93
    v_dot2c_f32_bf16 v164, s24, v94
    v_dot2c_f32_bf16 v166, v94, v94
    v_dot2c_f32_bf16 v165, s24, v95
    v_dot2c_f32_bf16 v167, v95, v95
    s_waitcnt lgkmcnt(8)
    v_dot2c_f32_bf16 v164, s24, v96
    v_dot2c_f32_bf16 v166, v96, v96
    v_dot2c_f32_bf16 v165, s24, v97
    v_dot2c_f32_bf16 v167, v97, v97
    v_dot2c_f32_bf16 v164, s24, v98
    v_dot2c_f32_bf16 v166, v98, v98
    v_dot2c_f32_bf16 v165, s24, v99
    v_dot2c_f32_bf16 v167, v99, v99
    s_waitcnt lgkmcnt(6)
    v_dot2c_f32_bf16 v164, s24, v100
    v_dot2c_f32_bf16 v166, v100, v100
    v_dot2c_f32_bf16 v165, s24, v101
    v_dot2c_f32_bf16 v167, v101, v101
    v_dot2c_f32_bf16 v164, s24, v102
    v_dot2c_f32_bf16 v166, v102, v102
    v_dot2c_f32_bf16 v165, s24, v103
    v_dot2c_f32_bf16 v167, v103, v103
    s_waitcnt lgkmcnt(4)
    v_dot2c_f32_bf16 v164, s24, v104
    v_dot2c_f32_bf16 v166, v104, v104
    v_dot2c_f32_bf16 v165, s24, v105
    v_dot2c_f32_bf16 v167, v105, v105
    v_dot2c_f32_bf16 v164, s24, v106
    v_dot2c_f32_bf16 v166, v106, v106
    v_dot2c_f32_bf16 v165, s24, v107
    v_dot2c_f32_bf16 v167, v107, v107
    s_waitcnt lgkmcnt(2)
    v_dot2c_f32_bf16 v164, s24, v108
    v_dot2c_f32_bf16 v166, v108, v108
    v_dot2c_f32_bf16 v165, s24, v109
    v_dot2c_f32_bf16 v167, v109, v109
    v_dot2c_f32_bf16 v164, s24, v110
    v_dot2c_f32_bf16 v166, v110, v110
    v_dot2c_f32_bf16 v165, s24, v111
    v_dot2c_f32_bf16 v167, v111, v111
    s_waitcnt lgkmcnt(0)
    v_dot2c_f32_bf16 v164, s24, v112
    v_dot2c_f32_bf16 v166, v112, v112
    v_dot2c_f32_bf16 v165, s24, v113
    v_dot2c_f32_bf16 v167, v113, v113
    v_dot2c_f32_bf16 v164, s24, v114
    v_dot2c_f32_bf16 v166, v114, v114
    v_dot2c_f32_bf16 v165, s24, v115
    v_dot2c_f32_bf16 v167, v115, v115
    s_nop 1
    v_add_f32 v164, v164, v165
    v_add_f32 v166, v166, v167
    s_nop 1
    v_permlane32_swap_b32 v164, v166
    v_add_f32 v164, v164, v166
    ds_write_b32 v26, v164 offset:17152
    s_add_u32 s37, s27, 16154624
    v_mov_b32 v20, 0
    buffer_atomic_add v20, v19, s[4:7], s37 offen sc0 sc1
    s_waitcnt lgkmcnt(0)
    s_barrier
    s_mov_b32 s39, 2146435072
    s_cmp_lg_u32 s3, 3
    s_cbranch_scc1 mk_fs81
    ds_read_b32 v168, v27 offset:17152
    ds_read_b32 v169, v27 offset:17408
    ds_read_b32 v170, v27 offset:17664
    ds_read_b32 v171, v27 offset:17920
    s_add_u32 s39, s42, 0
    s_waitcnt lgkmcnt(0)
    v_add_f32 v168, v168, v169
    v_add_f32 v170, v170, v171
    v_add_f32 v168, v168, v170
    v_mul_f32 v164, s16, v168
    v_mov_b32 v165, v164
    s_nop 1
    v_permlane32_swap_b32 v164, v165
    v_fma_f32 v165, -v164, v164, v165
    v_cvt_pk_bf16_f32 v175, v164, v164
    v_max_f32 v165, 0, v165
    v_add_f32 v174, s18, v165
    v_rsq_f32 v164, v174
    v_and_b32 v174, 0xffffff7f, v174
    v_mul_f32 v173, 0xc0135761, v164
    v_mul_f32 v172, v164, v164
    v_mul_f32 v165, 0xbdd2d3e8, v164
    v_and_b32 v173, 0xffffff7f, v173
    v_mul_f32 v172, v172, v165
    v_and_b32 v172, 0xffffff7f, v172
    v_or_b32 v172, 1, v172
mk_fs81:
    s_mov_b32 exec_hi, 0
    buffer_store_dwordx4 v[172:175], v2, s[4:7], s39 offen offset:512 sc1
    s_mov_b32 exec_hi, -1
    s_waitcnt vmcnt(6)
    ds_read_b64_tr_b16 v[132:133], v24 offset:32768
    ds_read_b64_tr_b16 v[134:135], v24 offset:33024
    ds_read_b64_tr_b16 v[136:137], v24 offset:33792
    ds_read_b64_tr_b16 v[138:139], v24 offset:34048
    ds_read_b64_tr_b16 v[140:141], v24 offset:34816
    ds_read_b64_tr_b16 v[142:143], v24 offset:35072
    ds_read_b64_tr_b16 v[144:145], v24 offset:35840
    ds_read_b64_tr_b16 v[146:147], v24 offset:36096
    s_waitcnt vmcnt(2)
    ds_read_b64_tr_b16 v[148:149], v24 offset:49152
    ds_read_b64_tr_b16 v[150:151], v24 offset:49408
    ds_read_b64_tr_b16 v[152:153], v24 offset:50176
    ds_read_b64_tr_b16 v[154:155], v24 offset:50432
    ds_read_b64_tr_b16 v[156:157], v24 offset:51200
    ds_read_b64_tr_b16 v[158:159], v24 offset:51456
    ds_read_b64_tr_b16 v[160:161], v24 offset:52224
    ds_read_b64_tr_b16 v[162:163], v24 offset:52480
    v_mov_b32 v164, 0
    v_mov_b32 v165, 0
    v_mov_b32 v166, 0
    v_mov_b32 v167, 0
    s_waitcnt lgkmcnt(14)
    v_dot2c_f32_bf16 v164, s24, v132
    v_dot2c_f32_bf16 v166, v132, v132
    v_dot2c_f32_bf16 v165, s24, v133
    v_dot2c_f32_bf16 v167, v133, v133
    v_dot2c_f32_bf16 v164, s24, v134
    v_dot2c_f32_bf16 v166, v134, v134
    v_dot2c_f32_bf16 v165, s24, v135
    v_dot2c_f32_bf16 v167, v135, v135
    s_waitcnt lgkmcnt(12)
    v_dot2c_f32_bf16 v164, s24, v136
    v_dot2c_f32_bf16 v166, v136, v136
    v_dot2c_f32_bf16 v165, s24, v137
    v_dot2c_f32_bf16 v167, v137, v137
    v_dot2c_f32_bf16 v164, s24, v138
    v_dot2c_f32_bf16 v166, v138, v138
    v_dot2c_f32_bf16 v165, s24, v139
    v_dot2c_f32_bf16 v167, v139, v139
    s_waitcnt lgkmcnt(10)
    v_dot2c_f32_bf16 v164, s24, v140
    v_dot2c_f32_bf16 v166, v140, v140
    v_dot2c_f32_bf16 v165, s24, v141
    v_dot2c_f32_bf16 v167, v141, v141
    v_dot2c_f32_bf16 v164, s24, v142
    v_dot2c_f32_bf16 v166, v142, v142
    v_dot2c_f32_bf16 v165, s24, v143
    v_dot2c_f32_bf16 v167, v143, v143
    s_waitcnt lgkmcnt(8)
    v_dot2c_f32_bf16 v164, s24, v144
    v_dot2c_f32_bf16 v166, v144, v144
    v_dot2c_f32_bf16 v165, s24, v145
    v_dot2c_f32_bf16 v167, v145, v145
    v_dot2c_f32_bf16 v164, s24, v146
    v_dot2c_f32_bf16 v166, v146, v146
    v_dot2c_f32_bf16 v165, s24, v147
    v_dot2c_f32_bf16 v167, v147, v147
    s_waitcnt lgkmcnt(6)
    v_dot2c_f32_bf16 v164, s24, v148
    v_dot2c_f32_bf16 v166, v148, v148
    v_dot2c_f32_bf16 v165, s24, v149
    v_dot2c_f32_bf16 v167, v149, v149
    v_dot2c_f32_bf16 v164, s24, v150
    v_dot2c_f32_bf16 v166, v150, v150
    v_dot2c_f32_bf16 v165, s24, v151
    v_dot2c_f32_bf16 v167, v151, v151
    s_waitcnt lgkmcnt(4)
    v_dot2c_f32_bf16 v164, s24, v152
    v_dot2c_f32_bf16 v166, v152, v152
    v_dot2c_f32_bf16 v165, s24, v153
    v_dot2c_f32_bf16 v167, v153, v153
    v_dot2c_f32_bf16 v164, s24, v154
    v_dot2c_f32_bf16 v166, v154, v154
    v_dot2c_f32_bf16 v165, s24, v155
    v_dot2c_f32_bf16 v167, v155, v155
    s_waitcnt lgkmcnt(2)
    v_dot2c_f32_bf16 v164, s24, v156
    v_dot2c_f32_bf16 v166, v156, v156
    v_dot2c_f32_bf16 v165, s24, v157
    v_dot2c_f32_bf16 v167, v157, v157
    v_dot2c_f32_bf16 v164, s24, v158
    v_dot2c_f32_bf16 v166, v158, v158
    v_dot2c_f32_bf16 v165, s24, v159
    v_dot2c_f32_bf16 v167, v159, v159
    s_waitcnt lgkmcnt(0)
    v_dot2c_f32_bf16 v164, s24, v160
    v_dot2c_f32_bf16 v166, v160, v160
    v_dot2c_f32_bf16 v165, s24, v161
    v_dot2c_f32_bf16 v167, v161, v161
    v_dot2c_f32_bf16 v164, s24, v162
    v_dot2c_f32_bf16 v166, v162, v162
    v_dot2c_f32_bf16 v165, s24, v163
    v_dot2c_f32_bf16 v167, v163, v163
    s_nop 1
    v_add_f32 v164, v164, v165
    v_add_f32 v166, v166, v167
    s_nop 1
    v_permlane32_swap_b32 v164, v166
    v_add_f32 v164, v164, v166
    ds_write_b32 v26, v164 offset:18176
    s_waitcnt lgkmcnt(0)
    s_barrier
    s_mov_b32 s39, 2146435072
    s_cmp_lg_u32 s3, 2
    s_cbranch_scc1 mk_fs82
    ds_read_b32 v168, v27 offset:18176
    ds_read_b32 v169, v27 offset:18432
    ds_read_b32 v170, v27 offset:18688
    ds_read_b32 v171, v27 offset:18944
    s_add_u32 s39, s42, 0
    s_waitcnt lgkmcnt(0)
    v_add_f32 v168, v168, v169
    v_add_f32 v170, v170, v171
    v_add_f32 v168, v168, v170
    v_mul_f32 v164, s16, v168
    v_mov_b32 v165, v164
    s_nop 1
    v_permlane32_swap_b32 v164, v165
    v_fma_f32 v165, -v164, v164, v165
    v_cvt_pk_bf16_f32 v175, v164, v164
    v_max_f32 v165, 0, v165
    v_add_f32 v174, s18, v165
    v_rsq_f32 v164, v174
    v_and_b32 v174, 0xffffff7f, v174
    v_mul_f32 v173, 0xc0135761, v164
    v_mul_f32 v172, v164, v164
    v_mul_f32 v165, 0xbdd2d3e8, v164
    v_and_b32 v173, 0xffffff7f, v173
    v_mul_f32 v172, v172, v165
    v_and_b32 v172, 0xffffff7f, v172
    v_or_b32 v172, 1, v172
mk_fs82:
    s_mov_b32 exec_hi, 0
    buffer_store_dwordx4 v[172:175], v2, s[4:7], s39 offen offset:1024 sc1
    s_mov_b32 exec_hi, -1
    s_waitcnt vmcnt(2)
    v_cmp_gt_u32 vcc, 16, v20
    s_nop 0
    s_and_b64 vcc, vcc, s[54:55]
    s_cbranch_scc1 mk_ps83
mk_po84:
    s_barrier
    s_mul_i32 s35, s20, 98304
    s_add_u32 s35, s35, s41
    s_add_u32 s35, s35, 8388608
    s_add_u32 s35, s35, s44
    s_sub_u32 s35, s35, 32768
    s_add_u32 m0, s41, 131072
    s_nop 0
    buffer_load_dwordx4 v2, s[4:7], s35 offen offset:0 sc1 lds
    buffer_load_dwordx4 v2, s[4:7], s35 offen offset:1024 sc1 lds
    buffer_load_dwordx4 v2, s[4:7], s35 offen offset:2048 sc1 lds
    buffer_load_dwordx4 v2, s[4:7], s35 offen offset:3072 sc1 lds
    s_add_u32 s35, s35, 16384
    s_add_u32 m0, s41, 147456
    s_nop 0
    buffer_load_dwordx4 v2, s[4:7], s35 offen offset:0 sc1 lds
    buffer_load_dwordx4 v2, s[4:7], s35 offen offset:1024 sc1 lds
    buffer_load_dwordx4 v2, s[4:7], s35 offen offset:2048 sc1 lds
    buffer_load_dwordx4 v2, s[4:7], s35 offen offset:3072 sc1 lds
    s_add_u32 s35, s35, 16384
    s_add_u32 m0, s41, 32768
    s_nop 0
    buffer_load_dwordx4 v2, s[4:7], s35 offen offset:0 sc1 lds
    buffer_load_dwordx4 v2, s[4:7], s35 offen offset:1024 sc1 lds
    buffer_load_dwordx4 v2, s[4:7], s35 offen offset:2048 sc1 lds
    buffer_load_dwordx4 v2, s[4:7], s35 offen offset:3072 sc1 lds
    s_add_u32 s35, s35, 16384
    s_add_u32 m0, s41, 49152
    s_nop 0
    buffer_load_dwordx4 v2, s[4:7], s35 offen offset:0 sc1 lds
    buffer_load_dwordx4 v2, s[4:7], s35 offen offset:1024 sc1 lds
    buffer_load_dwordx4 v2, s[4:7], s35 offen offset:2048 sc1 lds
    buffer_load_dwordx4 v2, s[4:7], s35 offen offset:3072 sc1 lds
    s_add_u32 s35, s35, 16384
    s_waitcnt vmcnt(12)
    ds_read_b64_tr_b16 v[84:85], v25 offset:32768
    ds_read_b64_tr_b16 v[86:87], v25 offset:33024
    ds_read_b64_tr_b16 v[88:89], v25 offset:33792
    ds_read_b64_tr_b16 v[90:91], v25 offset:34048
    ds_read_b64_tr_b16 v[92:93], v25 offset:34816
    ds_read_b64_tr_b16 v[94:95], v25 offset:35072
    ds_read_b64_tr_b16 v[96:97], v25 offset:35840
    ds_read_b64_tr_b16 v[98:99], v25 offset:36096
    s_waitcnt vmcnt(8)
    ds_read_b64_tr_b16 v[100:101], v25 offset:49152
    ds_read_b64_tr_b16 v[102:103], v25 offset:49408
    ds_read_b64_tr_b16 v[104:105], v25 offset:50176
    ds_read_b64_tr_b16 v[106:107], v25 offset:50432
    ds_read_b64_tr_b16 v[108:109], v25 offset:51200
    ds_read_b64_tr_b16 v[110:111], v25 offset:51456
    ds_read_b64_tr_b16 v[112:113], v25 offset:52224
    ds_read_b64_tr_b16 v[114:115], v25 offset:52480
    v_mov_b32 v164, 0
    v_mov_b32 v165, 0
    v_mov_b32 v166, 0
    v_mov_b32 v167, 0
    s_waitcnt lgkmcnt(14)
    v_dot2c_f32_bf16 v164, s24, v84
    v_dot2c_f32_bf16 v166, v84, v84
    v_dot2c_f32_bf16 v165, s24, v85
    v_dot2c_f32_bf16 v167, v85, v85
    v_dot2c_f32_bf16 v164, s24, v86
    v_dot2c_f32_bf16 v166, v86, v86
    v_dot2c_f32_bf16 v165, s24, v87
    v_dot2c_f32_bf16 v167, v87, v87
    s_cmp_eq_u32 s20, 10
    s_cselect_b32 s35, 2146435072, s35
    s_add_u32 m0, s41, 65536
    s_nop 0
    buffer_load_dwordx4 v2, s[4:7], s35 offen offset:0 sc1 lds
    s_waitcnt lgkmcnt(12)
    v_dot2c_f32_bf16 v164, s24, v88
    v_dot2c_f32_bf16 v166, v88, v88
    v_dot2c_f32_bf16 v165, s24, v89
    v_dot2c_f32_bf16 v167, v89, v89
    v_dot2c_f32_bf16 v164, s24, v90
    v_dot2c_f32_bf16 v166, v90, v90
    v_dot2c_f32_bf16 v165, s24, v91
    v_dot2c_f32_bf16 v167, v91, v91
    buffer_load_dwordx4 v2, s[4:7], s35 offen offset:1024 sc1 lds
    s_waitcnt lgkmcnt(10)
    v_dot2c_f32_bf16 v164, s24, v92
    v_dot2c_f32_bf16 v166, v92, v92
    v_dot2c_f32_bf16 v165, s24, v93
    v_dot2c_f32_bf16 v167, v93, v93
    v_dot2c_f32_bf16 v164, s24, v94
    v_dot2c_f32_bf16 v166, v94, v94
    v_dot2c_f32_bf16 v165, s24, v95
    v_dot2c_f32_bf16 v167, v95, v95
    buffer_load_dwordx4 v2, s[4:7], s35 offen offset:2048 sc1 lds
    s_waitcnt lgkmcnt(8)
    v_dot2c_f32_bf16 v164, s24, v96
    v_dot2c_f32_bf16 v166, v96, v96
    v_dot2c_f32_bf16 v165, s24, v97
    v_dot2c_f32_bf16 v167, v97, v97
    v_dot2c_f32_bf16 v164, s24, v98
    v_dot2c_f32_bf16 v166, v98, v98
    v_dot2c_f32_bf16 v165, s24, v99
    v_dot2c_f32_bf16 v167, v99, v99
    buffer_load_dwordx4 v2, s[4:7], s35 offen offset:3072 sc1 lds
    s_add_u32 s35, s35, 16384
    s_waitcnt lgkmcnt(6)
    v_dot2c_f32_bf16 v164, s24, v100
    v_dot2c_f32_bf16 v166, v100, v100
    v_dot2c_f32_bf16 v165, s24, v101
    v_dot2c_f32_bf16 v167, v101, v101
    v_dot2c_f32_bf16 v164, s24, v102
    v_dot2c_f32_bf16 v166, v102, v102
    v_dot2c_f32_bf16 v165, s24, v103
    v_dot2c_f32_bf16 v167, v103, v103
    s_add_u32 m0, s41, 81920
    s_nop 0
    buffer_load_dwordx4 v2, s[4:7], s35 offen offset:0 sc1 lds
    s_waitcnt lgkmcnt(4)
    v_dot2c_f32_bf16 v164, s24, v104
    v_dot2c_f32_bf16 v166, v104, v104
    v_dot2c_f32_bf16 v165, s24, v105
    v_dot2c_f32_bf16 v167, v105, v105
    v_dot2c_f32_bf16 v164, s24, v106
    v_dot2c_f32_bf16 v166, v106, v106
    v_dot2c_f32_bf16 v165, s24, v107
    v_dot2c_f32_bf16 v167, v107, v107
    buffer_load_dwordx4 v2, s[4:7], s35 offen offset:1024 sc1 lds
    s_waitcnt lgkmcnt(2)
    v_dot2c_f32_bf16 v164, s24, v108
    v_dot2c_f32_bf16 v166, v108, v108
    v_dot2c_f32_bf16 v165, s24, v109
    v_dot2c_f32_bf16 v167, v109, v109
    v_dot2c_f32_bf16 v164, s24, v110
    v_dot2c_f32_bf16 v166, v110, v110
    v_dot2c_f32_bf16 v165, s24, v111
    v_dot2c_f32_bf16 v167, v111, v111
    buffer_load_dwordx4 v2, s[4:7], s35 offen offset:2048 sc1 lds
    s_waitcnt lgkmcnt(0)
    v_dot2c_f32_bf16 v164, s24, v112
    v_dot2c_f32_bf16 v166, v112, v112
    v_dot2c_f32_bf16 v165, s24, v113
    v_dot2c_f32_bf16 v167, v113, v113
    v_dot2c_f32_bf16 v164, s24, v114
    v_dot2c_f32_bf16 v166, v114, v114
    v_dot2c_f32_bf16 v165, s24, v115
    v_dot2c_f32_bf16 v167, v115, v115
    buffer_load_dwordx4 v2, s[4:7], s35 offen offset:3072 sc1 lds
    s_add_u32 s35, s35, 16384
    v_add_f32 v164, v164, v165
    v_add_f32 v166, v166, v167
    s_nop 1
    v_permlane32_swap_b32 v164, v166
    v_add_f32 v164, v164, v166
    ds_write_b32 v26, v164 offset:20224
    s_waitcnt lgkmcnt(0)
    s_barrier
    s_mov_b32 s39, 2146435072
    s_cmp_lg_u32 s3, 0
    s_cbranch_scc1 mk_fs86
    ds_read_b32 v168, v27 offset:20224
    ds_read_b32 v169, v27 offset:20480
    ds_read_b32 v170, v27 offset:20736
    ds_read_b32 v171, v27 offset:20992
    s_add_u32 s39, s42, 16896
    s_waitcnt lgkmcnt(0)
    v_add_f32 v168, v168, v169
    v_add_f32 v170, v170, v171
    v_add_f32 v168, v168, v170
    v_mul_f32 v164, s16, v168
    v_mov_b32 v165, v164
    s_nop 1
    v_permlane32_swap_b32 v164, v165
    v_fma_f32 v165, -v164, v164, v165
    v_cvt_pk_bf16_f32 v175, v164, v164
    v_max_f32 v165, 0, v165
    v_add_f32 v174, s18, v165
    v_rsq_f32 v164, v174
    v_and_b32 v174, 0xffffff7f, v174
    v_mul_f32 v173, 0xc0135761, v164
    v_mul_f32 v172, v164, v164
    v_mul_f32 v165, 0xbdd2d3e8, v164
    v_and_b32 v173, 0xffffff7f, v173
    v_mul_f32 v172, v172, v165
    v_and_b32 v172, 0xffffff7f, v172
    v_or_b32 v172, 1, v172
mk_fs86:
    s_mov_b32 exec_hi, 0
    buffer_store_dwordx4 v[172:175], v2, s[4:7], s39 offen offset:0 sc1
    s_mov_b32 exec_hi, -1
    s_waitcnt vmcnt(13)
    ds_read_b64_tr_b16 v[132:133], v24 offset:0
    ds_read_b64_tr_b16 v[134:135], v24 offset:256
    ds_read_b64_tr_b16 v[136:137], v24 offset:1024
    ds_read_b64_tr_b16 v[138:139], v24 offset:1280
    ds_read_b64_tr_b16 v[140:141], v24 offset:2048
    ds_read_b64_tr_b16 v[142:143], v24 offset:2304
    ds_read_b64_tr_b16 v[144:145], v24 offset:3072
    ds_read_b64_tr_b16 v[146:147], v24 offset:3328
    s_waitcnt vmcnt(9)
    ds_read_b64_tr_b16 v[148:149], v24 offset:16384
    ds_read_b64_tr_b16 v[150:151], v24 offset:16640
    ds_read_b64_tr_b16 v[152:153], v24 offset:17408
    ds_read_b64_tr_b16 v[154:155], v24 offset:17664
    ds_read_b64_tr_b16 v[156:157], v24 offset:18432
    ds_read_b64_tr_b16 v[158:159], v24 offset:18688
    ds_read_b64_tr_b16 v[160:161], v24 offset:19456
    ds_read_b64_tr_b16 v[162:163], v24 offset:19712
    v_mov_b32 v164, 0
    v_mov_b32 v165, 0
    v_mov_b32 v166, 0
    v_mov_b32 v167, 0
    s_waitcnt lgkmcnt(14)
    v_dot2c_f32_bf16 v164, s24, v132
    v_dot2c_f32_bf16 v166, v132, v132
    v_dot2c_f32_bf16 v165, s24, v133
    v_dot2c_f32_bf16 v167, v133, v133
    v_dot2c_f32_bf16 v164, s24, v134
    v_dot2c_f32_bf16 v166, v134, v134
    v_dot2c_f32_bf16 v165, s24, v135
    v_dot2c_f32_bf16 v167, v135, v135
    s_waitcnt lgkmcnt(12)
    v_dot2c_f32_bf16 v164, s24, v136
    v_dot2c_f32_bf16 v166, v136, v136
    v_dot2c_f32_bf16 v165, s24, v137
    v_dot2c_f32_bf16 v167, v137, v137
    v_dot2c_f32_bf16 v164, s24, v138
    v_dot2c_f32_bf16 v166, v138, v138
    v_dot2c_f32_bf16 v165, s24, v139
    v_dot2c_f32_bf16 v167, v139, v139
    s_waitcnt lgkmcnt(10)
    v_dot2c_f32_bf16 v164, s24, v140
    v_dot2c_f32_bf16 v166, v140, v140
    v_dot2c_f32_bf16 v165, s24, v141
    v_dot2c_f32_bf16 v167, v141, v141
    v_dot2c_f32_bf16 v164, s24, v142
    v_dot2c_f32_bf16 v166, v142, v142
    v_dot2c_f32_bf16 v165, s24, v143
    v_dot2c_f32_bf16 v167, v143, v143
    s_waitcnt lgkmcnt(8)
    v_dot2c_f32_bf16 v164, s24, v144
    v_dot2c_f32_bf16 v166, v144, v144
    v_dot2c_f32_bf16 v165, s24, v145
    v_dot2c_f32_bf16 v167, v145, v145
    v_dot2c_f32_bf16 v164, s24, v146
    v_dot2c_f32_bf16 v166, v146, v146
    v_dot2c_f32_bf16 v165, s24, v147
    v_dot2c_f32_bf16 v167, v147, v147
    s_waitcnt lgkmcnt(6)
    v_dot2c_f32_bf16 v164, s24, v148
    v_dot2c_f32_bf16 v166, v148, v148
    v_dot2c_f32_bf16 v165, s24, v149
    v_dot2c_f32_bf16 v167, v149, v149
    v_dot2c_f32_bf16 v164, s24, v150
    v_dot2c_f32_bf16 v166, v150, v150
    v_dot2c_f32_bf16 v165, s24, v151
    v_dot2c_f32_bf16 v167, v151, v151
    s_waitcnt lgkmcnt(4)
    v_dot2c_f32_bf16 v164, s24, v152
    v_dot2c_f32_bf16 v166, v152, v152
    v_dot2c_f32_bf16 v165, s24, v153
    v_dot2c_f32_bf16 v167, v153, v153
    v_dot2c_f32_bf16 v164, s24, v154
    v_dot2c_f32_bf16 v166, v154, v154
    v_dot2c_f32_bf16 v165, s24, v155
    v_dot2c_f32_bf16 v167, v155, v155
    s_waitcnt lgkmcnt(2)
    v_dot2c_f32_bf16 v164, s24, v156
    v_dot2c_f32_bf16 v166, v156, v156
    v_dot2c_f32_bf16 v165, s24, v157
    v_dot2c_f32_bf16 v167, v157, v157
    v_dot2c_f32_bf16 v164, s24, v158
    v_dot2c_f32_bf16 v166, v158, v158
    v_dot2c_f32_bf16 v165, s24, v159
    v_dot2c_f32_bf16 v167, v159, v159
    s_waitcnt lgkmcnt(0)
    v_dot2c_f32_bf16 v164, s24, v160
    v_dot2c_f32_bf16 v166, v160, v160
    v_dot2c_f32_bf16 v165, s24, v161
    v_dot2c_f32_bf16 v167, v161, v161
    v_dot2c_f32_bf16 v164, s24, v162
    v_dot2c_f32_bf16 v166, v162, v162
    v_dot2c_f32_bf16 v165, s24, v163
    v_dot2c_f32_bf16 v167, v163, v163
    s_nop 1
    v_add_f32 v164, v164, v165
    v_add_f32 v166, v166, v167
    s_nop 1
    v_permlane32_swap_b32 v164, v166
    v_add_f32 v164, v164, v166
    ds_write_b32 v26, v164 offset:17152
    s_waitcnt vmcnt(5)
    ds_read_b64_tr_b16 v[84:85], v24 offset:32768
    ds_read_b64_tr_b16 v[86:87], v24 offset:33024
    ds_read_b64_tr_b16 v[88:89], v24 offset:33792
    ds_read_b64_tr_b16 v[90:91], v24 offset:34048
    ds_read_b64_tr_b16 v[92:93], v24 offset:34816
    ds_read_b64_tr_b16 v[94:95], v24 offset:35072
    ds_read_b64_tr_b16 v[96:97], v24 offset:35840
    ds_read_b64_tr_b16 v[98:99], v24 offset:36096
    s_waitcnt vmcnt(1)
    ds_read_b64_tr_b16 v[100:101], v24 offset:49152
    ds_read_b64_tr_b16 v[102:103], v24 offset:49408
    ds_read_b64_tr_b16 v[104:105], v24 offset:50176
    ds_read_b64_tr_b16 v[106:107], v24 offset:50432
    ds_read_b64_tr_b16 v[108:109], v24 offset:51200
    ds_read_b64_tr_b16 v[110:111], v24 offset:51456
    ds_read_b64_tr_b16 v[112:113], v24 offset:52224
    ds_read_b64_tr_b16 v[114:115], v24 offset:52480
    s_waitcnt lgkmcnt(15)
    s_barrier
    s_mov_b32 s39, 2146435072
    s_cmp_lg_u32 s3, 3
    s_cbranch_scc1 mk_fs87
    ds_read_b32 v168, v27 offset:17152
    ds_read_b32 v169, v27 offset:17408
    ds_read_b32 v170, v27 offset:17664
    ds_read_b32 v171, v27 offset:17920
    s_add_u32 s39, s42, 16896
    s_waitcnt lgkmcnt(0)
    v_add_f32 v168, v168, v169
    v_add_f32 v170, v170, v171
    v_add_f32 v168, v168, v170
    v_mul_f32 v164, s16, v168
    v_mov_b32 v165, v164
    s_nop 1
    v_permlane32_swap_b32 v164, v165
    v_fma_f32 v165, -v164, v164, v165
    v_cvt_pk_bf16_f32 v175, v164, v164
    v_max_f32 v165, 0, v165
    v_add_f32 v174, s18, v165
    v_rsq_f32 v164, v174
    v_and_b32 v174, 0xffffff7f, v174
    v_mul_f32 v173, 0xc0135761, v164
    v_mul_f32 v172, v164, v164
    v_mul_f32 v165, 0xbdd2d3e8, v164
    v_and_b32 v173, 0xffffff7f, v173
    v_mul_f32 v172, v172, v165
    v_and_b32 v172, 0xffffff7f, v172
    v_or_b32 v172, 1, v172
mk_fs87:
    s_mov_b32 exec_hi, 0
    buffer_store_dwordx4 v[172:175], v2, s[4:7], s39 offen offset:512 sc1
    s_mov_b32 exec_hi, -1
    v_mov_b32 v164, 0
    v_mov_b32 v165, 0
    v_mov_b32 v166, 0
    v_mov_b32 v167, 0
    s_waitcnt lgkmcnt(14)
    v_dot2c_f32_bf16 v164, s24, v84
    v_dot2c_f32_bf16 v166, v84, v84
    v_dot2c_f32_bf16 v165, s24, v85
    v_dot2c_f32_bf16 v167, v85, v85
    v_dot2c_f32_bf16 v164, s24, v86
    v_dot2c_f32_bf16 v166, v86, v86
    v_dot2c_f32_bf16 v165, s24, v87
    v_dot2c_f32_bf16 v167, v87, v87
    s_waitcnt lgkmcnt(12)
    v_dot2c_f32_bf16 v164, s24, v88
    v_dot2c_f32_bf16 v166, v88, v88
    v_dot2c_f32_bf16 v165, s24, v89
    v_dot2c_f32_bf16 v167, v89, v89
    v_dot2c_f32_bf16 v164, s24, v90
    v_dot2c_f32_bf16 v166, v90, v90
    v_dot2c_f32_bf16 v165, s24, v91
    v_dot2c_f32_bf16 v167, v91, v91
    s_waitcnt lgkmcnt(10)
    v_dot2c_f32_bf16 v164, s24, v92
    v_dot2c_f32_bf16 v166, v92, v92
    v_dot2c_f32_bf16 v165, s24, v93
    v_dot2c_f32_bf16 v167, v93, v93
    v_dot2c_f32_bf16 v164, s24, v94
    v_dot2c_f32_bf16 v166, v94, v94
    v_dot2c_f32_bf16 v165, s24, v95
    v_dot2c_f32_bf16 v167, v95, v95
    s_waitcnt lgkmcnt(8)
    v_dot2c_f32_bf16 v164, s24, v96
    v_dot2c_f32_bf16 v166, v96, v96
    v_dot2c_f32_bf16 v165, s24, v97
    v_dot2c_f32_bf16 v167, v97, v97
    v_dot2c_f32_bf16 v164, s24, v98
    v_dot2c_f32_bf16 v166, v98, v98
    v_dot2c_f32_bf16 v165, s24, v99
    v_dot2c_f32_bf16 v167, v99, v99
    s_waitcnt lgkmcnt(6)
    v_dot2c_f32_bf16 v164, s24, v100
    v_dot2c_f32_bf16 v166, v100, v100
    v_dot2c_f32_bf16 v165, s24, v101
    v_dot2c_f32_bf16 v167, v101, v101
    v_dot2c_f32_bf16 v164, s24, v102
    v_dot2c_f32_bf16 v166, v102, v102
    v_dot2c_f32_bf16 v165, s24, v103
    v_dot2c_f32_bf16 v167, v103, v103
    s_waitcnt lgkmcnt(4)
    v_dot2c_f32_bf16 v164, s24, v104
    v_dot2c_f32_bf16 v166, v104, v104
    v_dot2c_f32_bf16 v165, s24, v105
    v_dot2c_f32_bf16 v167, v105, v105
    v_dot2c_f32_bf16 v164, s24, v106
    v_dot2c_f32_bf16 v166, v106, v106
    v_dot2c_f32_bf16 v165, s24, v107
    v_dot2c_f32_bf16 v167, v107, v107
    s_waitcnt lgkmcnt(2)
    v_dot2c_f32_bf16 v164, s24, v108
    v_dot2c_f32_bf16 v166, v108, v108
    v_dot2c_f32_bf16 v165, s24, v109
    v_dot2c_f32_bf16 v167, v109, v109
    v_dot2c_f32_bf16 v164, s24, v110
    v_dot2c_f32_bf16 v166, v110, v110
    v_dot2c_f32_bf16 v165, s24, v111
    v_dot2c_f32_bf16 v167, v111, v111
    s_waitcnt lgkmcnt(0)
    v_dot2c_f32_bf16 v164, s24, v112
    v_dot2c_f32_bf16 v166, v112, v112
    v_dot2c_f32_bf16 v165, s24, v113
    v_dot2c_f32_bf16 v167, v113, v113
    v_dot2c_f32_bf16 v164, s24, v114
    v_dot2c_f32_bf16 v166, v114, v114
    v_dot2c_f32_bf16 v165, s24, v115
    v_dot2c_f32_bf16 v167, v115, v115
    s_nop 1
    v_add_f32 v164, v164, v165
    v_add_f32 v166, v166, v167
    s_nop 1
    v_permlane32_swap_b32 v164, v166
    v_add_f32 v164, v164, v166
    ds_write_b32 v26, v164 offset:18176
    s_waitcnt lgkmcnt(0)
    s_barrier
    s_mov_b32 s39, 2146435072
    s_cmp_lg_u32 s3, 2
    s_cbranch_scc1 mk_fs88
    ds_read_b32 v168, v27 offset:18176
    ds_read_b32 v169, v27 offset:18432
    ds_read_b32 v170, v27 offset:18688
    ds_read_b32 v171, v27 offset:18944
    s_add_u32 s39, s42, 16896
    s_waitcnt lgkmcnt(0)
    v_add_f32 v168, v168, v169
    v_add_f32 v170, v170, v171
    v_add_f32 v168, v168, v170
    v_mul_f32 v164, s16, v168
    v_mov_b32 v165, v164
    s_nop 1
    v_permlane32_swap_b32 v164, v165
    v_fma_f32 v165, -v164, v164, v165
    v_cvt_pk_bf16_f32 v175, v164, v164
    v_max_f32 v165, 0, v165
    v_add_f32 v174, s18, v165
    v_rsq_f32 v164, v174
    v_and_b32 v174, 0xffffff7f, v174
    v_mul_f32 v173, 0xc0135761, v164
    v_mul_f32 v172, v164, v164
    v_mul_f32 v165, 0xbdd2d3e8, v164
    v_and_b32 v173, 0xffffff7f, v173
    v_mul_f32 v172, v172, v165
    v_and_b32 v172, 0xffffff7f, v172
    v_or_b32 v172, 1, v172
mk_fs88:
    s_mov_b32 exec_hi, 0
    buffer_store_dwordx4 v[172:175], v2, s[4:7], s39 offen offset:1024 sc1
    s_mov_b32 exec_hi, -1
    s_mul_i32 s93, s22, 90112
    s_lshl_b32 s33, s3, 10
    s_add_u32 s93, s93, s33
    s_add_u32 s93, s93, 31457280
    s_add_u32 s94, s93, 90112
    s_mul_i32 s40, s23, 0
    s_add_u32 s40, s40, s93
    s_add_u32 s37, s29, 16297984
    v_mov_b32 v20, 0
    buffer_atomic_add v20, v13, s[4:7], s37 offen sc0 sc1
    s_waitcnt vmcnt(0)
    v_cmp_gt_u32 vcc, 11, v20
    s_nop 0
    s_and_b64 vcc, vcc, s[52:53]
    s_cbranch_scc1 mk_ps89
mk_po90:
    s_barrier
    buffer_load_dwordx4 v[252:255], v2, s[4:7], s40 offen sc1
    s_add_u32 s40, s40, 4096
    buffer_load_dwordx4 v[248:251], v2, s[4:7], s40 offen sc1
    s_add_u32 s40, s40, 4096
    buffer_load_dwordx4 v[244:247], v2, s[4:7], s40 offen sc1
    s_add_u32 s40, s40, 4096
    buffer_load_dwordx4 v[240:243], v2, s[4:7], s40 offen sc1
    s_add_u32 s40, s40, 4096
    buffer_load_dwordx4 v[236:239], v2, s[4:7], s40 offen sc1
    s_add_u32 s40, s40, 4096
    buffer_load_dwordx4 v[232:235], v2, s[4:7], s40 offen sc1
    s_add_u32 s40, s40, 4096
    buffer_load_dwordx4 v[228:231], v2, s[4:7], s40 offen sc1
    s_add_u32 s40, s40, 4096
    buffer_load_dwordx4 v[224:227], v2, s[4:7], s40 offen sc1
    s_add_u32 s40, s40, 4096
    buffer_load_dwordx4 v[220:223], v2, s[4:7], s40 offen sc1
    s_add_u32 s40, s40, 4096
    buffer_load_dwordx4 v[216:219], v2, s[4:7], s40 offen sc1
    s_add_u32 s40, s40, 4096
    buffer_load_dwordx4 v[212:215], v2, s[4:7], s40 offen sc1
    s_add_u32 s40, s40, 4096
    buffer_load_dwordx4 v[208:211], v2, s[4:7], s40 offen sc1
    s_add_u32 s40, s40, 4096
    buffer_load_dwordx4 v[204:207], v2, s[4:7], s40 offen sc1
    s_add_u32 s40, s40, 4096
    buffer_load_dwordx4 v[200:203], v2, s[4:7], s40 offen sc1
    s_add_u32 s40, s40, 4096
    s_waitcnt vmcnt(0)
    s_branch mk_B1
mk_ps1:
    s_sub_u32 s25, s25, 1
    s_cbranch_scc1 mk_pt3
    s_sleep 3
    buffer_load_dword v20, v18, s[12:15], 0 offen sc1
    s_waitcnt vmcnt(0)
    v_cmp_gt_u32 vcc, 1, v20
    s_nop 0
    s_and_b64 vcc, vcc, s[52:53]
    s_and_b64 vcc, vcc, 1
    s_cbranch_scc1 mk_ps1
    s_branch mk_po2
mk_pt3:
    s_mov_b32 s25, 0
    s_branch mk_po2
mk_ps4:
    s_sub_u32 s25, s25, 1
    s_cbranch_scc1 mk_pt6
    s_sleep 1
    v_mov_b32 v20, 0
    buffer_atomic_add v20, v17, s[4:7], s37 offen sc0 sc1
    s_waitcnt vmcnt(0)
    v_cmp_gt_u32 vcc, 16, v20
    s_nop 0
    s_and_b64 vcc, vcc, s[54:55]
    s_cbranch_scc1 mk_ps4
    s_branch mk_po5
mk_pt6:
    s_mov_b32 s25, 0
    s_branch mk_po5
mk_ps7:
    s_sub_u32 s25, s25, 1
    s_cbranch_scc1 mk_pt9
    s_sleep 1
    v_mov_b32 v20, 0
    buffer_atomic_add v20, v19, s[4:7], s37 offen sc0 sc1
    s_waitcnt vmcnt(0)
    v_cmp_gt_u32 vcc, 16, v20
    s_nop 0
    s_and_b64 vcc, vcc, s[54:55]
    s_cbranch_scc1 mk_ps7
    s_branch mk_po8
mk_pt9:
    s_mov_b32 s25, 0
    s_branch mk_po8
mk_ps10:
    s_sub_u32 s25, s25, 1
    s_cbranch_scc1 mk_pt12
    s_sleep 1
    v_mov_b32 v20, 0
    buffer_atomic_add v20, v19, s[4:7], s37 offen sc0 sc1
    s_waitcnt vmcnt(0)
    v_cmp_gt_u32 vcc, 16, v20
    s_nop 0
    s_and_b64 vcc, vcc, s[54:55]
    s_cbranch_scc1 mk_ps10
    s_branch mk_po11
mk_pt12:
    s_mov_b32 s25, 0
    s_branch mk_po11
mk_ps13:
    s_sub_u32 s25, s25, 1
    s_cbranch_scc1 mk_pt15
    s_sleep 1
    v_mov_b32 v20, 0
    buffer_atomic_add v20, v19, s[4:7], s37 offen sc0 sc1
    s_waitcnt vmcnt(0)
    v_cmp_gt_u32 vcc, 16, v20
    s_nop 0
    s_and_b64 vcc, vcc, s[54:55]
    s_cbranch_scc1 mk_ps13
    s_branch mk_po14
mk_pt15:
    s_mov_b32 s25, 0
    s_branch mk_po14
mk_qs16:
    s_sub_u32 s25, s25, 1
    s_cbranch_scc1 mk_qt18
    s_sleep 3
    buffer_load_dwordx4 v[176:179], v30, s[4:7], s39 offen offset:512 sc1
    s_waitcnt vmcnt(0)
    v_cmp_eq_u32 vcc, 0, v176
    s_cbranch_vccnz mk_qs16
    s_branch mk_qo17
mk_qt18:
    s_mov_b32 s25, 0
    s_branch mk_qo17
mk_qs19:
    s_sub_u32 s25, s25, 1
    s_cbranch_scc1 mk_qt21
    s_sleep 3
    buffer_load_dwordx4 v[180:183], v30, s[4:7], s39 offen offset:1024 sc1
    s_waitcnt vmcnt(0)
    v_cmp_eq_u32 vcc, 0, v180
    s_cbranch_vccnz mk_qs19
    s_branch mk_qo20
mk_qt21:
    s_mov_b32 s25, 0
    s_branch mk_qo20
mk_qs22:
    s_sub_u32 s25, s25, 1
    s_cbranch_scc1 mk_qt24
    s_sleep 3
    buffer_load_dwordx4 v[172:175], v30, s[4:7], s39 offen offset:0 sc1
    s_waitcnt vmcnt(0)
    v_cmp_eq_u32 vcc, 0, v172
    s_cbranch_vccnz mk_qs22
    s_branch mk_qo23
mk_qt24:
    s_mov_b32 s25, 0
    s_branch mk_qo23
mk_qs25:
    s_sub_u32 s25, s25, 1
    s_cbranch_scc1 mk_qt27
    s_sleep 3
    buffer_load_dwordx4 v[176:179], v30, s[4:7], s39 offen offset:512 sc1
    s_waitcnt vmcnt(0)
    v_cmp_eq_u32 vcc, 0, v176
    s_cbranch_vccnz mk_qs25
    s_branch mk_qo26
mk_qt27:
    s_mov_b32 s25, 0
    s_branch mk_qo26
mk_ps28:
    s_sub_u32 s25, s25, 1
    s_cbranch_scc1 mk_pt30
    s_sleep 1
    v_mov_b32 v20, 0
    buffer_atomic_add v20, v13, s[4:7], s37 offen sc0 sc1
    s_waitcnt vmcnt(0)
    v_cmp_gt_u32 vcc, 11, v20
    s_nop 0
    s_and_b64 vcc, vcc, s[52:53]
    s_cbranch_scc1 mk_ps28
    s_branch mk_po29
mk_pt30:
    s_mov_b32 s25, 0
    s_branch mk_po29
mk_qs31:
    s_sub_u32 s25, s25, 1
    s_cbranch_scc1 mk_qt33
    s_sleep 3
    buffer_load_dwordx4 v[180:183], v30, s[4:7], s39 offen offset:1024 sc1
    s_waitcnt vmcnt(0)
    v_cmp_eq_u32 vcc, 0, v180
    s_cbranch_vccnz mk_qs31
    s_branch mk_qo32
mk_qt33:
    s_mov_b32 s25, 0
    s_branch mk_qo32
mk_ps34:
    s_sub_u32 s25, s25, 1
    s_cbranch_scc1 mk_pt36
    s_sleep 1
    v_mov_b32 v20, 0
    buffer_atomic_add v20, v13, s[4:7], s37 offen sc0 sc1
    s_waitcnt vmcnt(0)
    v_cmp_gt_u32 vcc, 11, v20
    s_nop 0
    s_and_b64 vcc, vcc, s[52:53]
    s_cbranch_scc1 mk_ps34
    s_branch mk_po35
mk_pt36:
    s_mov_b32 s25, 0
    s_branch mk_po35
mk_ps37:
    s_sub_u32 s25, s25, 1
    s_cbranch_scc1 mk_pt39
    s_sleep 1
    v_mov_b32 v20, 0
    buffer_atomic_add v20, v19, s[4:7], s37 offen sc0 sc1
    s_waitcnt vmcnt(0)
    v_cmp_gt_u32 vcc, 16, v20
    s_nop 0
    s_and_b64 vcc, vcc, s[54:55]
    s_cbranch_scc1 mk_ps37
    s_branch mk_po38
mk_pt39:
    s_mov_b32 s25, 0
    s_branch mk_po38
mk_ps40:
    s_sub_u32 s25, s25, 1
    s_cbranch_scc1 mk_pt42
    s_sleep 1
    v_mov_b32 v20, 0
    buffer_atomic_add v20, v19, s[4:7], s37 offen sc0 sc1
    s_waitcnt vmcnt(0)
    v_cmp_gt_u32 vcc, 16, v20
    s_nop 0
    s_and_b64 vcc, vcc, s[54:55]
    s_cbranch_scc1 mk_ps40
    s_branch mk_po41
mk_pt42:
    s_mov_b32 s25, 0
    s_branch mk_po41
mk_ps43:
    s_sub_u32 s25, s25, 1
    s_cbranch_scc1 mk_pt45
    s_sleep 1
    v_mov_b32 v20, 0
    buffer_atomic_add v20, v19, s[4:7], s37 offen sc0 sc1
    s_waitcnt vmcnt(0)
    v_cmp_gt_u32 vcc, 16, v20
    s_nop 0
    s_and_b64 vcc, vcc, s[54:55]
    s_cbranch_scc1 mk_ps43
    s_branch mk_po44
mk_pt45:
    s_mov_b32 s25, 0
    s_branch mk_po44
mk_ps46:
    s_sub_u32 s25, s25, 1
    s_cbranch_scc1 mk_pt48
    s_sleep 1
    v_mov_b32 v20, 0
    buffer_atomic_add v20, v19, s[4:7], s37 offen sc0 sc1
    s_waitcnt vmcnt(0)
    v_cmp_gt_u32 vcc, 16, v20
    s_nop 0
    s_and_b64 vcc, vcc, s[54:55]
    s_cbranch_scc1 mk_ps46
    s_branch mk_po47
mk_pt48:
    s_mov_b32 s25, 0
    s_branch mk_po47
mk_qs49:
    s_sub_u32 s25, s25, 1
    s_cbranch_scc1 mk_qt51
    s_sleep 3
    buffer_load_dwordx4 v[176:179], v30, s[4:7], s39 offen offset:512 sc1
    s_waitcnt vmcnt(0)
    v_cmp_eq_u32 vcc, 0, v176
    s_cbranch_vccnz mk_qs49
    s_branch mk_qo50
mk_qt51:
    s_mov_b32 s25, 0
    s_branch mk_qo50
mk_qs52:
    s_sub_u32 s25, s25, 1
    s_cbranch_scc1 mk_qt54
    s_sleep 3
    buffer_load_dwordx4 v[180:183], v30, s[4:7], s39 offen offset:1024 sc1
    s_waitcnt vmcnt(0)
    v_cmp_eq_u32 vcc, 0, v180
    s_cbranch_vccnz mk_qs52
    s_branch mk_qo53
mk_qt54:
    s_mov_b32 s25, 0
    s_branch mk_qo53
mk_qs55:
    s_sub_u32 s25, s25, 1
    s_cbranch_scc1 mk_qt57
    s_sleep 3
    buffer_load_dwordx4 v[172:175], v30, s[4:7], s39 offen offset:0 sc1
    s_waitcnt vmcnt(0)
    v_cmp_eq_u32 vcc, 0, v172
    s_cbranch_vccnz mk_qs55
    s_branch mk_qo56
mk_qt57:
    s_mov_b32 s25, 0
    s_branch mk_qo56
mk_qs58:
    s_sub_u32 s25, s25, 1
    s_cbranch_scc1 mk_qt60
    s_sleep 3
    buffer_load_dwordx4 v[176:179], v30, s[4:7], s39 offen offset:512 sc1
    s_waitcnt vmcnt(0)
    v_cmp_eq_u32 vcc, 0, v176
    s_cbranch_vccnz mk_qs58
    s_branch mk_qo59
mk_qt60:
    s_mov_b32 s25, 0
    s_branch mk_qo59
mk_ps61:
    s_sub_u32 s25, s25, 1
    s_cbranch_scc1 mk_pt63
    s_sleep 1
    v_mov_b32 v20, 0
    buffer_atomic_add v20, v13, s[4:7], s37 offen sc0 sc1
    s_waitcnt vmcnt(0)
    v_cmp_gt_u32 vcc, 11, v20
    s_nop 0
    s_and_b64 vcc, vcc, s[52:53]
    s_cbranch_scc1 mk_ps61
    s_branch mk_po62
mk_pt63:
    s_mov_b32 s25, 0
    s_branch mk_po62
mk_qs64:
    s_sub_u32 s25, s25, 1
    s_cbranch_scc1 mk_qt66
    s_sleep 3
    buffer_load_dwordx4 v[180:183], v30, s[4:7], s39 offen offset:1024 sc1
    s_waitcnt vmcnt(0)
    v_cmp_eq_u32 vcc, 0, v180
    s_cbranch_vccnz mk_qs64
    s_branch mk_qo65
mk_qt66:
    s_mov_b32 s25, 0
    s_branch mk_qo65
mk_ps67:
    s_sub_u32 s25, s25, 1
    s_cbranch_scc1 mk_pt69
    s_sleep 1
    v_mov_b32 v20, 0
    buffer_atomic_add v20, v13, s[4:7], s37 offen sc0 sc1
    s_waitcnt vmcnt(0)
    v_cmp_gt_u32 vcc, 11, v20
    s_nop 0
    s_and_b64 vcc, vcc, s[52:53]
    s_cbranch_scc1 mk_ps67
    s_branch mk_po68
mk_pt69:
    s_mov_b32 s25, 0
    s_branch mk_po68
mk_ps72:
    s_sub_u32 s25, s25, 1
    s_cbranch_scc1 mk_pt74
    s_sleep 2
    v_mov_b32 v20, 0
    buffer_atomic_add v20, v19, s[4:7], s37 offen sc0 sc1
    s_waitcnt vmcnt(0)
    v_cmp_gt_u32 vcc, 16, v20
    s_nop 0
    s_and_b64 vcc, vcc, s[54:55]
    s_cbranch_scc1 mk_ps72
    s_branch mk_po73
mk_pt74:
    s_mov_b32 s25, 0
    s_branch mk_po73
mk_ps78:
    s_sub_u32 s25, s25, 1
    s_cbranch_scc1 mk_pt80
    s_sleep 16
    v_mov_b32 v20, 0
    buffer_atomic_add v20, v13, s[4:7], s37 offen sc0 sc1
    s_waitcnt vmcnt(0)
    v_cmp_gt_u32 vcc, 11, v20
    s_nop 0
    s_and_b64 vcc, vcc, s[52:53]
    s_cbranch_scc1 mk_ps78
    s_branch mk_po79
mk_pt80:
    s_mov_b32 s25, 0
    s_branch mk_po79
mk_ps83:
    s_sub_u32 s25, s25, 1
    s_cbranch_scc1 mk_pt85
    s_sleep 2
    v_mov_b32 v20, 0
    buffer_atomic_add v20, v19, s[4:7], s37 offen sc0 sc1
    s_waitcnt vmcnt(0)
    v_cmp_gt_u32 vcc, 16, v20
    s_nop 0
    s_and_b64 vcc, vcc, s[54:55]
    s_cbranch_scc1 mk_ps83
    s_branch mk_po84
mk_pt85:
    s_mov_b32 s25, 0
    s_branch mk_po84
mk_ps89:
    s_sub_u32 s25, s25, 1
    s_cbranch_scc1 mk_pt91
    s_sleep 16
    v_mov_b32 v20, 0
    buffer_atomic_add v20, v13, s[4:7], s37 offen sc0 sc1
    s_waitcnt vmcnt(0)
    v_cmp_gt_u32 vcc, 11, v20
    s_nop 0
    s_and_b64 vcc, vcc, s[52:53]
    s_cbranch_scc1 mk_ps89
    s_branch mk_po90
mk_pt91:
    s_mov_b32 s25, 0
    s_branch mk_po90
mk_codeend:
    s_endpgm
.section .rodata,"a"
.p2align 6
.amdhsa_kernel interleave_layers__ssm_conv_s4d__glu_gated_geglu__prompt_kernel
  .amdhsa_next_free_vgpr 512
  .amdhsa_next_free_sgpr 102
  .amdhsa_accum_offset 256
  .amdhsa_group_segment_fixed_size 0
  .amdhsa_kernarg_size 112
  .amdhsa_user_sgpr_count 2
  .amdhsa_user_sgpr_kernarg_segment_ptr 1
  .amdhsa_system_sgpr_workgroup_id_x 1
  .amdhsa_float_denorm_mode_32 3
  .amdhsa_float_denorm_mode_16_64 3
.end_amdhsa_kernel
```
